```python
import torch

def _softmax(x, axis=-1):
    return torch.softmax(x, dim=axis)
def _gelu(x):
    return torch.nn.functional.gelu(x, approximate="tanh")
def _silu(x):
    return torch.nn.functional.silu(x)
def _sigmoid(x):
    return torch.sigmoid(x)
def _layernorm(x, axis=-1, eps=1e-5):
    m = x.mean(dim=axis, keepdim=True)
    v = x.var(dim=axis, keepdim=True, unbiased=False)
    return (x - m) / torch.sqrt(v + eps)
def _scatter_add(tgt, idx, src, axis=0):
    return tgt.clone().index_add_(axis, idx, src)
def _segment_sum(src, seg, n):
    out = torch.zeros((n,) + src.shape[1:], dtype=src.dtype)
    return out.index_add_(0, seg, src)
def _pad(x, pw):
    flat = tuple(v for pair in reversed(pw) for v in pair)
    return torch.nn.functional.pad(x, flat)

kernel_name = 'gated_mix__linear_attn_block__dense_activation_relu__prompt'

def setup_inputs():

    _w = (lambda a: (lambda t: t.to(torch.bfloat16) if t.is_floating_point() else t)(torch.as_tensor(a)))
    def _A_setup():
        B, S, D = 1, 2048, 640
        return {
            "x": _w((lambda *s: torch.randn(*s, dtype=torch.bfloat16) * 0.05)(B, S, D)),
            "wqkv": _w((lambda *s: torch.randn(*s, dtype=torch.bfloat16) * 0.8)(D, 3 * D)),
            "wo": _w((lambda *s: torch.randn(*s, dtype=torch.bfloat16) * 0.2)(D, D)),
        }
    _A_in = _A_setup()

    def _B_setup():
        B, S, D, Dff = 1, 2048, 640, 1536
        return {
            "x": _w((lambda *s: torch.randn(*s, dtype=torch.bfloat16) * 0.05)(B, S, D)),
            "w1": _w((lambda *s: torch.randn(*s, dtype=torch.bfloat16) * 0.05)(D, Dff)),
            "w2": _w((lambda *s: torch.randn(*s, dtype=torch.bfloat16) * 0.05)(Dff, D)),
        }
    _B_in = _B_setup()

    return {
        "A_x": _A_in["x"],
        "A_wqkv": _A_in["wqkv"],
        "A_wo": _A_in["wo"],
        "B_x": _B_in["x"],
        "B_w1": _B_in["w1"],
        "B_w2": _B_in["w2"],
        "gate_w": _w((lambda *s: torch.randn(*s, dtype=torch.bfloat16) * 0.05)(640) * 16.0),
    }

def reference(A_x, A_wqkv, A_wo, B_x, B_w1, B_w2, gate_w):
    def _A_ref(x, wqkv, wo):
        B, S, D = x.shape
        H = 32; Dh = D // H
        qkv = (lambda x, *d: x.permute(*d))((x @ wqkv).reshape(B, S, 3, H, Dh), 2, 0, 3, 1, 4)
        q, k, v = qkv[0], qkv[1], qkv[2]
        phi = lambda t: torch.where(t > 0, t + 1, torch.exp(t)) + 1e-6
        pq, pk = phi(q), phi(k)
        kv = torch.einsum("bhsd,bhse->bhde", pk, v)
        z = torch.einsum("bhsd->bhd", pk)
        num = torch.einsum("bhqd,bhde->bhqe", pq, kv)
        den = torch.einsum("bhqd,bhd->bhq", pq, z)[..., None] + 1e-6
        o = num / den
        return (lambda x, *d: x.permute(*d))(o, 0, 2, 1, 3).reshape(B, S, D) @ wo

    def _B_ref(x, w1, w2):
        h = torch.einsum("bsd,df->bsf", x, w1)
        zero = torch.zeros_like(h)
        h = torch.maximum(h, zero)
        return torch.einsum("bsf,fd->bsd", h, w2)

    x = A_x
    g = _sigmoid((x * gate_w).sum(-1, keepdims=True))
    a = _A_ref(x, A_wqkv, A_wo)
    b = _B_ref(x, B_w1, B_w2)
    return g * a + (1 - g) * b
```

```asm
; @launch grid=(256,1,1) block=(512,1,1) lds=163840
.amdgcn_target "amdgcn-amd-amdhsa--gfx950"
.text
.globl gated_mix__linear_attn_block__dense_activation_relu__prompt_kernel
.p2align 8
.type gated_mix__linear_attn_block__dense_activation_relu__prompt_kernel,@function
gated_mix__linear_attn_block__dense_activation_relu__prompt_kernel:
    s_cmp_ge_u32 s2, 256
    s_cbranch_scc1 Lend
    s_load_dwordx16 s[64:79], s[0:1], 0
    s_load_dwordx4 s[80:83], s[0:1], 64
    v_lshrrev_b32 v1, 6, v0
    v_and_b32 v0, 63, v0
    v_readfirstlane_b32 s44, v1
    s_and_b32 s45, s2, 7
    s_lshr_b32 s46, s2, 3
    s_and_b32 s47, s45, 1
    s_lshl_b32 s47, s47, 3
    s_lshr_b32 s50, s46, 2
    s_add_u32 s47, s47, s50
    s_lshr_b32 s48, s45, 1
    s_lshl_b32 s48, s48, 1
    s_and_b32 s50, s46, 1
    s_add_u32 s48, s48, s50
    s_mov_b32 s49, 0
    s_cmp_ge_u32 s44, 4
    s_cbranch_scc1 Lload
    s_bitcmp1_b32 s46, 1
    s_cbranch_scc1 LcB
    s_waitcnt lgkmcnt(0)
    s_mov_b32 s8, s64
    s_and_b32 s9, s65, 0xffff
    s_mov_b32 s10, 2621440
    s_mov_b32 s11, 0x00020000
    s_mov_b32 s12, s66
    s_and_b32 s13, s67, 0xffff
    s_mov_b32 s14, 2457600
    s_mov_b32 s15, 0x00020000
    s_mov_b32 s16, s72
    s_and_b32 s17, s73, 0xffff
    s_mov_b32 s18, 1966080
    s_mov_b32 s19, 0x00020000
    s_mov_b32 s20, s82
    s_and_b32 s21, s83, 0xffff
    s_mov_b32 s22, 15204352
    s_mov_b32 s23, 0x00020000
    s_mov_b32 s24, s76
    s_and_b32 s25, s77, 0xffff
    s_mov_b32 s26, 1280
    s_mov_b32 s27, 0x00020000
    s_mov_b32 s28, s74
    s_and_b32 s29, s75, 0xffff
    s_mov_b32 s30, 1966080
    s_mov_b32 s31, 0x00020000
    s_mov_b32 s32, s68
    s_and_b32 s33, s69, 0xffff
    s_mov_b32 s34, 819200
    s_mov_b32 s35, 0x00020000
    s_mov_b32 s36, s78
    s_and_b32 s37, s79, 0xffff
    s_mov_b32 s38, 2621440
    s_mov_b32 s39, 0x00020000
    s_or_b32 s50, s2, s44
    s_cmp_lg_u32 s50, 0
    s_cbranch_scc1 Lnn_1
    s_memrealtime s[50:51]
    s_waitcnt lgkmcnt(0)
    s_or_b32 s50, s50, 1
    v_mov_b32 v5, s50
    v_mov_b32 v6, 0
    global_store_dword v6, v5, s[80:81] sc1
Lnn_1:
    v_mov_b32 v66, 0
    v_mov_b32 v65, 0
    v_mov_b32 v5, 163348
    ds_write_b32 v5, v66
    ds_write_b32 v5, v66 offset:4
    ds_write_b32 v5, v66 offset:8
    v_and_b32 v1, 15, v0
    v_lshrrev_b32 v2, 4, v0
    v_bfe_u32 v3, v0, 2, 2
    v_and_b32 v4, 3, v0
    v_lshrrev_b32 v5, 1, v1
    v_xor_b32 v5, v2, v5
    v_lshlrev_b32 v5, 4, v5
    v_lshl_add_u32 v5, v1, 7, v5
    s_lshl_b32 s50, s44, 12
    v_add_u32 v48, s50, v5
    v_xor_b32 v49, 64, v48
    v_lshrrev_b32 v5, 1, v2
    v_lshlrev_b32 v5, 4, v5
    v_and_b32 v6, 1, v2
    v_lshl_add_u32 v5, v6, 2, v5
    v_add_u32 v5, v5, v3
    v_mul_u32_u24 v50, 160, v5
    v_lshl_add_u32 v50, v4, 3, v50
    v_lshrrev_b32 v7, 1, v3
    v_lshlrev_b32 v7, 1, v7
    v_lshl_add_u32 v7, v6, 2, v7
    v_lshrrev_b32 v8, 1, v4
    v_and_b32 v9, 1, v4
    v_lshlrev_b32 v9, 3, v9
    v_lshl_add_u32 v9, v5, 7, v9
    v_add_u32 v10, 0, v8
    v_xor_b32 v10, v10, v7
    v_lshl_add_u32 v51, v10, 4, v9
    v_add_u32 v10, 2, v8
    v_xor_b32 v10, v10, v7
    v_lshl_add_u32 v52, v10, 4, v9
    v_add_u32 v10, 4, v8
    v_xor_b32 v10, v10, v7
    v_lshl_add_u32 v53, v10, 4, v9
    v_add_u32 v10, 6, v8
    v_xor_b32 v10, v10, v7
    v_lshl_add_u32 v54, v10, 4, v9
    v_mov_b32 v56, v48
    v_mov_b32 v57, v49
    v_mov_b32 v58, v50
    v_mov_b32 v59, v51
    v_mov_b32 v60, v52
    v_mov_b32 v61, v53
    v_mov_b32 v62, v54
    s_mov_b32 s50, 897988541
    v_mov_b32 v128, s50
    v_mov_b32 v129, s50
    v_mov_b32 v130, s50
    v_mov_b32 v131, s50
    v_mov_b32 v132, s50
    v_mov_b32 v133, s50
    v_mov_b32 v134, s50
    v_mov_b32 v135, s50
    v_mov_b32 v136, s50
    v_mov_b32 v137, s50
    v_mov_b32 v138, s50
    v_mov_b32 v139, s50
    v_mov_b32 v140, s50
    v_mov_b32 v141, s50
    v_mov_b32 v142, s50
    v_mov_b32 v143, s50
    v_mov_b32 v144, s50
    v_mov_b32 v145, s50
    v_mov_b32 v146, s50
    v_mov_b32 v147, s50
    v_mov_b32 v148, s50
    v_mov_b32 v149, s50
    v_mov_b32 v150, s50
    v_mov_b32 v151, s50
    v_mov_b32 v152, s50
    v_mov_b32 v153, s50
    v_mov_b32 v154, s50
    v_mov_b32 v155, s50
    v_mov_b32 v156, s50
    v_mov_b32 v157, s50
    v_mov_b32 v158, s50
    v_mov_b32 v159, s50
    v_mov_b32 v160, s50
    v_mov_b32 v161, s50
    v_mov_b32 v162, s50
    v_mov_b32 v163, s50
    v_mov_b32 v164, s50
    v_mov_b32 v165, s50
    v_mov_b32 v166, s50
    v_mov_b32 v167, s50
    v_mov_b32 v168, 0
    v_mov_b32 v169, 0
    v_mov_b32 v170, 0
    v_mov_b32 v171, 0
    v_mov_b32 v172, 0
    v_mov_b32 v173, 0
    v_mov_b32 v174, 0
    v_mov_b32 v175, 0
    v_mov_b32 v176, 0
    v_mov_b32 v177, 0
    v_mov_b32 v178, 0
    v_mov_b32 v179, 0
    v_mov_b32 v180, 0
    v_mov_b32 v181, 0
    v_mov_b32 v182, 0
    v_mov_b32 v183, 0
    v_mov_b32 v184, 0
    v_mov_b32 v185, 0
    v_mov_b32 v186, 0
    v_mov_b32 v187, 0
    v_mov_b32 v188, 0
    v_mov_b32 v189, 0
    v_mov_b32 v190, 0
    v_mov_b32 v191, 0
    v_mov_b32 v192, 0
    v_mov_b32 v193, 0
    v_mov_b32 v194, 0
    v_mov_b32 v195, 0
    v_mov_b32 v196, 0
    v_mov_b32 v197, 0
    v_mov_b32 v198, 0
    v_mov_b32 v199, 0
    v_mov_b32 v200, 0
    v_mov_b32 v201, 0
    v_mov_b32 v202, 0
    v_mov_b32 v203, 0
    v_mov_b32 v204, 0
    v_mov_b32 v205, 0
    v_mov_b32 v206, 0
    v_mov_b32 v207, 0
    v_mov_b32 v208, 0
    v_mov_b32 v209, 0
    v_mov_b32 v210, 0
    v_mov_b32 v211, 0
    v_mov_b32 v212, 0
    v_mov_b32 v213, 0
    v_mov_b32 v214, 0
    v_mov_b32 v215, 0
    v_mov_b32 v216, 0
    v_mov_b32 v217, 0
    v_mov_b32 v218, 0
    v_mov_b32 v219, 0
    v_mov_b32 v220, 0
    v_mov_b32 v221, 0
    v_mov_b32 v222, 0
    v_mov_b32 v223, 0
    v_mov_b32 v224, 0
    v_mov_b32 v225, 0
    v_mov_b32 v226, 0
    v_mov_b32 v227, 0
    v_mov_b32 v228, 0
    v_mov_b32 v229, 0
    v_mov_b32 v230, 0
    v_mov_b32 v231, 0
    v_mov_b32 v232, 0
    v_mov_b32 v233, 0
    v_mov_b32 v234, 0
    v_mov_b32 v235, 0
    v_mov_b32 v236, 0
    v_mov_b32 v237, 0
    v_mov_b32 v238, 0
    v_mov_b32 v239, 0
    s_mul_i32 s50, s44, 6720
    s_add_u32 s50, s50, 136448
    v_mov_b32 v15, 163328
    v_lshl_add_u32 v5, v2, 2, 0
    v_mul_u32_u24 v6, 205, v5
    v_lshrrev_b32 v16, 12, v6
    v_mul_u32_u24 v6, 20, v16
    v_sub_u32 v6, v5, v6
    v_mul_u32_u24 v7, 1680, v16
    v_lshl_add_u32 v7, v6, 2, v7
    v_add_u32 v21, s50, v7
    v_add_u32 v5, 0, v1
    v_mul_u32_u24 v6, 205, v5
    v_lshrrev_b32 v26, 12, v6
    v_mul_u32_u24 v6, 20, v26
    v_sub_u32 v6, v5, v6
    v_mul_u32_u24 v31, 80, v6
    v_lshl_add_u32 v5, v2, 2, 16
    v_mul_u32_u24 v6, 205, v5
    v_lshrrev_b32 v17, 12, v6
    v_mul_u32_u24 v6, 20, v17
    v_sub_u32 v6, v5, v6
    v_mul_u32_u24 v7, 1680, v17
    v_lshl_add_u32 v7, v6, 2, v7
    v_add_u32 v22, s50, v7
    v_add_u32 v5, 16, v1
    v_mul_u32_u24 v6, 205, v5
    v_lshrrev_b32 v27, 12, v6
    v_mul_u32_u24 v6, 20, v27
    v_sub_u32 v6, v5, v6
    v_mul_u32_u24 v32, 80, v6
    v_lshl_add_u32 v5, v2, 2, 32
    v_mul_u32_u24 v6, 205, v5
    v_lshrrev_b32 v18, 12, v6
    v_mul_u32_u24 v6, 20, v18
    v_sub_u32 v6, v5, v6
    v_mul_u32_u24 v7, 1680, v18
    v_lshl_add_u32 v7, v6, 2, v7
    v_add_u32 v23, s50, v7
    v_add_u32 v5, 32, v1
    v_mul_u32_u24 v6, 205, v5
    v_lshrrev_b32 v28, 12, v6
    v_mul_u32_u24 v6, 20, v28
    v_sub_u32 v6, v5, v6
    v_mul_u32_u24 v33, 80, v6
    v_lshl_add_u32 v5, v2, 2, 48
    v_mul_u32_u24 v6, 205, v5
    v_lshrrev_b32 v19, 12, v6
    v_mul_u32_u24 v6, 20, v19
    v_sub_u32 v6, v5, v6
    v_mul_u32_u24 v7, 1680, v19
    v_lshl_add_u32 v7, v6, 2, v7
    v_add_u32 v24, s50, v7
    v_add_u32 v5, 48, v1
    v_mul_u32_u24 v6, 205, v5
    v_lshrrev_b32 v29, 12, v6
    v_mul_u32_u24 v6, 20, v29
    v_sub_u32 v6, v5, v6
    v_mul_u32_u24 v34, 80, v6
    v_lshl_add_u32 v5, v2, 2, 64
    v_mul_u32_u24 v6, 205, v5
    v_lshrrev_b32 v20, 12, v6
    v_mul_u32_u24 v6, 20, v20
    v_sub_u32 v6, v5, v6
    v_mul_u32_u24 v7, 1680, v20
    v_lshl_add_u32 v7, v6, 2, v7
    v_add_u32 v25, s50, v7
    v_add_u32 v5, 64, v1
    v_mul_u32_u24 v6, 205, v5
    v_lshrrev_b32 v30, 12, v6
    v_mul_u32_u24 v6, 20, v30
    v_sub_u32 v6, v5, v6
    v_mul_u32_u24 v35, 80, v6
    v_add_u32 v5, v21, v31
    v_cmp_eq_u32 vcc, v16, v26
    s_nop 1
    v_cndmask_b32 v68, v15, v5, vcc
    v_add_u32 v5, v21, v32
    v_cmp_eq_u32 vcc, v16, v27
    s_nop 1
    v_cndmask_b32 v69, v15, v5, vcc
    v_add_u32 v5, v22, v31
    v_cmp_eq_u32 vcc, v17, v26
    s_nop 1
    v_cndmask_b32 v70, v15, v5, vcc
    v_add_u32 v5, v22, v32
    v_cmp_eq_u32 vcc, v17, v27
    s_nop 1
    v_cndmask_b32 v71, v15, v5, vcc
    v_add_u32 v5, v22, v33
    v_cmp_eq_u32 vcc, v17, v28
    s_nop 1
    v_cndmask_b32 v72, v15, v5, vcc
    v_add_u32 v5, v23, v32
    v_cmp_eq_u32 vcc, v18, v27
    s_nop 1
    v_cndmask_b32 v73, v15, v5, vcc
    v_add_u32 v5, v23, v33
    v_cmp_eq_u32 vcc, v18, v28
    s_nop 1
    v_cndmask_b32 v74, v15, v5, vcc
    v_add_u32 v5, v23, v34
    v_cmp_eq_u32 vcc, v18, v29
    s_nop 1
    v_cndmask_b32 v75, v15, v5, vcc
    v_add_u32 v5, v24, v33
    v_cmp_eq_u32 vcc, v19, v28
    s_nop 1
    v_cndmask_b32 v76, v15, v5, vcc
    v_add_u32 v5, v24, v34
    v_cmp_eq_u32 vcc, v19, v29
    s_nop 1
    v_cndmask_b32 v77, v15, v5, vcc
    v_add_u32 v5, v24, v35
    v_cmp_eq_u32 vcc, v19, v30
    s_nop 1
    v_cndmask_b32 v78, v15, v5, vcc
    v_add_u32 v5, v25, v34
    v_cmp_eq_u32 vcc, v20, v29
    s_nop 1
    v_cndmask_b32 v79, v15, v5, vcc
    v_add_u32 v5, v25, v35
    v_cmp_eq_u32 vcc, v20, v30
    s_nop 1
    v_cndmask_b32 v80, v15, v5, vcc
    v_cmp_eq_u32 vcc, 0, v1
    v_add_u32 v5, 1600, v21
    s_nop 0
    v_cndmask_b32 v81, v15, v5, vcc
    v_add_u32 v5, 1600, v22
    v_cndmask_b32 v82, v15, v5, vcc
    v_add_u32 v5, 1600, v23
    v_cndmask_b32 v83, v15, v5, vcc
    v_add_u32 v5, 1600, v24
    v_cndmask_b32 v84, v15, v5, vcc
    v_add_u32 v5, 1600, v25
    v_cndmask_b32 v85, v15, v5, vcc
    s_mov_b32 s50, 0
    s_mov_b32 s51, 0
    s_barrier
    ds_read_b128 v[16:19], v56 offset:0
    ds_read_b128 v[20:23], v56 offset:2048
    ds_read_b64_tr_b16 v[86:87], v58 offset:16384
    ds_read_b64_tr_b16 v[88:89], v58 offset:17664
    ds_read_b64_tr_b16 v[90:91], v58 offset:16416
    ds_read_b64_tr_b16 v[92:93], v58 offset:17696
    ds_read_b64_tr_b16 v[94:95], v58 offset:16448
    ds_read_b64_tr_b16 v[96:97], v58 offset:17728
    ds_read_b64_tr_b16 v[98:99], v58 offset:16480
    ds_read_b64_tr_b16 v[100:101], v58 offset:17760
    ds_read_b64_tr_b16 v[102:103], v58 offset:16512
    ds_read_b64_tr_b16 v[104:105], v58 offset:17792
    ds_read_b64_tr_b16 v[106:107], v58 offset:26624
    ds_read_b64_tr_b16 v[108:109], v58 offset:27904
Lp1_2:
    s_waitcnt lgkmcnt(12)
    s_waitcnt lgkmcnt(10)
    v_mfma_f32_16x16x32_bf16 v[128:131], v[16:19], v[86:89], v[128:131]
    ds_read_b64_tr_b16 v[110:111], v58 offset:26656
    v_mfma_f32_16x16x32_bf16 v[132:135], v[20:23], v[86:89], v[132:135]
    ds_read_b64_tr_b16 v[112:113], v58 offset:27936
    s_waitcnt lgkmcnt(10)
    v_mfma_f32_16x16x32_bf16 v[136:139], v[16:19], v[90:93], v[136:139]
    ds_read_b64_tr_b16 v[86:87], v58 offset:26688
    v_mfma_f32_16x16x32_bf16 v[140:143], v[20:23], v[90:93], v[140:143]
    ds_read_b64_tr_b16 v[88:89], v58 offset:27968
    s_waitcnt lgkmcnt(10)
    v_mfma_f32_16x16x32_bf16 v[144:147], v[16:19], v[94:97], v[144:147]
    ds_read_b64_tr_b16 v[90:91], v58 offset:26720
    v_mfma_f32_16x16x32_bf16 v[148:151], v[20:23], v[94:97], v[148:151]
    ds_read_b64_tr_b16 v[92:93], v58 offset:28000
    s_waitcnt lgkmcnt(10)
    v_mfma_f32_16x16x32_bf16 v[152:155], v[16:19], v[98:101], v[152:155]
    ds_read_b64_tr_b16 v[94:95], v58 offset:26752
    v_mfma_f32_16x16x32_bf16 v[156:159], v[20:23], v[98:101], v[156:159]
    ds_read_b64_tr_b16 v[96:97], v58 offset:28032
    s_waitcnt lgkmcnt(10)
    v_mfma_f32_16x16x32_bf16 v[160:163], v[16:19], v[102:105], v[160:163]
    ds_read_b64_tr_b16 v[98:99], v59 offset:36864
    v_mfma_f32_16x16x32_bf16 v[164:167], v[20:23], v[102:105], v[164:167]
    ds_read_b64_tr_b16 v[100:101], v59 offset:37888
    s_waitcnt lgkmcnt(10)
    v_mfma_f32_16x16x32_bf16 v[168:171], v[16:19], v[106:109], v[168:171]
    ds_read_b64_tr_b16 v[102:103], v60 offset:36864
    v_mfma_f32_16x16x32_bf16 v[172:175], v[20:23], v[106:109], v[172:175]
    ds_read_b64_tr_b16 v[104:105], v60 offset:37888
    s_waitcnt lgkmcnt(10)
    v_mfma_f32_16x16x32_bf16 v[176:179], v[16:19], v[110:113], v[176:179]
    ds_read_b64_tr_b16 v[106:107], v61 offset:36864
    v_mfma_f32_16x16x32_bf16 v[180:183], v[20:23], v[110:113], v[180:183]
    ds_read_b64_tr_b16 v[108:109], v61 offset:37888
    ds_read_b128 v[24:27], v57 offset:0
    ds_read_b128 v[28:31], v57 offset:2048
    s_waitcnt lgkmcnt(12)
    v_mfma_f32_16x16x32_bf16 v[184:187], v[16:19], v[86:89], v[184:187]
    ds_read_b64_tr_b16 v[110:111], v62 offset:36864
    v_mfma_f32_16x16x32_bf16 v[188:191], v[20:23], v[86:89], v[188:191]
    ds_read_b64_tr_b16 v[112:113], v62 offset:37888
    s_waitcnt lgkmcnt(12)
    v_mfma_f32_16x16x32_bf16 v[192:195], v[16:19], v[90:93], v[192:195]
    ds_read_b64_tr_b16 v[86:87], v58 offset:21504
    v_mfma_f32_16x16x32_bf16 v[196:199], v[20:23], v[90:93], v[196:199]
    ds_read_b64_tr_b16 v[88:89], v58 offset:22784
    s_waitcnt lgkmcnt(12)
    v_mfma_f32_16x16x32_bf16 v[200:203], v[16:19], v[94:97], v[200:203]
    ds_read_b64_tr_b16 v[90:91], v58 offset:21536
    v_mfma_f32_16x16x32_bf16 v[204:207], v[20:23], v[94:97], v[204:207]
    ds_read_b64_tr_b16 v[92:93], v58 offset:22816
    s_waitcnt lgkmcnt(12)
    v_mfma_f32_16x16x32_bf16 v[208:211], v[98:101], v[16:19], v[208:211]
    ds_read_b64_tr_b16 v[94:95], v58 offset:21568
    v_mfma_f32_16x16x32_bf16 v[212:215], v[98:101], v[20:23], v[212:215]
    ds_read_b64_tr_b16 v[96:97], v58 offset:22848
    s_waitcnt lgkmcnt(12)
    v_mfma_f32_16x16x32_bf16 v[216:219], v[102:105], v[16:19], v[216:219]
    ds_read_b64_tr_b16 v[98:99], v58 offset:21600
    v_mfma_f32_16x16x32_bf16 v[220:223], v[102:105], v[20:23], v[220:223]
    ds_read_b64_tr_b16 v[100:101], v58 offset:22880
    s_waitcnt lgkmcnt(12)
    v_mfma_f32_16x16x32_bf16 v[224:227], v[106:109], v[16:19], v[224:227]
    ds_read_b64_tr_b16 v[102:103], v58 offset:21632
    v_mfma_f32_16x16x32_bf16 v[228:231], v[106:109], v[20:23], v[228:231]
    ds_read_b64_tr_b16 v[104:105], v58 offset:22912
    s_waitcnt lgkmcnt(10)
    v_mfma_f32_16x16x32_bf16 v[232:235], v[110:113], v[16:19], v[232:235]
    ds_read_b64_tr_b16 v[106:107], v58 offset:31744
    v_mfma_f32_16x16x32_bf16 v[236:239], v[110:113], v[20:23], v[236:239]
    ds_read_b64_tr_b16 v[108:109], v58 offset:33024
    s_waitcnt lgkmcnt(10)
    v_mfma_f32_16x16x32_bf16 v[128:131], v[24:27], v[86:89], v[128:131]
    ds_read_b64_tr_b16 v[110:111], v58 offset:31776
    v_mfma_f32_16x16x32_bf16 v[132:135], v[28:31], v[86:89], v[132:135]
    ds_read_b64_tr_b16 v[112:113], v58 offset:33056
    s_waitcnt lgkmcnt(10)
    v_mfma_f32_16x16x32_bf16 v[136:139], v[24:27], v[90:93], v[136:139]
    ds_read_b64_tr_b16 v[86:87], v58 offset:31808
    v_mfma_f32_16x16x32_bf16 v[140:143], v[28:31], v[90:93], v[140:143]
    ds_read_b64_tr_b16 v[88:89], v58 offset:33088
    s_waitcnt lgkmcnt(10)
    v_mfma_f32_16x16x32_bf16 v[144:147], v[24:27], v[94:97], v[144:147]
    ds_read_b64_tr_b16 v[90:91], v58 offset:31840
    v_mfma_f32_16x16x32_bf16 v[148:151], v[28:31], v[94:97], v[148:151]
    ds_read_b64_tr_b16 v[92:93], v58 offset:33120
    s_waitcnt lgkmcnt(10)
    v_mfma_f32_16x16x32_bf16 v[152:155], v[24:27], v[98:101], v[152:155]
    ds_read_b64_tr_b16 v[94:95], v58 offset:31872
    v_mfma_f32_16x16x32_bf16 v[156:159], v[28:31], v[98:101], v[156:159]
    ds_read_b64_tr_b16 v[96:97], v58 offset:33152
    s_waitcnt lgkmcnt(10)
    v_mfma_f32_16x16x32_bf16 v[160:163], v[24:27], v[102:105], v[160:163]
    ds_read_b64_tr_b16 v[98:99], v59 offset:40960
    v_mfma_f32_16x16x32_bf16 v[164:167], v[28:31], v[102:105], v[164:167]
    ds_read_b64_tr_b16 v[100:101], v59 offset:41984
    s_waitcnt lgkmcnt(10)
    v_mfma_f32_16x16x32_bf16 v[168:171], v[24:27], v[106:109], v[168:171]
    ds_read_b64_tr_b16 v[102:103], v60 offset:40960
    v_mfma_f32_16x16x32_bf16 v[172:175], v[28:31], v[106:109], v[172:175]
    ds_read_b64_tr_b16 v[104:105], v60 offset:41984
    s_waitcnt lgkmcnt(10)
    v_mfma_f32_16x16x32_bf16 v[176:179], v[24:27], v[110:113], v[176:179]
    ds_read_b64_tr_b16 v[106:107], v61 offset:40960
    v_mfma_f32_16x16x32_bf16 v[180:183], v[28:31], v[110:113], v[180:183]
    ds_read_b64_tr_b16 v[108:109], v61 offset:41984
    s_waitcnt lgkmcnt(10)
    v_mfma_f32_16x16x32_bf16 v[184:187], v[24:27], v[86:89], v[184:187]
    ds_read_b64_tr_b16 v[110:111], v62 offset:40960
    v_mfma_f32_16x16x32_bf16 v[188:191], v[28:31], v[86:89], v[188:191]
    ds_read_b64_tr_b16 v[112:113], v62 offset:41984
    s_add_u32 s50, s50, 1
    s_cmp_eq_u32 s50, 10
    s_cbranch_scc1 Lp1last_3
    s_waitcnt lgkmcnt(10)
    v_mfma_f32_16x16x32_bf16 v[192:195], v[24:27], v[90:93], v[192:195]
    s_add_u32 s51, s51, 45056
    s_cmp_ge_u32 s51, 135168
    s_cselect_b32 s52, 135168, 0
    s_sub_u32 s51, s51, s52
    v_add_u32 v56, s51, v48
    v_add_u32 v57, s51, v49
    v_mfma_f32_16x16x32_bf16 v[196:199], v[28:31], v[90:93], v[196:199]
    v_add_u32 v58, s51, v50
    v_add_u32 v59, s51, v51
    v_add_u32 v60, s51, v52
    s_waitcnt lgkmcnt(8)
    v_mfma_f32_16x16x32_bf16 v[200:203], v[24:27], v[94:97], v[200:203]
    v_add_u32 v61, s51, v53
    v_add_u32 v62, s51, v54
    v_mfma_f32_16x16x32_bf16 v[204:207], v[28:31], v[94:97], v[204:207]
    s_lshl_b32 s53, s44, 4
    s_add_u32 s53, s53, s50
    s_cmp_lg_u32 s53, 6
    s_cbranch_scc1 Lx_4
    v_mov_b32 v66, 0
    global_load_dword v65, v66, s[80:81] sc1
Lx_4:
    s_waitcnt lgkmcnt(0)
    s_barrier
    ds_read_b128 v[16:19], v56 offset:0
    ds_read_b128 v[20:23], v56 offset:2048
    v_mfma_f32_16x16x32_bf16 v[208:211], v[98:101], v[24:27], v[208:211]
    ds_read_b64_tr_b16 v[86:87], v58 offset:16384
    ds_read_b64_tr_b16 v[88:89], v58 offset:17664
    v_mfma_f32_16x16x32_bf16 v[212:215], v[98:101], v[28:31], v[212:215]
    ds_read_b64_tr_b16 v[90:91], v58 offset:16416
    ds_read_b64_tr_b16 v[92:93], v58 offset:17696
    v_mfma_f32_16x16x32_bf16 v[216:219], v[102:105], v[24:27], v[216:219]
    ds_read_b64_tr_b16 v[94:95], v58 offset:16448
    ds_read_b64_tr_b16 v[96:97], v58 offset:17728
    v_mfma_f32_16x16x32_bf16 v[220:223], v[102:105], v[28:31], v[220:223]
    ds_read_b64_tr_b16 v[98:99], v58 offset:16480
    ds_read_b64_tr_b16 v[100:101], v58 offset:17760
    v_mfma_f32_16x16x32_bf16 v[224:227], v[106:109], v[24:27], v[224:227]
    ds_read_b64_tr_b16 v[102:103], v58 offset:16512
    v_mfma_f32_16x16x32_bf16 v[228:231], v[106:109], v[28:31], v[228:231]
    ds_read_b64_tr_b16 v[104:105], v58 offset:17792
    v_mfma_f32_16x16x32_bf16 v[232:235], v[110:113], v[24:27], v[232:235]
    ds_read_b64_tr_b16 v[106:107], v58 offset:26624
    v_mfma_f32_16x16x32_bf16 v[236:239], v[110:113], v[28:31], v[236:239]
    ds_read_b64_tr_b16 v[108:109], v58 offset:27904
    s_branch Lp1_2
Lp1last_3:
    s_waitcnt lgkmcnt(0)
    v_mfma_f32_16x16x32_bf16 v[192:195], v[24:27], v[90:93], v[192:195]
    v_mfma_f32_16x16x32_bf16 v[196:199], v[28:31], v[90:93], v[196:199]
    v_mfma_f32_16x16x32_bf16 v[200:203], v[24:27], v[94:97], v[200:203]
    v_mfma_f32_16x16x32_bf16 v[204:207], v[28:31], v[94:97], v[204:207]
    v_mfma_f32_16x16x32_bf16 v[208:211], v[98:101], v[24:27], v[208:211]
    v_mfma_f32_16x16x32_bf16 v[212:215], v[98:101], v[28:31], v[212:215]
    v_mfma_f32_16x16x32_bf16 v[216:219], v[102:105], v[24:27], v[216:219]
    v_mfma_f32_16x16x32_bf16 v[220:223], v[102:105], v[28:31], v[220:223]
    v_mfma_f32_16x16x32_bf16 v[224:227], v[106:109], v[24:27], v[224:227]
    v_mfma_f32_16x16x32_bf16 v[228:231], v[106:109], v[28:31], v[228:231]
    v_mfma_f32_16x16x32_bf16 v[232:235], v[110:113], v[24:27], v[232:235]
    v_mfma_f32_16x16x32_bf16 v[236:239], v[110:113], v[28:31], v[236:239]
    s_mov_b32 s50, 897988541
    s_mov_b32 s51, 1069066811
    s_lshl_b32 s52, s48, 1
    s_lshl_b32 s53, s47, 3
    s_lshl_b32 s54, s44, 1
    s_add_u32 s53, s53, s54
    s_mul_i32 s53, s53, 48
    s_add_u32 s53, s53, s52
    s_lshl_b32 s53, s53, 10
    v_lshlrev_b32 v1, 4, v0
    v_cvt_pk_bf16_f32 v16, v208, v209
    v_cvt_pk_bf16_f32 v17, v210, v211
    v_cvt_pk_bf16_f32 v18, v216, v217
    v_cvt_pk_bf16_f32 v19, v218, v219
    v_pk_max_i16 v16, v16, 0
    v_pk_max_i16 v17, v17, 0
    v_pk_max_i16 v18, v18, 0
    v_pk_max_i16 v19, v19, 0
    s_add_u32 s54, s53, 0
    buffer_store_dwordx4 v[16:19], v1, s[20:23], s54 offen sc1
    v_cvt_pk_bf16_f32 v20, v212, v213
    v_cvt_pk_bf16_f32 v21, v214, v215
    v_cvt_pk_bf16_f32 v22, v220, v221
    v_cvt_pk_bf16_f32 v23, v222, v223
    v_pk_max_i16 v20, v20, 0
    v_pk_max_i16 v21, v21, 0
    v_pk_max_i16 v22, v22, 0
    v_pk_max_i16 v23, v23, 0
    s_add_u32 s54, s53, 49152
    buffer_store_dwordx4 v[20:23], v1, s[20:23], s54 offen sc1
    v_cvt_pk_bf16_f32 v24, v224, v225
    v_cvt_pk_bf16_f32 v25, v226, v227
    v_cvt_pk_bf16_f32 v26, v232, v233
    v_cvt_pk_bf16_f32 v27, v234, v235
    v_pk_max_i16 v24, v24, 0
    v_pk_max_i16 v25, v25, 0
    v_pk_max_i16 v26, v26, 0
    v_pk_max_i16 v27, v27, 0
    s_add_u32 s54, s53, 1024
    buffer_store_dwordx4 v[24:27], v1, s[20:23], s54 offen sc1
    v_cvt_pk_bf16_f32 v28, v228, v229
    v_cvt_pk_bf16_f32 v29, v230, v231
    v_cvt_pk_bf16_f32 v30, v236, v237
    v_cvt_pk_bf16_f32 v31, v238, v239
    v_pk_max_i16 v28, v28, 0
    v_pk_max_i16 v29, v29, 0
    v_pk_max_i16 v30, v30, 0
    v_pk_max_i16 v31, v31, 0
    s_add_u32 s54, s53, 50176
    buffer_store_dwordx4 v[28:31], v1, s[20:23], s54 offen sc1
    v_cvt_pk_bf16_f32 v106, v168, v169
    v_cvt_pk_bf16_f32 v107, v170, v171
    v_cvt_pk_bf16_f32 v108, v172, v173
    v_cvt_pk_bf16_f32 v109, v174, v175
    v_cvt_pk_bf16_f32 v110, v176, v177
    v_cvt_pk_bf16_f32 v111, v178, v179
    v_cvt_pk_bf16_f32 v112, v180, v181
    v_cvt_pk_bf16_f32 v113, v182, v183
    v_cvt_pk_bf16_f32 v114, v184, v185
    v_cvt_pk_bf16_f32 v115, v186, v187
    v_cvt_pk_bf16_f32 v116, v188, v189
    v_cvt_pk_bf16_f32 v117, v190, v191
    v_cvt_pk_bf16_f32 v118, v192, v193
    v_cvt_pk_bf16_f32 v119, v194, v195
    v_cvt_pk_bf16_f32 v120, v196, v197
    v_cvt_pk_bf16_f32 v121, v198, v199
    v_cvt_pk_bf16_f32 v122, v200, v201
    v_cvt_pk_bf16_f32 v123, v202, v203
    v_cvt_pk_bf16_f32 v124, v204, v205
    v_cvt_pk_bf16_f32 v125, v206, v207
    v_mov_b32 v32, 0x3f803f80
    v_mov_b32 v33, 0x3f803f80
    v_mov_b32 v34, 0x3f803f80
    v_mov_b32 v35, 0x3f803f80
    v_mul_f32 v2, s51, v128
    v_exp_f32_e64 v2, v2 clamp
    v_max_f32 v128, s50, v128
    v_add_f32 v128, v128, v2
    v_mul_f32 v3, s51, v129
    v_exp_f32_e64 v3, v3 clamp
    v_max_f32 v129, s50, v129
    v_add_f32 v129, v129, v3
    v_mul_f32 v4, s51, v130
    v_exp_f32_e64 v4, v4 clamp
    v_max_f32 v130, s50, v130
    v_add_f32 v130, v130, v4
    v_mul_f32 v5, s51, v131
    v_exp_f32_e64 v5, v5 clamp
    v_max_f32 v131, s50, v131
    v_add_f32 v131, v131, v5
    v_mul_f32 v2, s51, v132
    v_exp_f32_e64 v2, v2 clamp
    v_max_f32 v132, s50, v132
    v_add_f32 v132, v132, v2
    v_mul_f32 v3, s51, v133
    v_exp_f32_e64 v3, v3 clamp
    v_max_f32 v133, s50, v133
    v_add_f32 v133, v133, v3
    v_mul_f32 v4, s51, v134
    v_exp_f32_e64 v4, v4 clamp
    v_max_f32 v134, s50, v134
    v_add_f32 v134, v134, v4
    v_mul_f32 v5, s51, v135
    v_exp_f32_e64 v5, v5 clamp
    v_max_f32 v135, s50, v135
    v_add_f32 v135, v135, v5
    v_cvt_pk_bf16_f32 v86, v128, v129
    v_cvt_pk_bf16_f32 v87, v130, v131
    v_cvt_pk_bf16_f32 v88, v132, v133
    v_cvt_pk_bf16_f32 v89, v134, v135
    v_mul_f32 v2, s51, v136
    v_exp_f32_e64 v2, v2 clamp
    v_max_f32 v136, s50, v136
    v_add_f32 v136, v136, v2
    v_mul_f32 v3, s51, v137
    v_exp_f32_e64 v3, v3 clamp
    v_max_f32 v137, s50, v137
    v_add_f32 v137, v137, v3
    v_mul_f32 v4, s51, v138
    v_exp_f32_e64 v4, v4 clamp
    v_max_f32 v138, s50, v138
    v_add_f32 v138, v138, v4
    v_mul_f32 v5, s51, v139
    v_exp_f32_e64 v5, v5 clamp
    v_max_f32 v139, s50, v139
    v_add_f32 v139, v139, v5
    v_mul_f32 v2, s51, v140
    v_exp_f32_e64 v2, v2 clamp
    v_max_f32 v140, s50, v140
    v_add_f32 v140, v140, v2
    v_mul_f32 v3, s51, v141
    v_exp_f32_e64 v3, v3 clamp
    v_max_f32 v141, s50, v141
    v_add_f32 v141, v141, v3
    v_mul_f32 v4, s51, v142
    v_exp_f32_e64 v4, v4 clamp
    v_max_f32 v142, s50, v142
    v_add_f32 v142, v142, v4
    v_mul_f32 v5, s51, v143
    v_exp_f32_e64 v5, v5 clamp
    v_max_f32 v143, s50, v143
    v_add_f32 v143, v143, v5
    v_cvt_pk_bf16_f32 v90, v136, v137
    v_cvt_pk_bf16_f32 v91, v138, v139
    v_cvt_pk_bf16_f32 v92, v140, v141
    v_cvt_pk_bf16_f32 v93, v142, v143
    v_mul_f32 v2, s51, v144
    v_exp_f32_e64 v2, v2 clamp
    v_max_f32 v144, s50, v144
    v_add_f32 v144, v144, v2
    v_mul_f32 v3, s51, v145
    v_exp_f32_e64 v3, v3 clamp
    v_max_f32 v145, s50, v145
    v_add_f32 v145, v145, v3
    v_mul_f32 v4, s51, v146
    v_exp_f32_e64 v4, v4 clamp
    v_max_f32 v146, s50, v146
    v_add_f32 v146, v146, v4
    v_mul_f32 v5, s51, v147
    v_exp_f32_e64 v5, v5 clamp
    v_max_f32 v147, s50, v147
    v_add_f32 v147, v147, v5
    v_mul_f32 v2, s51, v148
    v_exp_f32_e64 v2, v2 clamp
    v_max_f32 v148, s50, v148
    v_add_f32 v148, v148, v2
    v_mul_f32 v3, s51, v149
    v_exp_f32_e64 v3, v3 clamp
    v_max_f32 v149, s50, v149
    v_add_f32 v149, v149, v3
    v_mul_f32 v4, s51, v150
    v_exp_f32_e64 v4, v4 clamp
    v_max_f32 v150, s50, v150
    v_add_f32 v150, v150, v4
    v_mul_f32 v5, s51, v151
    v_exp_f32_e64 v5, v5 clamp
    v_max_f32 v151, s50, v151
    v_add_f32 v151, v151, v5
    v_cvt_pk_bf16_f32 v94, v144, v145
    v_cvt_pk_bf16_f32 v95, v146, v147
    v_cvt_pk_bf16_f32 v96, v148, v149
    v_cvt_pk_bf16_f32 v97, v150, v151
    v_mul_f32 v2, s51, v152
    v_exp_f32_e64 v2, v2 clamp
    v_max_f32 v152, s50, v152
    v_add_f32 v152, v152, v2
    v_mul_f32 v3, s51, v153
    v_exp_f32_e64 v3, v3 clamp
    v_max_f32 v153, s50, v153
    v_add_f32 v153, v153, v3
    v_mul_f32 v4, s51, v154
    v_exp_f32_e64 v4, v4 clamp
    v_max_f32 v154, s50, v154
    v_add_f32 v154, v154, v4
    v_mul_f32 v5, s51, v155
    v_exp_f32_e64 v5, v5 clamp
    v_max_f32 v155, s50, v155
    v_add_f32 v155, v155, v5
    v_mul_f32 v2, s51, v156
    v_exp_f32_e64 v2, v2 clamp
    v_max_f32 v156, s50, v156
    v_add_f32 v156, v156, v2
    v_mul_f32 v3, s51, v157
    v_exp_f32_e64 v3, v3 clamp
    v_max_f32 v157, s50, v157
    v_add_f32 v157, v157, v3
    v_mul_f32 v4, s51, v158
    v_exp_f32_e64 v4, v4 clamp
    v_max_f32 v158, s50, v158
    v_add_f32 v158, v158, v4
    v_mul_f32 v5, s51, v159
    v_exp_f32_e64 v5, v5 clamp
    v_max_f32 v159, s50, v159
    v_add_f32 v159, v159, v5
    v_cvt_pk_bf16_f32 v98, v152, v153
    v_cvt_pk_bf16_f32 v99, v154, v155
    v_cvt_pk_bf16_f32 v100, v156, v157
    v_cvt_pk_bf16_f32 v101, v158, v159
    v_mul_f32 v2, s51, v160
    v_exp_f32_e64 v2, v2 clamp
    v_max_f32 v160, s50, v160
    v_add_f32 v160, v160, v2
    v_mul_f32 v3, s51, v161
    v_exp_f32_e64 v3, v3 clamp
    v_max_f32 v161, s50, v161
    v_add_f32 v161, v161, v3
    v_mul_f32 v4, s51, v162
    v_exp_f32_e64 v4, v4 clamp
    v_max_f32 v162, s50, v162
    v_add_f32 v162, v162, v4
    v_mul_f32 v5, s51, v163
    v_exp_f32_e64 v5, v5 clamp
    v_max_f32 v163, s50, v163
    v_add_f32 v163, v163, v5
    v_mul_f32 v2, s51, v164
    v_exp_f32_e64 v2, v2 clamp
    v_max_f32 v164, s50, v164
    v_add_f32 v164, v164, v2
    v_mul_f32 v3, s51, v165
    v_exp_f32_e64 v3, v3 clamp
    v_max_f32 v165, s50, v165
    v_add_f32 v165, v165, v3
    v_mul_f32 v4, s51, v166
    v_exp_f32_e64 v4, v4 clamp
    v_max_f32 v166, s50, v166
    v_add_f32 v166, v166, v4
    v_mul_f32 v5, s51, v167
    v_exp_f32_e64 v5, v5 clamp
    v_max_f32 v167, s50, v167
    v_add_f32 v167, v167, v5
    v_cvt_pk_bf16_f32 v102, v160, v161
    v_cvt_pk_bf16_f32 v103, v162, v163
    v_cvt_pk_bf16_f32 v104, v164, v165
    v_cvt_pk_bf16_f32 v105, v166, v167
    v_mfma_f32_16x16x32_bf16 v[168:171], v[86:89], v[106:109], 0
    v_mfma_f32_16x16x32_bf16 v[172:175], v[86:89], v[110:113], 0
    v_mfma_f32_16x16x32_bf16 v[176:179], v[90:93], v[106:109], 0
    v_mfma_f32_16x16x32_bf16 v[180:183], v[90:93], v[110:113], 0
    v_mfma_f32_16x16x32_bf16 v[184:187], v[90:93], v[114:117], 0
    v_mfma_f32_16x16x32_bf16 v[188:191], v[94:97], v[110:113], 0
    v_mfma_f32_16x16x32_bf16 v[192:195], v[94:97], v[114:117], 0
    v_mfma_f32_16x16x32_bf16 v[196:199], v[94:97], v[118:121], 0
    v_mfma_f32_16x16x32_bf16 v[200:203], v[98:101], v[114:117], 0
    v_mfma_f32_16x16x32_bf16 v[204:207], v[98:101], v[118:121], 0
    v_mfma_f32_16x16x32_bf16 v[208:211], v[98:101], v[122:125], 0
    v_mfma_f32_16x16x32_bf16 v[212:215], v[102:105], v[118:121], 0
    v_mfma_f32_16x16x32_bf16 v[216:219], v[102:105], v[122:125], 0
    v_mfma_f32_16x16x32_bf16 v[220:223], v[86:89], v[32:35], 0
    v_mfma_f32_16x16x32_bf16 v[224:227], v[90:93], v[32:35], 0
    v_mfma_f32_16x16x32_bf16 v[228:231], v[94:97], v[32:35], 0
    v_mfma_f32_16x16x32_bf16 v[232:235], v[98:101], v[32:35], 0
    v_mfma_f32_16x16x32_bf16 v[236:239], v[102:105], v[32:35], 0
    s_cmp_lg_u32 s44, 0
    s_cbranch_scc1 Lnz_5
    s_mov_b32 s52, 0
    s_waitcnt vmcnt(0)
Lnzl_6:
    v_readfirstlane_b32 s49, v65
    s_nop 1
    s_cmp_lg_u32 s49, 0
    s_cbranch_scc1 Lnzok_7
    global_load_dword v65, v66, s[80:81] sc1
    s_add_u32 s52, s52, 1
    s_cmp_lt_u32 s52, 40000
    s_waitcnt vmcnt(0)
    s_cbranch_scc1 Lnzl_6
Lnzok_7:
    v_mov_b32 v66, 163344
    ds_write_b32 v66, v65
Lnz_5:
    ds_write_b128 v68, v[168:171]
    ds_write_b128 v69, v[172:175]
    ds_write_b128 v70, v[176:179]
    ds_write_b128 v71, v[180:183]
    ds_write_b128 v72, v[184:187]
    ds_write_b128 v73, v[188:191]
    ds_write_b128 v74, v[192:195]
    ds_write_b128 v75, v[196:199]
    ds_write_b128 v76, v[200:203]
    ds_write_b128 v77, v[204:207]
    ds_write_b128 v78, v[208:211]
    ds_write_b128 v79, v[212:215]
    ds_write_b128 v80, v[216:219]
    ds_write_b128 v81, v[220:223]
    ds_write_b128 v82, v[224:227]
    ds_write_b128 v83, v[228:231]
    ds_write_b128 v84, v[232:235]
    ds_write_b128 v85, v[236:239]
    s_waitcnt vmcnt(0) lgkmcnt(0)
    s_barrier
    s_cmp_lg_u32 s44, 0
    s_cbranch_scc1 Lfl_8
    v_mov_b32 v5, s49
    v_mov_b32 v6, 0
    v_cmp_eq_u32 vcc, 0, v0
    v_mov_b32 v7, 1073741824
    s_nop 0
    v_cndmask_b32 v6, v7, v6, vcc
    s_lshr_b32 s52, s45, 1
    s_lshl_b32 s52, s52, 2
    s_and_b32 s53, s46, 3
    s_add_u32 s52, s52, s53
    s_lshl_b32 s52, s52, 2
    s_lshl_b32 s53, s47, 8
    s_add_u32 s52, s52, s53
    s_add_u32 s52, s52, 10551296
    buffer_store_dword v5, v6, s[20:23], s52 offen sc1
Lfl_8:
    s_lshl_b32 s52, s44, 6
    v_add_u32 v5, s52, v0
    v_lshlrev_b32 v5, 4, v5
    v_add_u32 v6, 136448, v5
    v_add_u32 v7, 4096, v5
    v_cmp_gt_u32 vcc, 6720, v7
    v_mov_b32 v8, 1073741824
    s_nop 0
    v_cndmask_b32 v7, v8, v7, vcc
    v_add_u32 v9, 4096, v6
    v_cndmask_b32 v9, v6, v9, vcc
    ds_read_b128 v[16:19], v6 offset:0
    ds_read_b128 v[20:23], v6 offset:6720
    ds_read_b128 v[24:27], v6 offset:13440
    ds_read_b128 v[28:31], v6 offset:20160
    ds_read_b128 v[32:35], v9 offset:0
    ds_read_b128 v[36:39], v9 offset:6720
    ds_read_b128 v[40:43], v9 offset:13440
    ds_read_b128 v[44:47], v9 offset:20160
    s_lshl_b32 s52, s48, 4
    s_add_u32 s52, s52, s47
    s_mul_i32 s52, s52, 7168
    s_add_u32 s52, s52, 9502720
    s_waitcnt lgkmcnt(0)
    v_add_f32 v16, v16, v20
    v_add_f32 v24, v24, v28
    v_add_f32 v17, v17, v21
    v_add_f32 v25, v25, v29
    v_add_f32 v18, v18, v22
    v_add_f32 v26, v26, v30
    v_add_f32 v19, v19, v23
    v_add_f32 v27, v27, v31
    v_add_f32 v16, v16, v24
    v_add_f32 v17, v17, v25
    v_add_f32 v18, v18, v26
    v_add_f32 v19, v19, v27
    buffer_store_dwordx4 v[16:19], v5, s[20:23], s52 offen sc1
    v_add_f32 v32, v32, v36
    v_add_f32 v40, v40, v44
    v_add_f32 v33, v33, v37
    v_add_f32 v41, v41, v45
    v_add_f32 v34, v34, v38
    v_add_f32 v42, v42, v46
    v_add_f32 v35, v35, v39
    v_add_f32 v43, v43, v47
    v_add_f32 v32, v32, v40
    v_add_f32 v33, v33, v41
    v_add_f32 v34, v34, v42
    v_add_f32 v35, v35, v43
    buffer_store_dwordx4 v[32:35], v7, s[20:23], s52 offen sc1
    v_mov_b32 v5, 163344
    ds_read_b32 v5, v5
    s_waitcnt lgkmcnt(0)
    v_readfirstlane_b32 s49, v5
    s_mov_b32 s7, 0
    s_branch Lp2C
LcB:
    s_waitcnt lgkmcnt(0)
    s_mov_b32 s8, s64
    s_and_b32 s9, s65, 0xffff
    s_mov_b32 s10, 2621440
    s_mov_b32 s11, 0x00020000
    s_mov_b32 s12, s66
    s_and_b32 s13, s67, 0xffff
    s_mov_b32 s14, 2457600
    s_mov_b32 s15, 0x00020000
    s_mov_b32 s16, s72
    s_and_b32 s17, s73, 0xffff
    s_mov_b32 s18, 1966080
    s_mov_b32 s19, 0x00020000
    s_mov_b32 s20, s82
    s_and_b32 s21, s83, 0xffff
    s_mov_b32 s22, 15204352
    s_mov_b32 s23, 0x00020000
    s_mov_b32 s24, s76
    s_and_b32 s25, s77, 0xffff
    s_mov_b32 s26, 1280
    s_mov_b32 s27, 0x00020000
    s_mov_b32 s28, s74
    s_and_b32 s29, s75, 0xffff
    s_mov_b32 s30, 1966080
    s_mov_b32 s31, 0x00020000
    s_mov_b32 s32, s68
    s_and_b32 s33, s69, 0xffff
    s_mov_b32 s34, 819200
    s_mov_b32 s35, 0x00020000
    s_mov_b32 s36, s78
    s_and_b32 s37, s79, 0xffff
    s_mov_b32 s38, 2621440
    s_mov_b32 s39, 0x00020000
    s_or_b32 s50, s2, s44
    s_cmp_lg_u32 s50, 0
    s_cbranch_scc1 Lnn_9
    s_memrealtime s[50:51]
    s_waitcnt lgkmcnt(0)
    s_or_b32 s50, s50, 1
    v_mov_b32 v5, s50
    v_mov_b32 v6, 0
    global_store_dword v6, v5, s[80:81] sc1
Lnn_9:
    v_mov_b32 v66, 0
    v_mov_b32 v65, 0
    v_mov_b32 v5, 163348
    ds_write_b32 v5, v66
    ds_write_b32 v5, v66 offset:4
    ds_write_b32 v5, v66 offset:8
    v_and_b32 v1, 15, v0
    v_lshrrev_b32 v2, 4, v0
    v_bfe_u32 v3, v0, 2, 2
    v_and_b32 v4, 3, v0
    v_lshrrev_b32 v5, 1, v1
    v_xor_b32 v5, v2, v5
    v_lshlrev_b32 v5, 4, v5
    v_lshl_add_u32 v5, v1, 7, v5
    s_lshl_b32 s50, s44, 12
    v_add_u32 v48, s50, v5
    v_xor_b32 v49, 64, v48
    v_lshrrev_b32 v5, 1, v2
    v_lshlrev_b32 v5, 4, v5
    v_and_b32 v6, 1, v2
    v_lshl_add_u32 v5, v6, 2, v5
    v_add_u32 v5, v5, v3
    v_mul_u32_u24 v50, 160, v5
    v_lshl_add_u32 v50, v4, 3, v50
    v_lshrrev_b32 v7, 1, v3
    v_lshlrev_b32 v7, 1, v7
    v_lshl_add_u32 v7, v6, 2, v7
    v_lshrrev_b32 v8, 1, v4
    v_and_b32 v9, 1, v4
    v_lshlrev_b32 v9, 3, v9
    v_lshl_add_u32 v9, v5, 7, v9
    v_add_u32 v10, 0, v8
    v_xor_b32 v10, v10, v7
    v_lshl_add_u32 v51, v10, 4, v9
    v_add_u32 v10, 2, v8
    v_xor_b32 v10, v10, v7
    v_lshl_add_u32 v52, v10, 4, v9
    v_add_u32 v10, 4, v8
    v_xor_b32 v10, v10, v7
    v_lshl_add_u32 v53, v10, 4, v9
    v_add_u32 v10, 6, v8
    v_xor_b32 v10, v10, v7
    v_lshl_add_u32 v54, v10, 4, v9
    v_mov_b32 v56, v48
    v_mov_b32 v57, v49
    v_mov_b32 v58, v50
    v_mov_b32 v59, v51
    v_mov_b32 v60, v52
    v_mov_b32 v61, v53
    v_mov_b32 v62, v54
    v_lshlrev_b32 v63, 4, v2
    v_add_u32 v63, 135168, v63
    s_and_b32 s3, s46, 3
    s_mul_i32 s3, s3, 3
    s_lshr_b32 s4, s46, 2
    s_mul_i32 s4, s4, 1
    s_add_u32 s3, s3, s4
    s_cmp_ge_u32 s3, 10
    s_cselect_b32 s4, 10, 0
    s_sub_u32 s3, s3, s4
    s_cmp_ge_u32 s3, 10
    s_cselect_b32 s4, 10, 0
    s_sub_u32 s3, s3, s4
    s_lshl_b32 s5, s3, 7
    v_add_u32 v63, s5, v63
    s_mov_b32 s55, s3
    s_mov_b32 s50, 897988541
    v_mov_b32 v128, s50
    v_mov_b32 v129, s50
    v_mov_b32 v130, s50
    v_mov_b32 v131, s50
    v_mov_b32 v132, s50
    v_mov_b32 v133, s50
    v_mov_b32 v134, s50
    v_mov_b32 v135, s50
    v_mov_b32 v136, s50
    v_mov_b32 v137, s50
    v_mov_b32 v138, s50
    v_mov_b32 v139, s50
    v_mov_b32 v140, s50
    v_mov_b32 v141, s50
    v_mov_b32 v142, s50
    v_mov_b32 v143, s50
    v_mov_b32 v144, s50
    v_mov_b32 v145, s50
    v_mov_b32 v146, s50
    v_mov_b32 v147, s50
    v_mov_b32 v148, s50
    v_mov_b32 v149, s50
    v_mov_b32 v150, s50
    v_mov_b32 v151, s50
    v_mov_b32 v152, s50
    v_mov_b32 v153, s50
    v_mov_b32 v154, s50
    v_mov_b32 v155, s50
    v_mov_b32 v156, s50
    v_mov_b32 v157, s50
    v_mov_b32 v158, s50
    v_mov_b32 v159, s50
    v_mov_b32 v160, s50
    v_mov_b32 v161, s50
    v_mov_b32 v162, s50
    v_mov_b32 v163, s50
    v_mov_b32 v164, s50
    v_mov_b32 v165, s50
    v_mov_b32 v166, s50
    v_mov_b32 v167, s50
    v_mov_b32 v168, 0
    v_mov_b32 v169, 0
    v_mov_b32 v170, 0
    v_mov_b32 v171, 0
    v_mov_b32 v172, 0
    v_mov_b32 v173, 0
    v_mov_b32 v174, 0
    v_mov_b32 v175, 0
    v_mov_b32 v176, 0
    v_mov_b32 v177, 0
    v_mov_b32 v178, 0
    v_mov_b32 v179, 0
    v_mov_b32 v180, 0
    v_mov_b32 v181, 0
    v_mov_b32 v182, 0
    v_mov_b32 v183, 0
    v_mov_b32 v184, 0
    v_mov_b32 v185, 0
    v_mov_b32 v186, 0
    v_mov_b32 v187, 0
    v_mov_b32 v188, 0
    v_mov_b32 v189, 0
    v_mov_b32 v190, 0
    v_mov_b32 v191, 0
    v_mov_b32 v192, 0
    v_mov_b32 v193, 0
    v_mov_b32 v194, 0
    v_mov_b32 v195, 0
    v_mov_b32 v196, 0
    v_mov_b32 v197, 0
    v_mov_b32 v198, 0
    v_mov_b32 v199, 0
    v_mov_b32 v200, 0
    v_mov_b32 v201, 0
    v_mov_b32 v202, 0
    v_mov_b32 v203, 0
    v_mov_b32 v204, 0
    v_mov_b32 v205, 0
    v_mov_b32 v206, 0
    v_mov_b32 v207, 0
    v_mov_b32 v208, 0
    v_mov_b32 v209, 0
    v_mov_b32 v210, 0
    v_mov_b32 v211, 0
    v_mov_b32 v212, 0
    v_mov_b32 v213, 0
    v_mov_b32 v214, 0
    v_mov_b32 v215, 0
    v_mov_b32 v216, 0
    v_mov_b32 v217, 0
    v_mov_b32 v218, 0
    v_mov_b32 v219, 0
    v_mov_b32 v220, 0
    v_mov_b32 v221, 0
    v_mov_b32 v222, 0
    v_mov_b32 v223, 0
    v_mov_b32 v224, 0
    v_mov_b32 v225, 0
    v_mov_b32 v226, 0
    v_mov_b32 v227, 0
    v_mov_b32 v228, 0
    v_mov_b32 v229, 0
    v_mov_b32 v230, 0
    v_mov_b32 v231, 0
    v_mov_b32 v232, 0
    v_mov_b32 v233, 0
    v_mov_b32 v234, 0
    v_mov_b32 v235, 0
    v_mov_b32 v236, 0
    v_mov_b32 v237, 0
    v_mov_b32 v238, 0
    v_mov_b32 v239, 0
    s_mov_b32 s50, 0
    s_mov_b32 s51, 0
    s_barrier
    ds_read_b128 v[16:19], v56 offset:0
    ds_read_b128 v[20:23], v56 offset:2048
    ds_read_b64_tr_b16 v[86:87], v58 offset:16384
    ds_read_b64_tr_b16 v[88:89], v58 offset:17664
    ds_read_b64_tr_b16 v[90:91], v58 offset:16416
    ds_read_b64_tr_b16 v[92:93], v58 offset:17696
    ds_read_b64_tr_b16 v[94:95], v58 offset:16448
    ds_read_b64_tr_b16 v[96:97], v58 offset:17728
    ds_read_b64_tr_b16 v[98:99], v58 offset:16480
    ds_read_b64_tr_b16 v[100:101], v58 offset:17760
    ds_read_b64_tr_b16 v[102:103], v58 offset:16512
    ds_read_b64_tr_b16 v[104:105], v58 offset:17792
    ds_read_b64_tr_b16 v[106:107], v59 offset:28672
    ds_read_b64_tr_b16 v[108:109], v59 offset:29696
Lp1_10:
    s_waitcnt lgkmcnt(12)
    s_waitcnt lgkmcnt(10)
    v_mfma_f32_16x16x32_bf16 v[128:131], v[86:89], v[16:19], v[128:131]
    ds_read_b64_tr_b16 v[110:111], v60 offset:28672
    v_mfma_f32_16x16x32_bf16 v[132:135], v[86:89], v[20:23], v[132:135]
    ds_read_b64_tr_b16 v[112:113], v60 offset:29696
    s_waitcnt lgkmcnt(10)
    v_mfma_f32_16x16x32_bf16 v[136:139], v[90:93], v[16:19], v[136:139]
    ds_read_b64_tr_b16 v[86:87], v61 offset:28672
    v_mfma_f32_16x16x32_bf16 v[140:143], v[90:93], v[20:23], v[140:143]
    ds_read_b64_tr_b16 v[88:89], v61 offset:29696
    s_waitcnt lgkmcnt(10)
    v_mfma_f32_16x16x32_bf16 v[144:147], v[94:97], v[16:19], v[144:147]
    ds_read_b64_tr_b16 v[90:91], v62 offset:28672
    v_mfma_f32_16x16x32_bf16 v[148:151], v[94:97], v[20:23], v[148:151]
    ds_read_b64_tr_b16 v[92:93], v62 offset:29696
    s_waitcnt lgkmcnt(10)
    v_mfma_f32_16x16x32_bf16 v[152:155], v[98:101], v[16:19], v[152:155]
    ds_read_b64_tr_b16 v[94:95], v59 offset:36864
    v_mfma_f32_16x16x32_bf16 v[156:159], v[98:101], v[20:23], v[156:159]
    ds_read_b64_tr_b16 v[96:97], v59 offset:37888
    s_waitcnt lgkmcnt(10)
    v_mfma_f32_16x16x32_bf16 v[160:163], v[102:105], v[16:19], v[160:163]
    ds_read_b64_tr_b16 v[98:99], v60 offset:36864
    v_mfma_f32_16x16x32_bf16 v[164:167], v[102:105], v[20:23], v[164:167]
    ds_read_b64_tr_b16 v[100:101], v60 offset:37888
    s_waitcnt lgkmcnt(10)
    v_mfma_f32_16x16x32_bf16 v[168:171], v[106:109], v[16:19], v[168:171]
    ds_read_b64_tr_b16 v[102:103], v61 offset:36864
    v_mfma_f32_16x16x32_bf16 v[172:175], v[106:109], v[20:23], v[172:175]
    ds_read_b64_tr_b16 v[104:105], v61 offset:37888
    s_waitcnt lgkmcnt(10)
    v_mfma_f32_16x16x32_bf16 v[176:179], v[110:113], v[16:19], v[176:179]
    ds_read_b64_tr_b16 v[106:107], v62 offset:36864
    v_mfma_f32_16x16x32_bf16 v[180:183], v[110:113], v[20:23], v[180:183]
    ds_read_b64_tr_b16 v[108:109], v62 offset:37888
    ds_read_b128 v[24:27], v57 offset:0
    ds_read_b128 v[28:31], v57 offset:2048
    s_waitcnt lgkmcnt(12)
    v_mfma_f32_16x16x32_bf16 v[184:187], v[86:89], v[16:19], v[184:187]
    ds_read_b128 v[110:113], v63 offset:0
    v_mfma_f32_16x16x32_bf16 v[188:191], v[86:89], v[20:23], v[188:191]
    s_waitcnt lgkmcnt(11)
    v_mfma_f32_16x16x32_bf16 v[192:195], v[90:93], v[16:19], v[192:195]
    ds_read_b64_tr_b16 v[86:87], v58 offset:21504
    v_mfma_f32_16x16x32_bf16 v[196:199], v[90:93], v[20:23], v[196:199]
    ds_read_b64_tr_b16 v[88:89], v58 offset:22784
    s_waitcnt lgkmcnt(11)
    v_mfma_f32_16x16x32_bf16 v[200:203], v[94:97], v[16:19], v[200:203]
    ds_read_b64_tr_b16 v[90:91], v58 offset:21536
    v_mfma_f32_16x16x32_bf16 v[204:207], v[94:97], v[20:23], v[204:207]
    ds_read_b64_tr_b16 v[92:93], v58 offset:22816
    s_waitcnt lgkmcnt(11)
    v_mfma_f32_16x16x32_bf16 v[208:211], v[98:101], v[16:19], v[208:211]
    ds_read_b64_tr_b16 v[94:95], v58 offset:21568
    v_mfma_f32_16x16x32_bf16 v[212:215], v[98:101], v[20:23], v[212:215]
    ds_read_b64_tr_b16 v[96:97], v58 offset:22848
    s_waitcnt lgkmcnt(11)
    v_mfma_f32_16x16x32_bf16 v[216:219], v[102:105], v[16:19], v[216:219]
    ds_read_b64_tr_b16 v[98:99], v58 offset:21600
    v_mfma_f32_16x16x32_bf16 v[220:223], v[102:105], v[20:23], v[220:223]
    ds_read_b64_tr_b16 v[100:101], v58 offset:22880
    s_waitcnt lgkmcnt(11)
    v_mfma_f32_16x16x32_bf16 v[224:227], v[106:109], v[16:19], v[224:227]
    ds_read_b64_tr_b16 v[102:103], v58 offset:21632
    v_mfma_f32_16x16x32_bf16 v[228:231], v[106:109], v[20:23], v[228:231]
    ds_read_b64_tr_b16 v[104:105], v58 offset:22912
    s_waitcnt lgkmcnt(10)
    v_mfma_f32_16x16x32_bf16 v[232:235], v[110:113], v[16:19], v[232:235]
    ds_read_b64_tr_b16 v[106:107], v59 offset:32768
    v_mfma_f32_16x16x32_bf16 v[236:239], v[110:113], v[20:23], v[236:239]
    ds_read_b64_tr_b16 v[108:109], v59 offset:33792
    s_waitcnt lgkmcnt(10)
    v_mfma_f32_16x16x32_bf16 v[128:131], v[86:89], v[24:27], v[128:131]
    ds_read_b64_tr_b16 v[110:111], v60 offset:32768
    v_mfma_f32_16x16x32_bf16 v[132:135], v[86:89], v[28:31], v[132:135]
    ds_read_b64_tr_b16 v[112:113], v60 offset:33792
    s_waitcnt lgkmcnt(10)
    v_mfma_f32_16x16x32_bf16 v[136:139], v[90:93], v[24:27], v[136:139]
    ds_read_b64_tr_b16 v[86:87], v61 offset:32768
    v_mfma_f32_16x16x32_bf16 v[140:143], v[90:93], v[28:31], v[140:143]
    ds_read_b64_tr_b16 v[88:89], v61 offset:33792
    s_waitcnt lgkmcnt(10)
    v_mfma_f32_16x16x32_bf16 v[144:147], v[94:97], v[24:27], v[144:147]
    ds_read_b64_tr_b16 v[90:91], v62 offset:32768
    v_mfma_f32_16x16x32_bf16 v[148:151], v[94:97], v[28:31], v[148:151]
    ds_read_b64_tr_b16 v[92:93], v62 offset:33792
    s_waitcnt lgkmcnt(10)
    v_mfma_f32_16x16x32_bf16 v[152:155], v[98:101], v[24:27], v[152:155]
    ds_read_b64_tr_b16 v[94:95], v59 offset:40960
    v_mfma_f32_16x16x32_bf16 v[156:159], v[98:101], v[28:31], v[156:159]
    ds_read_b64_tr_b16 v[96:97], v59 offset:41984
    s_waitcnt lgkmcnt(10)
    v_mfma_f32_16x16x32_bf16 v[160:163], v[102:105], v[24:27], v[160:163]
    ds_read_b64_tr_b16 v[98:99], v60 offset:40960
    v_mfma_f32_16x16x32_bf16 v[164:167], v[102:105], v[28:31], v[164:167]
    ds_read_b64_tr_b16 v[100:101], v60 offset:41984
    s_waitcnt lgkmcnt(10)
    v_mfma_f32_16x16x32_bf16 v[168:171], v[106:109], v[24:27], v[168:171]
    ds_read_b64_tr_b16 v[102:103], v61 offset:40960
    v_mfma_f32_16x16x32_bf16 v[172:175], v[106:109], v[28:31], v[172:175]
    ds_read_b64_tr_b16 v[104:105], v61 offset:41984
    s_waitcnt lgkmcnt(10)
    v_mfma_f32_16x16x32_bf16 v[176:179], v[110:113], v[24:27], v[176:179]
    ds_read_b64_tr_b16 v[106:107], v62 offset:40960
    v_mfma_f32_16x16x32_bf16 v[180:183], v[110:113], v[28:31], v[180:183]
    ds_read_b64_tr_b16 v[108:109], v62 offset:41984
    s_waitcnt lgkmcnt(10)
    v_mfma_f32_16x16x32_bf16 v[184:187], v[86:89], v[24:27], v[184:187]
    ds_read_b128 v[110:113], v63 offset:64
    v_mfma_f32_16x16x32_bf16 v[188:191], v[86:89], v[28:31], v[188:191]
    s_add_u32 s50, s50, 1
    s_cmp_eq_u32 s50, 10
    s_cbranch_scc1 Lp1last_11
    s_waitcnt lgkmcnt(9)
    v_mfma_f32_16x16x32_bf16 v[192:195], v[90:93], v[24:27], v[192:195]
    s_add_u32 s51, s51, 45056
    s_cmp_ge_u32 s51, 135168
    s_cselect_b32 s52, 135168, 0
    s_sub_u32 s51, s51, s52
    v_add_u32 v56, s51, v48
    v_add_u32 v57, s51, v49
    v_mfma_f32_16x16x32_bf16 v[196:199], v[90:93], v[28:31], v[196:199]
    v_add_u32 v58, s51, v50
    v_add_u32 v59, s51, v51
    v_add_u32 v60, s51, v52
    s_waitcnt lgkmcnt(7)
    v_mfma_f32_16x16x32_bf16 v[200:203], v[94:97], v[24:27], v[200:203]
    v_add_u32 v61, s51, v53
    v_add_u32 v62, s51, v54
    v_add_u32 v63, 128, v63
    v_mfma_f32_16x16x32_bf16 v[204:207], v[94:97], v[28:31], v[204:207]
    s_add_u32 s55, s55, 1
    s_cmp_eq_u32 s55, 10
    s_cselect_b32 s52, 1280, 0
    s_cselect_b32 s55, 0, s55
    v_subrev_u32 v63, s52, v63
    s_lshl_b32 s53, s44, 4
    s_add_u32 s53, s53, s50
    s_cmp_lg_u32 s53, 6
    s_cbranch_scc1 Lx_12
    v_mov_b32 v66, 0
    global_load_dword v65, v66, s[80:81] sc1
Lx_12:
    s_waitcnt lgkmcnt(0)
    s_barrier
    ds_read_b128 v[16:19], v56 offset:0
    ds_read_b128 v[20:23], v56 offset:2048
    v_mfma_f32_16x16x32_bf16 v[208:211], v[98:101], v[24:27], v[208:211]
    ds_read_b64_tr_b16 v[86:87], v58 offset:16384
    ds_read_b64_tr_b16 v[88:89], v58 offset:17664
    v_mfma_f32_16x16x32_bf16 v[212:215], v[98:101], v[28:31], v[212:215]
    ds_read_b64_tr_b16 v[90:91], v58 offset:16416
    ds_read_b64_tr_b16 v[92:93], v58 offset:17696
    v_mfma_f32_16x16x32_bf16 v[216:219], v[102:105], v[24:27], v[216:219]
    ds_read_b64_tr_b16 v[94:95], v58 offset:16448
    ds_read_b64_tr_b16 v[96:97], v58 offset:17728
    v_mfma_f32_16x16x32_bf16 v[220:223], v[102:105], v[28:31], v[220:223]
    ds_read_b64_tr_b16 v[98:99], v58 offset:16480
    ds_read_b64_tr_b16 v[100:101], v58 offset:17760
    v_mfma_f32_16x16x32_bf16 v[224:227], v[106:109], v[24:27], v[224:227]
    ds_read_b64_tr_b16 v[102:103], v58 offset:16512
    v_mfma_f32_16x16x32_bf16 v[228:231], v[106:109], v[28:31], v[228:231]
    ds_read_b64_tr_b16 v[104:105], v58 offset:17792
    v_mfma_f32_16x16x32_bf16 v[232:235], v[110:113], v[24:27], v[232:235]
    ds_read_b64_tr_b16 v[106:107], v59 offset:28672
    v_mfma_f32_16x16x32_bf16 v[236:239], v[110:113], v[28:31], v[236:239]
    ds_read_b64_tr_b16 v[108:109], v59 offset:29696
    s_branch Lp1_10
Lp1last_11:
    s_waitcnt lgkmcnt(0)
    v_mfma_f32_16x16x32_bf16 v[192:195], v[90:93], v[24:27], v[192:195]
    v_mfma_f32_16x16x32_bf16 v[196:199], v[90:93], v[28:31], v[196:199]
    v_mfma_f32_16x16x32_bf16 v[200:203], v[94:97], v[24:27], v[200:203]
    v_mfma_f32_16x16x32_bf16 v[204:207], v[94:97], v[28:31], v[204:207]
    v_mfma_f32_16x16x32_bf16 v[208:211], v[98:101], v[24:27], v[208:211]
    v_mfma_f32_16x16x32_bf16 v[212:215], v[98:101], v[28:31], v[212:215]
    v_mfma_f32_16x16x32_bf16 v[216:219], v[102:105], v[24:27], v[216:219]
    v_mfma_f32_16x16x32_bf16 v[220:223], v[102:105], v[28:31], v[220:223]
    v_mfma_f32_16x16x32_bf16 v[224:227], v[106:109], v[24:27], v[224:227]
    v_mfma_f32_16x16x32_bf16 v[228:231], v[106:109], v[28:31], v[228:231]
    v_mfma_f32_16x16x32_bf16 v[232:235], v[110:113], v[24:27], v[232:235]
    v_mfma_f32_16x16x32_bf16 v[236:239], v[110:113], v[28:31], v[236:239]
    s_mov_b32 s50, 897988541
    s_mov_b32 s51, 1069066811
    s_lshl_b32 s52, s48, 2
    s_add_u32 s52, s52, 16
    s_lshl_b32 s53, s47, 3
    s_lshl_b32 s54, s44, 1
    s_add_u32 s53, s53, s54
    s_mul_i32 s53, s53, 48
    s_add_u32 s53, s53, s52
    s_lshl_b32 s53, s53, 10
    v_lshlrev_b32 v1, 4, v0
    v_cvt_pk_bf16_f32 v16, v168, v169
    v_cvt_pk_bf16_f32 v17, v170, v171
    v_cvt_pk_bf16_f32 v18, v176, v177
    v_cvt_pk_bf16_f32 v19, v178, v179
    v_pk_max_i16 v16, v16, 0
    v_pk_max_i16 v17, v17, 0
    v_pk_max_i16 v18, v18, 0
    v_pk_max_i16 v19, v19, 0
    s_add_u32 s54, s53, 0
    buffer_store_dwordx4 v[16:19], v1, s[20:23], s54 offen sc1
    v_cvt_pk_bf16_f32 v20, v172, v173
    v_cvt_pk_bf16_f32 v21, v174, v175
    v_cvt_pk_bf16_f32 v22, v180, v181
    v_cvt_pk_bf16_f32 v23, v182, v183
    v_pk_max_i16 v20, v20, 0
    v_pk_max_i16 v21, v21, 0
    v_pk_max_i16 v22, v22, 0
    v_pk_max_i16 v23, v23, 0
    s_add_u32 s54, s53, 49152
    buffer_store_dwordx4 v[20:23], v1, s[20:23], s54 offen sc1
    v_cvt_pk_bf16_f32 v24, v184, v185
    v_cvt_pk_bf16_f32 v25, v186, v187
    v_cvt_pk_bf16_f32 v26, v192, v193
    v_cvt_pk_bf16_f32 v27, v194, v195
    v_pk_max_i16 v24, v24, 0
    v_pk_max_i16 v25, v25, 0
    v_pk_max_i16 v26, v26, 0
    v_pk_max_i16 v27, v27, 0
    s_add_u32 s54, s53, 1024
    buffer_store_dwordx4 v[24:27], v1, s[20:23], s54 offen sc1
    v_cvt_pk_bf16_f32 v28, v188, v189
    v_cvt_pk_bf16_f32 v29, v190, v191
    v_cvt_pk_bf16_f32 v30, v196, v197
    v_cvt_pk_bf16_f32 v31, v198, v199
    v_pk_max_i16 v28, v28, 0
    v_pk_max_i16 v29, v29, 0
    v_pk_max_i16 v30, v30, 0
    v_pk_max_i16 v31, v31, 0
    s_add_u32 s54, s53, 50176
    buffer_store_dwordx4 v[28:31], v1, s[20:23], s54 offen sc1
    v_cvt_pk_bf16_f32 v16, v200, v201
    v_cvt_pk_bf16_f32 v17, v202, v203
    v_cvt_pk_bf16_f32 v18, v208, v209
    v_cvt_pk_bf16_f32 v19, v210, v211
    v_pk_max_i16 v16, v16, 0
    v_pk_max_i16 v17, v17, 0
    v_pk_max_i16 v18, v18, 0
    v_pk_max_i16 v19, v19, 0
    s_add_u32 s54, s53, 2048
    buffer_store_dwordx4 v[16:19], v1, s[20:23], s54 offen sc1
    v_cvt_pk_bf16_f32 v20, v204, v205
    v_cvt_pk_bf16_f32 v21, v206, v207
    v_cvt_pk_bf16_f32 v22, v212, v213
    v_cvt_pk_bf16_f32 v23, v214, v215
    v_pk_max_i16 v20, v20, 0
    v_pk_max_i16 v21, v21, 0
    v_pk_max_i16 v22, v22, 0
    v_pk_max_i16 v23, v23, 0
    s_add_u32 s54, s53, 51200
    buffer_store_dwordx4 v[20:23], v1, s[20:23], s54 offen sc1
    v_cvt_pk_bf16_f32 v24, v216, v217
    v_cvt_pk_bf16_f32 v25, v218, v219
    v_cvt_pk_bf16_f32 v26, v224, v225
    v_cvt_pk_bf16_f32 v27, v226, v227
    v_pk_max_i16 v24, v24, 0
    v_pk_max_i16 v25, v25, 0
    v_pk_max_i16 v26, v26, 0
    v_pk_max_i16 v27, v27, 0
    s_add_u32 s54, s53, 3072
    buffer_store_dwordx4 v[24:27], v1, s[20:23], s54 offen sc1
    v_cvt_pk_bf16_f32 v28, v220, v221
    v_cvt_pk_bf16_f32 v29, v222, v223
    v_cvt_pk_bf16_f32 v30, v228, v229
    v_cvt_pk_bf16_f32 v31, v230, v231
    v_pk_max_i16 v28, v28, 0
    v_pk_max_i16 v29, v29, 0
    v_pk_max_i16 v30, v30, 0
    v_pk_max_i16 v31, v31, 0
    s_add_u32 s54, s53, 52224
    buffer_store_dwordx4 v[28:31], v1, s[20:23], s54 offen sc1
    v_mul_f32 v2, s51, v232
    v_exp_f32_e64 v2, -v2
    s_nop 0
    v_add_f32 v2, 1.0, v2
    v_rcp_f32 v196, v2
    v_mul_f32 v2, s51, v236
    v_exp_f32_e64 v2, -v2
    s_nop 0
    v_add_f32 v2, 1.0, v2
    v_rcp_f32 v197, v2
    s_cmp_lg_u32 s48, 0
    s_cbranch_scc1 Lng_13
    v_and_b32 v1, 15, v0
    v_lshlrev_b32 v1, 2, v1
    v_cmp_gt_u32 vcc, 16, v0
    v_mov_b32 v6, 1073741824
    s_nop 0
    v_cndmask_b32 v1, v6, v1, vcc
    s_lshl_b32 s52, s47, 7
    s_lshl_b32 s53, s44, 5
    s_add_u32 s52, s52, s53
    s_lshl_b32 s52, s52, 2
    s_add_u32 s52, s52, 9437184
    s_add_u32 s53, s52, 0
    buffer_store_dword v196, v1, s[20:23], s53 offen sc1
    s_add_u32 s53, s52, 64
    buffer_store_dword v197, v1, s[20:23], s53 offen sc1
Lng_13:
    v_mul_f32 v2, s51, v128
    v_exp_f32_e64 v2, v2 clamp
    v_max_f32 v128, s50, v128
    v_add_f32 v128, v128, v2
    v_mul_f32 v3, s51, v129
    v_exp_f32_e64 v3, v3 clamp
    v_max_f32 v129, s50, v129
    v_add_f32 v129, v129, v3
    v_mul_f32 v4, s51, v130
    v_exp_f32_e64 v4, v4 clamp
    v_max_f32 v130, s50, v130
    v_add_f32 v130, v130, v4
    v_mul_f32 v5, s51, v131
    v_exp_f32_e64 v5, v5 clamp
    v_max_f32 v131, s50, v131
    v_add_f32 v131, v131, v5
    v_cvt_pk_bf16_f32 v176, v128, v129
    v_cvt_pk_bf16_f32 v177, v130, v131
    v_mul_f32 v2, s51, v132
    v_exp_f32_e64 v2, v2 clamp
    v_max_f32 v132, s50, v132
    v_add_f32 v132, v132, v2
    v_mul_f32 v3, s51, v133
    v_exp_f32_e64 v3, v3 clamp
    v_max_f32 v133, s50, v133
    v_add_f32 v133, v133, v3
    v_mul_f32 v4, s51, v134
    v_exp_f32_e64 v4, v4 clamp
    v_max_f32 v134, s50, v134
    v_add_f32 v134, v134, v4
    v_mul_f32 v5, s51, v135
    v_exp_f32_e64 v5, v5 clamp
    v_max_f32 v135, s50, v135
    v_add_f32 v135, v135, v5
    v_cvt_pk_bf16_f32 v186, v132, v133
    v_cvt_pk_bf16_f32 v187, v134, v135
    v_mul_f32 v2, s51, v136
    v_exp_f32_e64 v2, v2 clamp
    v_max_f32 v136, s50, v136
    v_add_f32 v136, v136, v2
    v_mul_f32 v3, s51, v137
    v_exp_f32_e64 v3, v3 clamp
    v_max_f32 v137, s50, v137
    v_add_f32 v137, v137, v3
    v_mul_f32 v4, s51, v138
    v_exp_f32_e64 v4, v4 clamp
    v_max_f32 v138, s50, v138
    v_add_f32 v138, v138, v4
    v_mul_f32 v5, s51, v139
    v_exp_f32_e64 v5, v5 clamp
    v_max_f32 v139, s50, v139
    v_add_f32 v139, v139, v5
    v_cvt_pk_bf16_f32 v178, v136, v137
    v_cvt_pk_bf16_f32 v179, v138, v139
    v_mul_f32 v2, s51, v140
    v_exp_f32_e64 v2, v2 clamp
    v_max_f32 v140, s50, v140
    v_add_f32 v140, v140, v2
    v_mul_f32 v3, s51, v141
    v_exp_f32_e64 v3, v3 clamp
    v_max_f32 v141, s50, v141
    v_add_f32 v141, v141, v3
    v_mul_f32 v4, s51, v142
    v_exp_f32_e64 v4, v4 clamp
    v_max_f32 v142, s50, v142
    v_add_f32 v142, v142, v4
    v_mul_f32 v5, s51, v143
    v_exp_f32_e64 v5, v5 clamp
    v_max_f32 v143, s50, v143
    v_add_f32 v143, v143, v5
    v_cvt_pk_bf16_f32 v188, v140, v141
    v_cvt_pk_bf16_f32 v189, v142, v143
    v_mul_f32 v2, s51, v144
    v_exp_f32_e64 v2, v2 clamp
    v_max_f32 v144, s50, v144
    v_add_f32 v144, v144, v2
    v_mul_f32 v3, s51, v145
    v_exp_f32_e64 v3, v3 clamp
    v_max_f32 v145, s50, v145
    v_add_f32 v145, v145, v3
    v_mul_f32 v4, s51, v146
    v_exp_f32_e64 v4, v4 clamp
    v_max_f32 v146, s50, v146
    v_add_f32 v146, v146, v4
    v_mul_f32 v5, s51, v147
    v_exp_f32_e64 v5, v5 clamp
    v_max_f32 v147, s50, v147
    v_add_f32 v147, v147, v5
    v_cvt_pk_bf16_f32 v180, v144, v145
    v_cvt_pk_bf16_f32 v181, v146, v147
    v_mul_f32 v2, s51, v148
    v_exp_f32_e64 v2, v2 clamp
    v_max_f32 v148, s50, v148
    v_add_f32 v148, v148, v2
    v_mul_f32 v3, s51, v149
    v_exp_f32_e64 v3, v3 clamp
    v_max_f32 v149, s50, v149
    v_add_f32 v149, v149, v3
    v_mul_f32 v4, s51, v150
    v_exp_f32_e64 v4, v4 clamp
    v_max_f32 v150, s50, v150
    v_add_f32 v150, v150, v4
    v_mul_f32 v5, s51, v151
    v_exp_f32_e64 v5, v5 clamp
    v_max_f32 v151, s50, v151
    v_add_f32 v151, v151, v5
    v_cvt_pk_bf16_f32 v190, v148, v149
    v_cvt_pk_bf16_f32 v191, v150, v151
    v_mul_f32 v2, s51, v152
    v_exp_f32_e64 v2, v2 clamp
    v_max_f32 v152, s50, v152
    v_add_f32 v152, v152, v2
    v_mul_f32 v3, s51, v153
    v_exp_f32_e64 v3, v3 clamp
    v_max_f32 v153, s50, v153
    v_add_f32 v153, v153, v3
    v_mul_f32 v4, s51, v154
    v_exp_f32_e64 v4, v4 clamp
    v_max_f32 v154, s50, v154
    v_add_f32 v154, v154, v4
    v_mul_f32 v5, s51, v155
    v_exp_f32_e64 v5, v5 clamp
    v_max_f32 v155, s50, v155
    v_add_f32 v155, v155, v5
    v_cvt_pk_bf16_f32 v182, v152, v153
    v_cvt_pk_bf16_f32 v183, v154, v155
    v_mul_f32 v2, s51, v156
    v_exp_f32_e64 v2, v2 clamp
    v_max_f32 v156, s50, v156
    v_add_f32 v156, v156, v2
    v_mul_f32 v3, s51, v157
    v_exp_f32_e64 v3, v3 clamp
    v_max_f32 v157, s50, v157
    v_add_f32 v157, v157, v3
    v_mul_f32 v4, s51, v158
    v_exp_f32_e64 v4, v4 clamp
    v_max_f32 v158, s50, v158
    v_add_f32 v158, v158, v4
    v_mul_f32 v5, s51, v159
    v_exp_f32_e64 v5, v5 clamp
    v_max_f32 v159, s50, v159
    v_add_f32 v159, v159, v5
    v_cvt_pk_bf16_f32 v192, v156, v157
    v_cvt_pk_bf16_f32 v193, v158, v159
    v_mul_f32 v2, s51, v160
    v_exp_f32_e64 v2, v2 clamp
    v_max_f32 v160, s50, v160
    v_add_f32 v160, v160, v2
    v_mul_f32 v3, s51, v161
    v_exp_f32_e64 v3, v3 clamp
    v_max_f32 v161, s50, v161
    v_add_f32 v161, v161, v3
    v_mul_f32 v4, s51, v162
    v_exp_f32_e64 v4, v4 clamp
    v_max_f32 v162, s50, v162
    v_add_f32 v162, v162, v4
    v_mul_f32 v5, s51, v163
    v_exp_f32_e64 v5, v5 clamp
    v_max_f32 v163, s50, v163
    v_add_f32 v163, v163, v5
    v_cvt_pk_bf16_f32 v184, v160, v161
    v_cvt_pk_bf16_f32 v185, v162, v163
    v_mul_f32 v2, s51, v164
    v_exp_f32_e64 v2, v2 clamp
    v_max_f32 v164, s50, v164
    v_add_f32 v164, v164, v2
    v_mul_f32 v3, s51, v165
    v_exp_f32_e64 v3, v3 clamp
    v_max_f32 v165, s50, v165
    v_add_f32 v165, v165, v3
    v_mul_f32 v4, s51, v166
    v_exp_f32_e64 v4, v4 clamp
    v_max_f32 v166, s50, v166
    v_add_f32 v166, v166, v4
    v_mul_f32 v5, s51, v167
    v_exp_f32_e64 v5, v5 clamp
    v_max_f32 v167, s50, v167
    v_add_f32 v167, v167, v5
    v_cvt_pk_bf16_f32 v194, v164, v165
    v_cvt_pk_bf16_f32 v195, v166, v167
    s_cmp_lg_u32 s44, 0
    s_cbranch_scc1 Lnz_14
    s_mov_b32 s52, 0
    s_waitcnt vmcnt(0)
Lnzl_15:
    v_readfirstlane_b32 s49, v65
    s_nop 1
    s_cmp_lg_u32 s49, 0
    s_cbranch_scc1 Lnzok_16
    global_load_dword v65, v66, s[80:81] sc1
    s_add_u32 s52, s52, 1
    s_cmp_lt_u32 s52, 40000
    s_waitcnt vmcnt(0)
    s_cbranch_scc1 Lnzl_15
Lnzok_16:
    v_mov_b32 v66, 163344
    ds_write_b32 v66, v65
Lnz_14:
    s_waitcnt vmcnt(0) lgkmcnt(0)
    s_barrier
    s_cmp_lg_u32 s44, 0
    s_cbranch_scc1 Lfl_17
    v_mov_b32 v5, s49
    v_mov_b32 v6, 0
    v_cmp_eq_u32 vcc, 0, v0
    v_mov_b32 v7, 1073741824
    s_nop 0
    v_cndmask_b32 v6, v7, v6, vcc
    s_lshr_b32 s52, s45, 1
    s_lshl_b32 s52, s52, 2
    s_and_b32 s53, s46, 3
    s_add_u32 s52, s52, s53
    s_lshl_b32 s52, s52, 2
    s_lshl_b32 s53, s47, 8
    s_add_u32 s52, s52, s53
    s_add_u32 s52, s52, 10551296
    buffer_store_dword v5, v6, s[20:23], s52 offen sc1
Lfl_17:
    v_mov_b32 v5, 163344
    ds_read_b32 v5, v5
    s_waitcnt lgkmcnt(0)
    v_readfirstlane_b32 s49, v5
Lp2C:
    s_cmp_ge_u32 s46, 30
    s_cbranch_scc1 LredC
    s_mul_i32 s50, s46, 86
    s_lshr_b32 s50, s50, 8
    s_mul_i32 s51, s50, 3
    s_sub_u32 s51, s46, s51
    s_mul_i32 s52, s51, 5
    s_lshl_b32 s56, s45, 4
    s_add_u32 s52, s52, s56
    s_and_b32 s53, s44, 3
    s_lshr_b32 s54, s44, 2
    s_mul_i32 s55, s54, 3
    s_add_u32 s55, s55, s52
    v_lshrrev_b32 v5, 3, v0
    v_and_b32 v6, 7, v0
    v_lshrrev_b32 v2, 4, v0
    v_lshlrev_b32 v7, 1, v2
    v_xor_b32 v7, v6, v7
    v_mul_u32_u24 v8, 1280, v5
    s_lshl_b32 s56, s50, 7
    v_add_u32 v8, s56, v8
    v_lshl_add_u32 v78, v7, 4, v8
    s_mul_i32 s57, s53, 491520
    s_add_u32 s63, s57, 491520
    s_mul_i32 s56, s50, 40960
    s_add_u32 s57, s57, s56
    s_lshl_b32 s58, s53, 12
    s_mul_i32 s59, s53, 204800
    s_mul_i32 s60, s53, 20480
    s_add_u32 s60, s60, 45056
    s_add_u32 s57, s57, 286720
    s_cmp_ge_u32 s57, s63
    s_cselect_b32 s56, 491520, 0
    s_sub_u32 s57, s57, s56
    v_and_b32 v1, 15, v0
    v_lshrrev_b32 v2, 4, v0
    v_bfe_u32 v3, v0, 2, 2
    v_and_b32 v4, 3, v0
    v_lshlrev_b32 v100, 4, v0
    v_mov_b32 v5, 1073741824
    v_cmp_gt_u32 vcc, 48, v0
    s_nop 1
    v_cndmask_b32 v79, v5, v100, vcc
    v_lshrrev_b32 v6, 2, v1
    v_lshlrev_b32 v6, 1, v6
    v_and_b32 v7, 1, v1
    v_add_u32 v6, v6, v7
    v_lshlrev_b32 v6, 4, v6
    v_lshl_add_u32 v6, v2, 7, v6
    v_add_u32 v6, 768, v6
    v_cndmask_b32 v6, v5, v6, vcc
    v_and_b32 v7, 2, v1
    v_cmp_eq_u32 vcc, 0, v7
    s_nop 1
    v_cndmask_b32 v204, v5, v6, vcc
    v_and_b32 v6, 1, v2
    v_lshrrev_b32 v7, 1, v3
    v_lshlrev_b32 v7, 1, v7
    v_lshl_add_u32 v7, v6, 2, v7
    v_lshl_add_u32 v8, v2, 2, v3
    v_and_b32 v9, 1, v4
    v_lshlrev_b32 v9, 3, v9
    v_lshl_add_u32 v9, v8, 7, v9
    s_lshl_b32 s56, s53, 12
    v_add_u32 v9, s56, v9
    v_lshrrev_b32 v8, 1, v4
    v_add_u32 v12, 0, v8
    v_xor_b32 v12, v12, v7
    v_lshl_add_u32 v96, v12, 4, v9
    v_add_u32 v12, 2, v8
    v_xor_b32 v12, v12, v7
    v_lshl_add_u32 v97, v12, 4, v9
    v_add_u32 v12, 4, v8
    v_xor_b32 v12, v12, v7
    v_lshl_add_u32 v98, v12, 4, v9
    v_add_u32 v12, 6, v8
    v_xor_b32 v12, v12, v7
    v_lshl_add_u32 v99, v12, 4, v9
    v_add_u32 v200, 0x20000, v96
    v_add_u32 v201, 0x20000, v97
    v_add_u32 v202, 0x20000, v98
    v_add_u32 v203, 0x20000, v99
    v_mov_b32 v208, 0
    v_mov_b32 v209, 0
    v_mov_b32 v210, 0
    v_mov_b32 v211, 0
    v_mov_b32 v212, 0
    v_mov_b32 v213, 0
    v_mov_b32 v214, 0
    v_mov_b32 v215, 0
    v_mov_b32 v216, 0
    v_mov_b32 v217, 0
    v_mov_b32 v218, 0
    v_mov_b32 v219, 0
    v_mov_b32 v220, 0
    v_mov_b32 v221, 0
    v_mov_b32 v222, 0
    v_mov_b32 v223, 0
    v_mov_b32 v224, 0
    v_mov_b32 v225, 0
    v_mov_b32 v226, 0
    v_mov_b32 v227, 0
    v_mov_b32 v228, 0
    v_mov_b32 v229, 0
    v_mov_b32 v230, 0
    v_mov_b32 v231, 0
    v_mov_b32 v232, 0
    v_mov_b32 v233, 0
    v_mov_b32 v234, 0
    v_mov_b32 v235, 0
    v_mov_b32 v236, 0
    v_mov_b32 v237, 0
    v_mov_b32 v238, 0
    v_mov_b32 v239, 0
    v_mov_b32 v240, 0
    v_mov_b32 v241, 0
    v_mov_b32 v242, 0
    v_mov_b32 v243, 0
    v_mov_b32 v244, 0
    v_mov_b32 v245, 0
    v_mov_b32 v246, 0
    v_mov_b32 v247, 0
    v_mov_b32 v248, 0
    v_mov_b32 v249, 0
    v_mov_b32 v250, 0
    v_mov_b32 v251, 0
    v_mov_b32 v252, 0
    v_mov_b32 v253, 0
    v_mov_b32 v254, 0
    v_mov_b32 v255, 0
    v_mul_u32_u24 v12, 5, v2
    s_mul_i32 s56, s53, 20480
    s_add_u32 s56, s56, 45056
    v_lshlrev_b32 v13, 3, v4
    v_add_u32 v13, s56, v13
    v_add_u32 v14, 0, v3
    v_mul_u32_u24 v15, 52, v14
    v_lshrrev_b32 v15, 8, v15
    v_mul_u32_u24 v15, 15, v15
    v_add3_u32 v14, v14, v15, v12
    v_bfe_u32 v15, v14, 1, 2
    v_lshlrev_b32 v15, 5, v15
    v_lshl_add_u32 v14, v14, 7, v15
    v_add_u32 v68, v14, v13
    v_add_u32 v14, 4, v3
    v_mul_u32_u24 v15, 52, v14
    v_lshrrev_b32 v15, 8, v15
    v_mul_u32_u24 v15, 15, v15
    v_add3_u32 v14, v14, v15, v12
    v_bfe_u32 v15, v14, 1, 2
    v_lshlrev_b32 v15, 5, v15
    v_lshl_add_u32 v14, v14, 7, v15
    v_add_u32 v69, v14, v13
    v_add_u32 v14, 8, v3
    v_mul_u32_u24 v15, 52, v14
    v_lshrrev_b32 v15, 8, v15
    v_mul_u32_u24 v15, 15, v15
    v_add3_u32 v14, v14, v15, v12
    v_bfe_u32 v15, v14, 1, 2
    v_lshlrev_b32 v15, 5, v15
    v_lshl_add_u32 v14, v14, 7, v15
    v_add_u32 v70, v14, v13
    v_add_u32 v14, 12, v3
    v_mul_u32_u24 v15, 52, v14
    v_lshrrev_b32 v15, 8, v15
    v_mul_u32_u24 v15, 15, v15
    v_add3_u32 v14, v14, v15, v12
    v_bfe_u32 v15, v14, 1, 2
    v_lshlrev_b32 v15, 5, v15
    v_lshl_add_u32 v14, v14, 7, v15
    v_add_u32 v71, v14, v13
    v_add_u32 v14, 16, v3
    v_mul_u32_u24 v15, 52, v14
    v_lshrrev_b32 v15, 8, v15
    v_mul_u32_u24 v15, 15, v15
    v_add3_u32 v14, v14, v15, v12
    v_bfe_u32 v15, v14, 1, 2
    v_lshlrev_b32 v15, 5, v15
    v_lshl_add_u32 v14, v14, 7, v15
    v_add_u32 v72, v14, v13
    v_mov_b32 v14, 0
    v_add_u32 v14, v14, v12
    v_bfe_u32 v15, v14, 1, 2
    v_lshlrev_b32 v15, 5, v15
    v_lshl_add_u32 v14, v14, 7, v15
    v_add_u32 v73, v14, v13
    v_add_u32 v14, 0, v3
    v_mul_u32_u24 v15, 52, v14
    v_lshrrev_b32 v15, 8, v15
    v_mul_u32_u24 v15, 15, v15
    v_add3_u32 v14, v14, v15, v12
    v_add_u32 v14, 80, v14
    v_bfe_u32 v15, v14, 1, 2
    v_lshlrev_b32 v15, 5, v15
    v_lshl_add_u32 v14, v14, 7, v15
    v_add_u32 v74, v14, v13
    v_add_u32 v14, 4, v3
    v_mul_u32_u24 v15, 52, v14
    v_lshrrev_b32 v15, 8, v15
    v_mul_u32_u24 v15, 15, v15
    v_add3_u32 v14, v14, v15, v12
    v_add_u32 v14, 80, v14
    v_bfe_u32 v15, v14, 1, 2
    v_lshlrev_b32 v15, 5, v15
    v_lshl_add_u32 v14, v14, 7, v15
    v_add_u32 v75, v14, v13
    v_add_u32 v14, 8, v3
    v_mul_u32_u24 v15, 52, v14
    v_lshrrev_b32 v15, 8, v15
    v_mul_u32_u24 v15, 15, v15
    v_add3_u32 v14, v14, v15, v12
    v_add_u32 v14, 80, v14
    v_bfe_u32 v15, v14, 1, 2
    v_lshlrev_b32 v15, 5, v15
    v_lshl_add_u32 v14, v14, 7, v15
    v_add_u32 v76, v14, v13
    v_add_u32 v14, 12, v3
    v_mul_u32_u24 v15, 52, v14
    v_lshrrev_b32 v15, 8, v15
    v_mul_u32_u24 v15, 15, v15
    v_add3_u32 v14, v14, v15, v12
    v_add_u32 v14, 80, v14
    v_bfe_u32 v15, v14, 1, 2
    v_lshlrev_b32 v15, 5, v15
    v_lshl_add_u32 v14, v14, 7, v15
    v_add_u32 v77, v14, v13
    v_add_u32 v14, 16, v3
    v_mul_u32_u24 v15, 52, v14
    v_lshrrev_b32 v15, 8, v15
    v_mul_u32_u24 v15, 15, v15
    v_add3_u32 v14, v14, v15, v12
    v_add_u32 v14, 80, v14
    v_bfe_u32 v15, v14, 1, 2
    v_lshlrev_b32 v15, 5, v15
    v_lshl_add_u32 v14, v14, 7, v15
    v_add_u32 v198, v14, v13
    v_mov_b32 v14, 80
    v_add_u32 v14, v14, v12
    v_bfe_u32 v15, v14, 1, 2
    v_lshlrev_b32 v15, 5, v15
    v_lshl_add_u32 v14, v14, 7, v15
    v_add_u32 v199, v14, v13
    v_lshlrev_b32 v11, 2, v1
    v_add_u32 v4, 0x10000, v96
    v_add_u32 v5, 0x10000, v97
    v_add_u32 v6, 0x10000, v98
    v_add_u32 v7, 0x10000, v99
    s_mul_i32 s3, s55, 48
    s_mul_i32 s56, s53, 12
    s_add_u32 s3, s3, s56
    s_lshl_b32 s3, s3, 10
    s_lshl_b32 s61, s50, 10
    s_mul_i32 s62, s55, 20480
    s_mul_i32 s56, s53, 5120
    s_add_u32 s62, s62, s56
    s_waitcnt vmcnt(0)
    s_bitcmp1_b32 s46, 1
    s_cbranch_scc1 Lpub_18
    v_mov_b32 v12, 163348
    v_mov_b32 v13, 1
    v_cmp_eq_u32 vcc, 0, v0
    s_nop 1
    s_and_saveexec_b64 s[4:5], vcc
    ds_add_rtn_u32 v13, v12, v13
    s_waitcnt lgkmcnt(0)
    s_mov_b64 exec, s[4:5]
    v_readfirstlane_b32 s6, v13
    s_nop 1
    s_cmp_lg_u32 s6, 3
    s_cbranch_scc1 Lpub_18
    v_mov_b32 v12, s49
    v_mov_b32 v13, 0
    v_cmp_eq_u32 vcc, 0, v0
    v_mov_b32 v14, 1073741824
    s_nop 0
    v_cndmask_b32 v13, v14, v13, vcc
    s_lshl_b32 s4, s48, 8
    s_lshl_b32 s5, s47, 2
    s_add_u32 s4, s4, s5
    s_add_u32 s4, s4, 10559488
    buffer_store_dword v12, v13, s[20:23], s4 offen sc1
Lfl_19:
Lpub_18:
    v_mov_b32 v12, 163356
    v_mov_b32 v13, 1
    v_cmp_eq_u32 vcc, 0, v0
    s_nop 1
    s_and_saveexec_b64 s[4:5], vcc
    ds_add_u32 v12, v13
    s_mov_b64 exec, s[4:5]
    v_mov_b32 v12, 163352
    s_mov_b32 s4, 0
Llw_20:
    ds_read_b32 v13, v12
    s_waitcnt lgkmcnt(0)
    v_readfirstlane_b32 s5, v13
    s_nop 1
    s_cmp_ge_u32 s5, 4
    s_cbranch_scc1 Llwd_21
    s_add_u32 s4, s4, 1
    s_cmp_lt_u32 s4, 160000
    s_cbranch_scc1 Llw_20
Llwd_21:
    s_add_u32 s6, s3, s61
    s_add_u32 s56, s6, 0
    buffer_load_dwordx4 v[104:107], v100, s[20:23], s56 offen sc1
    s_add_u32 s56, s6, 49152
    buffer_load_dwordx4 v[108:111], v100, s[20:23], s56 offen sc1
    s_add_u32 s56, s6, 98304
    buffer_load_dwordx4 v[112:115], v100, s[20:23], s56 offen sc1
    s_add_u32 s61, s61, 1024
    s_cmp_ge_u32 s61, 12288
    s_cselect_b32 s56, 12288, 0
    s_sub_u32 s61, s61, s56
    s_add_u32 s6, s3, s61
    s_add_u32 s56, s6, 0
    buffer_load_dwordx4 v[116:119], v100, s[20:23], s56 offen sc1
    s_add_u32 s56, s6, 49152
    buffer_load_dwordx4 v[120:123], v100, s[20:23], s56 offen sc1
    s_add_u32 s56, s6, 98304
    buffer_load_dwordx4 v[124:127], v100, s[20:23], s56 offen sc1
    s_add_u32 s61, s61, 1024
    s_cmp_ge_u32 s61, 12288
    s_cselect_b32 s56, 12288, 0
    s_sub_u32 s61, s61, s56
    s_add_u32 s6, s3, s61
    s_add_u32 s56, s6, 0
    buffer_load_dwordx4 v[128:131], v100, s[20:23], s56 offen sc1
    s_add_u32 s56, s6, 49152
    buffer_load_dwordx4 v[132:135], v100, s[20:23], s56 offen sc1
    s_add_u32 s56, s6, 98304
    buffer_load_dwordx4 v[136:139], v100, s[20:23], s56 offen sc1
    s_add_u32 s61, s61, 1024
    s_cmp_ge_u32 s61, 12288
    s_cselect_b32 s56, 12288, 0
    s_sub_u32 s61, s61, s56
    s_add_u32 s6, s3, s61
    s_add_u32 s56, s6, 0
    buffer_load_dwordx4 v[140:143], v100, s[20:23], s56 offen sc1
    s_add_u32 s56, s6, 49152
    buffer_load_dwordx4 v[144:147], v100, s[20:23], s56 offen sc1
    s_add_u32 s56, s6, 98304
    buffer_load_dwordx4 v[148:151], v100, s[20:23], s56 offen sc1
    s_add_u32 s61, s61, 1024
    s_cmp_ge_u32 s61, 12288
    s_cselect_b32 s56, 12288, 0
    s_sub_u32 s61, s61, s56
    s_add_u32 s6, s3, s61
    s_add_u32 s56, s6, 0
    buffer_load_dwordx4 v[16:19], v100, s[20:23], s56 offen sc1
    s_add_u32 s56, s6, 49152
    buffer_load_dwordx4 v[20:23], v100, s[20:23], s56 offen sc1
    s_add_u32 s56, s6, 98304
    buffer_load_dwordx4 v[24:27], v100, s[20:23], s56 offen sc1
    s_add_u32 s61, s61, 1024
    s_cmp_ge_u32 s61, 12288
    s_cselect_b32 s56, 12288, 0
    s_sub_u32 s61, s61, s56
    s_add_u32 s6, s3, s61
    s_add_u32 s56, s6, 0
    buffer_load_dwordx4 v[28:31], v100, s[20:23], s56 offen sc1
    s_add_u32 s56, s6, 49152
    buffer_load_dwordx4 v[32:35], v100, s[20:23], s56 offen sc1
    s_add_u32 s56, s6, 98304
    buffer_load_dwordx4 v[36:39], v100, s[20:23], s56 offen sc1
    s_add_u32 s61, s61, 1024
    s_cmp_ge_u32 s61, 12288
    s_cselect_b32 s56, 12288, 0
    s_sub_u32 s61, s61, s56
    s_add_u32 s6, s3, s61
    s_add_u32 s56, s6, 0
    buffer_load_dwordx4 v[40:43], v100, s[20:23], s56 offen sc1
    s_add_u32 s56, s6, 49152
    buffer_load_dwordx4 v[44:47], v100, s[20:23], s56 offen sc1
    s_add_u32 s56, s6, 98304
    buffer_load_dwordx4 v[48:51], v100, s[20:23], s56 offen sc1
    s_add_u32 s61, s61, 1024
    s_cmp_ge_u32 s61, 12288
    s_cselect_b32 s56, 12288, 0
    s_sub_u32 s61, s61, s56
    s_lshl_b32 s6, s55, 6
    s_add_u32 s56, s6, 9437184
    buffer_load_dword v101, v11, s[20:23], s56 offen sc1
    s_add_u32 s56, s6, 9437248
    buffer_load_dword v102, v11, s[20:23], s56 offen sc1
    s_add_u32 s56, s6, 9437312
    buffer_load_dword v103, v11, s[20:23], s56 offen sc1
    v_mov_b32 v12, 163356
    s_mov_b32 s4, 0
Llw_22:
    ds_read_b32 v13, v12
    s_waitcnt lgkmcnt(0)
    v_readfirstlane_b32 s5, v13
    s_nop 1
    s_cmp_ge_u32 s5, 4
    s_cbranch_scc1 Llwd_23
    s_add_u32 s4, s4, 1
    s_cmp_lt_u32 s4, 160000
    s_cbranch_scc1 Llw_22
Llwd_23:
    s_add_u32 m0, s58, 126976
    s_add_u32 s56, s57, 0
    buffer_load_dwordx4 v78, s[28:31], s56 offen lds
    s_add_u32 m0, s58, 128000
    s_add_u32 s56, s57, 10240
    buffer_load_dwordx4 v78, s[28:31], s56 offen lds
    s_add_u32 s57, s57, 40960
    s_cmp_ge_u32 s57, s63
    s_cselect_b32 s56, 491520, 0
    s_sub_u32 s57, s57, s56
    s_add_u32 m0, s58, 143360
    s_add_u32 s56, s57, 0
    buffer_load_dwordx4 v78, s[28:31], s56 offen lds
    s_add_u32 m0, s58, 144384
    s_add_u32 s56, s57, 10240
    buffer_load_dwordx4 v78, s[28:31], s56 offen lds
    s_add_u32 s57, s57, 40960
    s_cmp_ge_u32 s57, s63
    s_cselect_b32 s56, 491520, 0
    s_sub_u32 s57, s57, s56
    ds_read_b64_tr_b16 v[80:81], v96 offset:45056
    ds_read_b64_tr_b16 v[82:83], v96 offset:47104
    ds_read_b64_tr_b16 v[84:85], v97 offset:45056
    ds_read_b64_tr_b16 v[86:87], v97 offset:47104
    ds_read_b64_tr_b16 v[88:89], v98 offset:45056
    ds_read_b64_tr_b16 v[90:91], v98 offset:47104
    ds_read_b64_tr_b16 v[92:93], v99 offset:45056
    ds_read_b64_tr_b16 v[94:95], v99 offset:47104
    ds_read_b64_tr_b16 v[52:53], v96 offset:61440
    ds_read_b64_tr_b16 v[54:55], v96 offset:63488
    ds_read_b64_tr_b16 v[56:57], v97 offset:61440
    ds_read_b64_tr_b16 v[58:59], v97 offset:63488
    ds_read_b64_tr_b16 v[60:61], v98 offset:61440
    ds_read_b64_tr_b16 v[62:63], v98 offset:63488
    ds_read_b64_tr_b16 v[64:65], v99 offset:61440
    ds_read_b64_tr_b16 v[66:67], v99 offset:63488
    s_waitcnt vmcnt(25)
    s_waitcnt lgkmcnt(14)
    v_mfma_f32_16x16x32_bf16 v[208:211], v[80:83], v[104:107], v[208:211]
    v_mfma_f32_16x16x32_bf16 v[224:227], v[80:83], v[108:111], v[224:227]
    v_mfma_f32_16x16x32_bf16 v[240:243], v[80:83], v[112:115], v[240:243]
    s_waitcnt lgkmcnt(12)
    v_mfma_f32_16x16x32_bf16 v[212:215], v[84:87], v[104:107], v[212:215]
    v_mfma_f32_16x16x32_bf16 v[228:231], v[84:87], v[108:111], v[228:231]
    v_mfma_f32_16x16x32_bf16 v[244:247], v[84:87], v[112:115], v[244:247]
    s_waitcnt lgkmcnt(10)
    v_mfma_f32_16x16x32_bf16 v[216:219], v[88:91], v[104:107], v[216:219]
    v_mfma_f32_16x16x32_bf16 v[232:235], v[88:91], v[108:111], v[232:235]
    v_mfma_f32_16x16x32_bf16 v[248:251], v[88:91], v[112:115], v[248:251]
    s_waitcnt lgkmcnt(8)
    v_mfma_f32_16x16x32_bf16 v[220:223], v[92:95], v[104:107], v[220:223]
    v_mfma_f32_16x16x32_bf16 v[236:239], v[92:95], v[108:111], v[236:239]
    v_mfma_f32_16x16x32_bf16 v[252:255], v[92:95], v[112:115], v[252:255]
    s_add_u32 s6, s3, s61
    s_add_u32 s56, s6, 0
    buffer_load_dwordx4 v[104:107], v100, s[20:23], s56 offen sc1
    s_add_u32 s56, s6, 49152
    buffer_load_dwordx4 v[108:111], v100, s[20:23], s56 offen sc1
    s_add_u32 s56, s6, 98304
    buffer_load_dwordx4 v[112:115], v100, s[20:23], s56 offen sc1
    s_add_u32 s61, s61, 1024
    s_cmp_ge_u32 s61, 12288
    s_cselect_b32 s56, 12288, 0
    s_sub_u32 s61, s61, s56
    ds_read_b64_tr_b16 v[80:81], v4 offset:12288
    ds_read_b64_tr_b16 v[82:83], v4 offset:14336
    ds_read_b64_tr_b16 v[84:85], v5 offset:12288
    ds_read_b64_tr_b16 v[86:87], v5 offset:14336
    ds_read_b64_tr_b16 v[88:89], v6 offset:12288
    ds_read_b64_tr_b16 v[90:91], v6 offset:14336
    ds_read_b64_tr_b16 v[92:93], v7 offset:12288
    ds_read_b64_tr_b16 v[94:95], v7 offset:14336
    s_waitcnt vmcnt(25)
    s_waitcnt lgkmcnt(14)
    v_mfma_f32_16x16x32_bf16 v[208:211], v[52:55], v[116:119], v[208:211]
    v_mfma_f32_16x16x32_bf16 v[224:227], v[52:55], v[120:123], v[224:227]
    v_mfma_f32_16x16x32_bf16 v[240:243], v[52:55], v[124:127], v[240:243]
    s_waitcnt lgkmcnt(12)
    v_mfma_f32_16x16x32_bf16 v[212:215], v[56:59], v[116:119], v[212:215]
    v_mfma_f32_16x16x32_bf16 v[228:231], v[56:59], v[120:123], v[228:231]
    v_mfma_f32_16x16x32_bf16 v[244:247], v[56:59], v[124:127], v[244:247]
    s_waitcnt lgkmcnt(10)
    v_mfma_f32_16x16x32_bf16 v[216:219], v[60:63], v[116:119], v[216:219]
    v_mfma_f32_16x16x32_bf16 v[232:235], v[60:63], v[120:123], v[232:235]
    v_mfma_f32_16x16x32_bf16 v[248:251], v[60:63], v[124:127], v[248:251]
    s_waitcnt lgkmcnt(8)
    v_mfma_f32_16x16x32_bf16 v[220:223], v[64:67], v[116:119], v[220:223]
    v_mfma_f32_16x16x32_bf16 v[236:239], v[64:67], v[120:123], v[236:239]
    v_mfma_f32_16x16x32_bf16 v[252:255], v[64:67], v[124:127], v[252:255]
    s_add_u32 s6, s3, s61
    s_add_u32 s56, s6, 0
    buffer_load_dwordx4 v[116:119], v100, s[20:23], s56 offen sc1
    s_add_u32 s56, s6, 49152
    buffer_load_dwordx4 v[120:123], v100, s[20:23], s56 offen sc1
    s_add_u32 s56, s6, 98304
    buffer_load_dwordx4 v[124:127], v100, s[20:23], s56 offen sc1
    s_add_u32 s61, s61, 1024
    s_cmp_ge_u32 s61, 12288
    s_cselect_b32 s56, 12288, 0
    s_sub_u32 s61, s61, s56
    ds_read_b64_tr_b16 v[52:53], v4 offset:28672
    ds_read_b64_tr_b16 v[54:55], v4 offset:30720
    ds_read_b64_tr_b16 v[56:57], v5 offset:28672
    ds_read_b64_tr_b16 v[58:59], v5 offset:30720
    ds_read_b64_tr_b16 v[60:61], v6 offset:28672
    ds_read_b64_tr_b16 v[62:63], v6 offset:30720
    ds_read_b64_tr_b16 v[64:65], v7 offset:28672
    ds_read_b64_tr_b16 v[66:67], v7 offset:30720
    s_waitcnt vmcnt(25)
    s_waitcnt lgkmcnt(14)
    v_mfma_f32_16x16x32_bf16 v[208:211], v[80:83], v[128:131], v[208:211]
    v_mfma_f32_16x16x32_bf16 v[224:227], v[80:83], v[132:135], v[224:227]
    v_mfma_f32_16x16x32_bf16 v[240:243], v[80:83], v[136:139], v[240:243]
    s_waitcnt lgkmcnt(12)
    v_mfma_f32_16x16x32_bf16 v[212:215], v[84:87], v[128:131], v[212:215]
    v_mfma_f32_16x16x32_bf16 v[228:231], v[84:87], v[132:135], v[228:231]
    v_mfma_f32_16x16x32_bf16 v[244:247], v[84:87], v[136:139], v[244:247]
    s_waitcnt lgkmcnt(10)
    v_mfma_f32_16x16x32_bf16 v[216:219], v[88:91], v[128:131], v[216:219]
    v_mfma_f32_16x16x32_bf16 v[232:235], v[88:91], v[132:135], v[232:235]
    v_mfma_f32_16x16x32_bf16 v[248:251], v[88:91], v[136:139], v[248:251]
    s_waitcnt lgkmcnt(8)
    v_mfma_f32_16x16x32_bf16 v[220:223], v[92:95], v[128:131], v[220:223]
    v_mfma_f32_16x16x32_bf16 v[236:239], v[92:95], v[132:135], v[236:239]
    v_mfma_f32_16x16x32_bf16 v[252:255], v[92:95], v[136:139], v[252:255]
    s_add_u32 s6, s3, s61
    s_add_u32 s56, s6, 0
    buffer_load_dwordx4 v[128:131], v100, s[20:23], s56 offen sc1
    s_add_u32 s56, s6, 49152
    buffer_load_dwordx4 v[132:135], v100, s[20:23], s56 offen sc1
    s_add_u32 s56, s6, 98304
    buffer_load_dwordx4 v[136:139], v100, s[20:23], s56 offen sc1
    s_add_u32 s61, s61, 1024
    s_cmp_ge_u32 s61, 12288
    s_cselect_b32 s56, 12288, 0
    s_sub_u32 s61, s61, s56
    ds_read_b64_tr_b16 v[80:81], v4 offset:45056
    ds_read_b64_tr_b16 v[82:83], v4 offset:47104
    ds_read_b64_tr_b16 v[84:85], v5 offset:45056
    ds_read_b64_tr_b16 v[86:87], v5 offset:47104
    ds_read_b64_tr_b16 v[88:89], v6 offset:45056
    ds_read_b64_tr_b16 v[90:91], v6 offset:47104
    ds_read_b64_tr_b16 v[92:93], v7 offset:45056
    ds_read_b64_tr_b16 v[94:95], v7 offset:47104
    s_waitcnt vmcnt(25)
    s_waitcnt lgkmcnt(14)
    v_mfma_f32_16x16x32_bf16 v[208:211], v[52:55], v[140:143], v[208:211]
    v_mfma_f32_16x16x32_bf16 v[224:227], v[52:55], v[144:147], v[224:227]
    v_mfma_f32_16x16x32_bf16 v[240:243], v[52:55], v[148:151], v[240:243]
    s_waitcnt lgkmcnt(12)
    v_mfma_f32_16x16x32_bf16 v[212:215], v[56:59], v[140:143], v[212:215]
    v_mfma_f32_16x16x32_bf16 v[228:231], v[56:59], v[144:147], v[228:231]
    v_mfma_f32_16x16x32_bf16 v[244:247], v[56:59], v[148:151], v[244:247]
    s_waitcnt lgkmcnt(10)
    v_mfma_f32_16x16x32_bf16 v[216:219], v[60:63], v[140:143], v[216:219]
    v_mfma_f32_16x16x32_bf16 v[232:235], v[60:63], v[144:147], v[232:235]
    v_mfma_f32_16x16x32_bf16 v[248:251], v[60:63], v[148:151], v[248:251]
    s_waitcnt lgkmcnt(8)
    v_mfma_f32_16x16x32_bf16 v[220:223], v[64:67], v[140:143], v[220:223]
    v_mfma_f32_16x16x32_bf16 v[236:239], v[64:67], v[144:147], v[236:239]
    v_mfma_f32_16x16x32_bf16 v[252:255], v[64:67], v[148:151], v[252:255]
    s_add_u32 s6, s3, s61
    s_add_u32 s56, s6, 0
    buffer_load_dwordx4 v[140:143], v100, s[20:23], s56 offen sc1
    s_add_u32 s56, s6, 49152
    buffer_load_dwordx4 v[144:147], v100, s[20:23], s56 offen sc1
    s_add_u32 s56, s6, 98304
    buffer_load_dwordx4 v[148:151], v100, s[20:23], s56 offen sc1
    s_add_u32 s61, s61, 1024
    s_cmp_ge_u32 s61, 12288
    s_cselect_b32 s56, 12288, 0
    s_sub_u32 s61, s61, s56
    ds_read_b64_tr_b16 v[52:53], v96 offset:0
    ds_read_b64_tr_b16 v[54:55], v96 offset:2048
    ds_read_b64_tr_b16 v[56:57], v97 offset:0
    ds_read_b64_tr_b16 v[58:59], v97 offset:2048
    ds_read_b64_tr_b16 v[60:61], v98 offset:0
    ds_read_b64_tr_b16 v[62:63], v98 offset:2048
    ds_read_b64_tr_b16 v[64:65], v99 offset:0
    ds_read_b64_tr_b16 v[66:67], v99 offset:2048
    s_waitcnt vmcnt(25)
    s_waitcnt lgkmcnt(14)
    v_mfma_f32_16x16x32_bf16 v[208:211], v[80:83], v[16:19], v[208:211]
    v_mfma_f32_16x16x32_bf16 v[224:227], v[80:83], v[20:23], v[224:227]
    v_mfma_f32_16x16x32_bf16 v[240:243], v[80:83], v[24:27], v[240:243]
    s_waitcnt lgkmcnt(12)
    v_mfma_f32_16x16x32_bf16 v[212:215], v[84:87], v[16:19], v[212:215]
    v_mfma_f32_16x16x32_bf16 v[228:231], v[84:87], v[20:23], v[228:231]
    v_mfma_f32_16x16x32_bf16 v[244:247], v[84:87], v[24:27], v[244:247]
    s_waitcnt lgkmcnt(10)
    v_mfma_f32_16x16x32_bf16 v[216:219], v[88:91], v[16:19], v[216:219]
    v_mfma_f32_16x16x32_bf16 v[232:235], v[88:91], v[20:23], v[232:235]
    v_mfma_f32_16x16x32_bf16 v[248:251], v[88:91], v[24:27], v[248:251]
    s_waitcnt lgkmcnt(8)
    v_mfma_f32_16x16x32_bf16 v[220:223], v[92:95], v[16:19], v[220:223]
    v_mfma_f32_16x16x32_bf16 v[236:239], v[92:95], v[20:23], v[236:239]
    v_mfma_f32_16x16x32_bf16 v[252:255], v[92:95], v[24:27], v[252:255]
    s_add_u32 s6, s3, s61
    s_add_u32 s56, s6, 0
    buffer_load_dwordx4 v[16:19], v100, s[20:23], s56 offen sc1
    s_add_u32 s56, s6, 49152
    buffer_load_dwordx4 v[20:23], v100, s[20:23], s56 offen sc1
    s_add_u32 s56, s6, 98304
    buffer_load_dwordx4 v[24:27], v100, s[20:23], s56 offen sc1
    s_add_u32 s61, s61, 1024
    s_cmp_ge_u32 s61, 12288
    s_cselect_b32 s56, 12288, 0
    s_sub_u32 s61, s61, s56
    s_barrier
    s_add_u32 m0, s60, 0
    s_add_u32 s56, s59, 0
    buffer_load_dwordx4 v78, s[32:35], s56 offen lds
    s_add_u32 m0, s60, 1024
    s_add_u32 s56, s59, 10240
    buffer_load_dwordx4 v78, s[32:35], s56 offen lds
    s_add_u32 m0, s60, 2048
    s_add_u32 s56, s59, 20480
    buffer_load_dwordx4 v78, s[32:35], s56 offen lds
    s_add_u32 m0, s60, 3072
    s_add_u32 s56, s59, 30720
    buffer_load_dwordx4 v78, s[32:35], s56 offen lds
    s_add_u32 m0, s60, 4096
    s_add_u32 s56, s59, 40960
    buffer_load_dwordx4 v78, s[32:35], s56 offen lds
    s_add_u32 m0, s60, 5120
    s_add_u32 s56, s59, 51200
    buffer_load_dwordx4 v78, s[32:35], s56 offen lds
    s_add_u32 m0, s60, 6144
    s_add_u32 s56, s59, 61440
    buffer_load_dwordx4 v78, s[32:35], s56 offen lds
    s_add_u32 m0, s60, 7168
    s_add_u32 s56, s59, 71680
    buffer_load_dwordx4 v78, s[32:35], s56 offen lds
    s_add_u32 m0, s60, 8192
    s_add_u32 s56, s59, 81920
    buffer_load_dwordx4 v78, s[32:35], s56 offen lds
    s_add_u32 m0, s60, 9216
    s_add_u32 s56, s59, 92160
    buffer_load_dwordx4 v78, s[32:35], s56 offen lds
    ds_read_b64_tr_b16 v[80:81], v96 offset:16384
    ds_read_b64_tr_b16 v[82:83], v96 offset:18432
    ds_read_b64_tr_b16 v[84:85], v97 offset:16384
    ds_read_b64_tr_b16 v[86:87], v97 offset:18432
    ds_read_b64_tr_b16 v[88:89], v98 offset:16384
    ds_read_b64_tr_b16 v[90:91], v98 offset:18432
    ds_read_b64_tr_b16 v[92:93], v99 offset:16384
    ds_read_b64_tr_b16 v[94:95], v99 offset:18432
    s_waitcnt vmcnt(35)
    s_waitcnt lgkmcnt(14)
    v_mfma_f32_16x16x32_bf16 v[208:211], v[52:55], v[28:31], v[208:211]
    v_mfma_f32_16x16x32_bf16 v[224:227], v[52:55], v[32:35], v[224:227]
    v_mfma_f32_16x16x32_bf16 v[240:243], v[52:55], v[36:39], v[240:243]
    s_waitcnt lgkmcnt(12)
    v_mfma_f32_16x16x32_bf16 v[212:215], v[56:59], v[28:31], v[212:215]
    v_mfma_f32_16x16x32_bf16 v[228:231], v[56:59], v[32:35], v[228:231]
    v_mfma_f32_16x16x32_bf16 v[244:247], v[56:59], v[36:39], v[244:247]
    s_waitcnt lgkmcnt(10)
    v_mfma_f32_16x16x32_bf16 v[216:219], v[60:63], v[28:31], v[216:219]
    v_mfma_f32_16x16x32_bf16 v[232:235], v[60:63], v[32:35], v[232:235]
    v_mfma_f32_16x16x32_bf16 v[248:251], v[60:63], v[36:39], v[248:251]
    s_waitcnt lgkmcnt(8)
    v_mfma_f32_16x16x32_bf16 v[220:223], v[64:67], v[28:31], v[220:223]
    v_mfma_f32_16x16x32_bf16 v[236:239], v[64:67], v[32:35], v[236:239]
    v_mfma_f32_16x16x32_bf16 v[252:255], v[64:67], v[36:39], v[252:255]
    s_waitcnt vmcnt(25)
    s_barrier
    s_add_u32 m0, s58, 0
    s_add_u32 s56, s57, 0
    buffer_load_dwordx4 v78, s[28:31], s56 offen lds
    s_add_u32 m0, s58, 1024
    s_add_u32 s56, s57, 10240
    buffer_load_dwordx4 v78, s[28:31], s56 offen lds
    s_add_u32 s57, s57, 40960
    s_cmp_ge_u32 s57, s63
    s_cselect_b32 s56, 491520, 0
    s_sub_u32 s57, s57, s56
    s_bitcmp0_b32 s46, 1
    s_cbranch_scc1 Loj_24
    v_lshlrev_b32 v12, 2, v0
    s_lshl_b32 s56, s48, 3
    v_add_u32 v12, s56, v12
    v_cmp_gt_u32 vcc, 2, v0
    v_mov_b32 v13, 1073741824
    s_nop 0
    v_cndmask_b32 v12, v13, v12, vcc
    s_mov_b32 s5, 10567680
    buffer_load_dword v9, v12, s[20:23], s5 offen sc1
Loj_24:
    ds_read_b64_tr_b16 v[52:53], v4 offset:61440
    ds_read_b64_tr_b16 v[54:55], v4 offset:63488
    ds_read_b64_tr_b16 v[56:57], v5 offset:61440
    ds_read_b64_tr_b16 v[58:59], v5 offset:63488
    ds_read_b64_tr_b16 v[60:61], v6 offset:61440
    ds_read_b64_tr_b16 v[62:63], v6 offset:63488
    ds_read_b64_tr_b16 v[64:65], v7 offset:61440
    ds_read_b64_tr_b16 v[66:67], v7 offset:63488
    s_waitcnt lgkmcnt(14)
    v_mfma_f32_16x16x32_bf16 v[208:211], v[80:83], v[40:43], v[208:211]
    v_mfma_f32_16x16x32_bf16 v[224:227], v[80:83], v[44:47], v[224:227]
    v_mfma_f32_16x16x32_bf16 v[240:243], v[80:83], v[48:51], v[240:243]
    s_waitcnt lgkmcnt(12)
    v_mfma_f32_16x16x32_bf16 v[212:215], v[84:87], v[40:43], v[212:215]
    v_mfma_f32_16x16x32_bf16 v[228:231], v[84:87], v[44:47], v[228:231]
    v_mfma_f32_16x16x32_bf16 v[244:247], v[84:87], v[48:51], v[244:247]
    s_waitcnt lgkmcnt(10)
    v_mfma_f32_16x16x32_bf16 v[216:219], v[88:91], v[40:43], v[216:219]
    v_mfma_f32_16x16x32_bf16 v[232:235], v[88:91], v[44:47], v[232:235]
    v_mfma_f32_16x16x32_bf16 v[248:251], v[88:91], v[48:51], v[248:251]
    s_waitcnt lgkmcnt(8)
    v_mfma_f32_16x16x32_bf16 v[220:223], v[92:95], v[40:43], v[220:223]
    v_mfma_f32_16x16x32_bf16 v[236:239], v[92:95], v[44:47], v[236:239]
    v_mfma_f32_16x16x32_bf16 v[252:255], v[92:95], v[48:51], v[252:255]
    s_barrier
    s_add_u32 m0, s58, 16384
    s_add_u32 s56, s57, 0
    buffer_load_dwordx4 v78, s[28:31], s56 offen lds
    s_add_u32 m0, s58, 17408
    s_add_u32 s56, s57, 10240
    buffer_load_dwordx4 v78, s[28:31], s56 offen lds
    s_add_u32 s57, s57, 40960
    s_cmp_ge_u32 s57, s63
    s_cselect_b32 s56, 491520, 0
    s_sub_u32 s57, s57, s56
    s_bitcmp0_b32 s46, 1
    s_cbranch_scc1 Loj_25
    s_waitcnt vmcnt(2)
    v_cmp_eq_u32 vcc, s49, v9
    s_nop 1
    s_and_b32 s6, vcc_lo, 3
    s_cmp_eq_u32 s6, 3
    s_cbranch_scc1 Lfo_26
    v_lshlrev_b32 v12, 2, v0
    s_lshl_b32 s56, s48, 3
    v_add_u32 v12, s56, v12
    v_cmp_gt_u32 vcc, 2, v0
    v_mov_b32 v13, 1073741824
    s_nop 0
    v_cndmask_b32 v12, v13, v12, vcc
    s_mov_b32 s4, 0
    s_mov_b32 s5, 10567680
    s_mov_b32 s7, 0x3
Lpoll_27:
    buffer_load_dword v14, v12, s[20:23], s5 offen sc1
    s_waitcnt vmcnt(0)
    v_cmp_eq_u32 vcc, s49, v14
    s_nop 1
    s_and_b32 s6, vcc_lo, s7
    s_cmp_eq_u32 s6, s7
    s_cbranch_scc1 Lpd_28
    s_add_u32 s4, s4, 1
    s_cmp_lt_u32 s4, 40000
    s_sleep 1
    s_cbranch_scc1 Lpoll_27
Lpd_28:
Lfo_26:
    v_lshlrev_b32 v12, 4, v0
    v_and_b32 v13, 15, v0
    v_lshrrev_b32 v14, 2, v13
    v_lshlrev_b32 v14, 1, v14
    v_and_b32 v8, 1, v13
    v_add_u32 v14, v14, v8
    v_lshlrev_b32 v14, 4, v14
    v_lshrrev_b32 v8, 4, v0
    v_lshl_add_u32 v14, v8, 7, v14
    v_add_u32 v14, 1024, v14
    v_and_b32 v8, 2, v13
    v_cmp_eq_u32 vcc, 0, v8
    v_mov_b32 v8, 1073741824
    s_nop 0
    v_cndmask_b32 v14, v8, v14, vcc
    s_mul_i32 s6, s48, 6144
    s_add_u32 s56, s6, 10485760
    buffer_load_dwordx4 v[152:155], v12, s[20:23], s56 offen sc1
    buffer_load_dwordx4 v[156:159], v14, s[20:23], s56 offen sc1
    s_add_u32 s56, s6, 10487296
    buffer_load_dwordx4 v[160:163], v12, s[20:23], s56 offen sc1
    buffer_load_dwordx4 v[164:167], v14, s[20:23], s56 offen sc1
    s_add_u32 s56, s6, 10488832
    buffer_load_dwordx4 v[168:171], v12, s[20:23], s56 offen sc1
    buffer_load_dwordx4 v[172:175], v14, s[20:23], s56 offen sc1
    s_add_u32 s56, s6, 10490368
    buffer_load_dwordx4 v[28:31], v12, s[20:23], s56 offen sc1
    buffer_load_dwordx4 v[32:35], v14, s[20:23], s56 offen sc1
Loj_25:
    ds_read_b64_tr_b16 v[80:81], v200 offset:12288
    ds_read_b64_tr_b16 v[82:83], v200 offset:14336
    ds_read_b64_tr_b16 v[84:85], v201 offset:12288
    ds_read_b64_tr_b16 v[86:87], v201 offset:14336
    ds_read_b64_tr_b16 v[88:89], v202 offset:12288
    ds_read_b64_tr_b16 v[90:91], v202 offset:14336
    ds_read_b64_tr_b16 v[92:93], v203 offset:12288
    ds_read_b64_tr_b16 v[94:95], v203 offset:14336
    s_waitcnt vmcnt(26)
    s_waitcnt lgkmcnt(14)
    v_mfma_f32_16x16x32_bf16 v[208:211], v[52:55], v[104:107], v[208:211]
    v_mfma_f32_16x16x32_bf16 v[224:227], v[52:55], v[108:111], v[224:227]
    v_mfma_f32_16x16x32_bf16 v[240:243], v[52:55], v[112:115], v[240:243]
    s_waitcnt lgkmcnt(12)
    v_mfma_f32_16x16x32_bf16 v[212:215], v[56:59], v[104:107], v[212:215]
    v_mfma_f32_16x16x32_bf16 v[228:231], v[56:59], v[108:111], v[228:231]
    v_mfma_f32_16x16x32_bf16 v[244:247], v[56:59], v[112:115], v[244:247]
    s_waitcnt lgkmcnt(10)
    v_mfma_f32_16x16x32_bf16 v[216:219], v[60:63], v[104:107], v[216:219]
    v_mfma_f32_16x16x32_bf16 v[232:235], v[60:63], v[108:111], v[232:235]
    v_mfma_f32_16x16x32_bf16 v[248:251], v[60:63], v[112:115], v[248:251]
    s_waitcnt lgkmcnt(8)
    v_mfma_f32_16x16x32_bf16 v[220:223], v[64:67], v[104:107], v[220:223]
    v_mfma_f32_16x16x32_bf16 v[236:239], v[64:67], v[108:111], v[236:239]
    v_mfma_f32_16x16x32_bf16 v[252:255], v[64:67], v[112:115], v[252:255]
    s_waitcnt vmcnt(2)
    s_barrier
    s_add_u32 m0, s58, 126976
    s_add_u32 s56, s57, 0
    buffer_load_dwordx4 v78, s[28:31], s56 offen lds
    s_add_u32 m0, s58, 128000
    s_add_u32 s56, s57, 10240
    buffer_load_dwordx4 v78, s[28:31], s56 offen lds
    s_add_u32 s57, s57, 40960
    s_cmp_ge_u32 s57, s63
    s_cselect_b32 s56, 491520, 0
    s_sub_u32 s57, s57, s56
    s_bitcmp0_b32 s46, 1
    s_cbranch_scc1 Loj_29
    s_waitcnt vmcnt(2)
    s_mov_b32 s4, 897988541
    s_lshl_b32 s5, s47, 3
    s_lshl_b32 s6, s44, 1
    s_add_u32 s5, s5, s6
    s_mul_i32 s5, s5, 24
    s_mul_i32 s6, s48, 3
    s_add_u32 s5, s5, s6
    s_lshl_b32 s5, s5, 10
    s_add_u32 s5, s5, 11534336
    v_lshlrev_b32 v14, 4, v0
    v_mfma_f32_16x16x32_bf16 v[36:39], v[152:155], v[176:179], 0
    v_mfma_f32_16x16x32_bf16 v[40:43], v[156:159], v[176:179], 0
    s_nop 7
    v_add_f32 v12, s4, v41
    v_rcp_f32 v12, v12
    s_nop 0
    v_mul_f32 v12, v12, v196
    v_mul_f32 v44, v12, v36
    v_mul_f32 v45, v12, v37
    v_mul_f32 v46, v12, v38
    v_mul_f32 v47, v12, v39
    v_cvt_pk_bf16_f32 v8, v44, v45
    v_cvt_pk_bf16_f32 v9, v46, v47
    v_mul_f32 v48, v12, v40
    v_mfma_f32_16x16x32_bf16 v[36:39], v[160:163], v[178:181], 0
    v_mfma_f32_16x16x32_bf16 v[40:43], v[164:167], v[178:181], 0
    s_nop 7
    v_add_f32 v12, s4, v41
    v_rcp_f32 v12, v12
    s_nop 0
    v_mul_f32 v12, v12, v196
    v_mul_f32 v49, v12, v36
    v_mul_f32 v50, v12, v37
    v_mul_f32 v51, v12, v38
    v_cvt_pk_bf16_f32 v10, v48, v49
    v_cvt_pk_bf16_f32 v11, v50, v51
    s_add_u32 s56, s5, 0
    buffer_store_dwordx4 v[8:11], v14, s[20:23], s56 offen sc1
    v_mul_f32 v44, v12, v39
    v_mul_f32 v45, v12, v40
    v_mfma_f32_16x16x32_bf16 v[36:39], v[168:171], v[180:183], 0
    v_mfma_f32_16x16x32_bf16 v[40:43], v[172:175], v[180:183], 0
    s_nop 7
    v_add_f32 v12, s4, v41
    v_rcp_f32 v12, v12
    s_nop 0
    v_mul_f32 v12, v12, v196
    v_mul_f32 v46, v12, v36
    v_mul_f32 v47, v12, v37
    v_cvt_pk_bf16_f32 v8, v44, v45
    v_cvt_pk_bf16_f32 v9, v46, v47
    v_mul_f32 v48, v12, v38
    v_mul_f32 v49, v12, v39
    v_mul_f32 v50, v12, v40
    v_mfma_f32_16x16x32_bf16 v[36:39], v[28:31], v[182:185], 0
    v_mfma_f32_16x16x32_bf16 v[40:43], v[32:35], v[182:185], 0
    s_nop 7
    v_add_f32 v12, s4, v41
    v_rcp_f32 v12, v12
    s_nop 0
    v_mul_f32 v12, v12, v196
    v_mul_f32 v51, v12, v36
    v_cvt_pk_bf16_f32 v10, v48, v49
    v_cvt_pk_bf16_f32 v11, v50, v51
    s_add_u32 s56, s5, 1024
    buffer_store_dwordx4 v[8:11], v14, s[20:23], s56 offen sc1
    v_mul_f32 v44, v12, v37
    v_mul_f32 v45, v12, v38
    v_mul_f32 v46, v12, v39
    v_mul_f32 v47, v12, v40
    v_cvt_pk_bf16_f32 v8, v44, v45
    v_cvt_pk_bf16_f32 v9, v46, v47
    v_mov_b32 v10, 0
    v_mov_b32 v11, 0
    s_add_u32 s56, s5, 2048
    buffer_store_dwordx4 v[8:11], v14, s[20:23], s56 offen sc1
    v_mfma_f32_16x16x32_bf16 v[36:39], v[152:155], v[186:189], 0
    v_mfma_f32_16x16x32_bf16 v[40:43], v[156:159], v[186:189], 0
    s_nop 7
    v_add_f32 v12, s4, v41
    v_rcp_f32 v12, v12
    s_nop 0
    v_mul_f32 v12, v12, v197
    v_mul_f32 v44, v12, v36
    v_mul_f32 v45, v12, v37
    v_mul_f32 v46, v12, v38
    v_mul_f32 v47, v12, v39
    v_cvt_pk_bf16_f32 v8, v44, v45
    v_cvt_pk_bf16_f32 v9, v46, v47
    v_mul_f32 v48, v12, v40
    v_mfma_f32_16x16x32_bf16 v[36:39], v[160:163], v[188:191], 0
    v_mfma_f32_16x16x32_bf16 v[40:43], v[164:167], v[188:191], 0
    s_nop 7
    v_add_f32 v12, s4, v41
    v_rcp_f32 v12, v12
    s_nop 0
    v_mul_f32 v12, v12, v197
    v_mul_f32 v49, v12, v36
    v_mul_f32 v50, v12, v37
    v_mul_f32 v51, v12, v38
    v_cvt_pk_bf16_f32 v10, v48, v49
    v_cvt_pk_bf16_f32 v11, v50, v51
    s_add_u32 s56, s5, 24576
    buffer_store_dwordx4 v[8:11], v14, s[20:23], s56 offen sc1
    v_mul_f32 v44, v12, v39
    v_mul_f32 v45, v12, v40
    v_mfma_f32_16x16x32_bf16 v[36:39], v[168:171], v[190:193], 0
    v_mfma_f32_16x16x32_bf16 v[40:43], v[172:175], v[190:193], 0
    s_nop 7
    v_add_f32 v12, s4, v41
    v_rcp_f32 v12, v12
    s_nop 0
    v_mul_f32 v12, v12, v197
    v_mul_f32 v46, v12, v36
    v_mul_f32 v47, v12, v37
    v_cvt_pk_bf16_f32 v8, v44, v45
    v_cvt_pk_bf16_f32 v9, v46, v47
    v_mul_f32 v48, v12, v38
    v_mul_f32 v49, v12, v39
    v_mul_f32 v50, v12, v40
    v_mfma_f32_16x16x32_bf16 v[36:39], v[28:31], v[192:195], 0
    v_mfma_f32_16x16x32_bf16 v[40:43], v[32:35], v[192:195], 0
    s_nop 7
    v_add_f32 v12, s4, v41
    v_rcp_f32 v12, v12
    s_nop 0
    v_mul_f32 v12, v12, v197
    v_mul_f32 v51, v12, v36
    v_cvt_pk_bf16_f32 v10, v48, v49
    v_cvt_pk_bf16_f32 v11, v50, v51
    s_add_u32 s56, s5, 25600
    buffer_store_dwordx4 v[8:11], v14, s[20:23], s56 offen sc1
    v_mul_f32 v44, v12, v37
    v_mul_f32 v45, v12, v38
    v_mul_f32 v46, v12, v39
    v_mul_f32 v47, v12, v40
    v_cvt_pk_bf16_f32 v8, v44, v45
    v_cvt_pk_bf16_f32 v9, v46, v47
    v_mov_b32 v10, 0
    v_mov_b32 v11, 0
    s_add_u32 s56, s5, 26624
    buffer_store_dwordx4 v[8:11], v14, s[20:23], s56 offen sc1
Loj_29:
    ds_read_b64_tr_b16 v[52:53], v96 offset:0
    ds_read_b64_tr_b16 v[54:55], v96 offset:2048
    ds_read_b64_tr_b16 v[56:57], v97 offset:0
    ds_read_b64_tr_b16 v[58:59], v97 offset:2048
    ds_read_b64_tr_b16 v[60:61], v98 offset:0
    ds_read_b64_tr_b16 v[62:63], v98 offset:2048
    ds_read_b64_tr_b16 v[64:65], v99 offset:0
    ds_read_b64_tr_b16 v[66:67], v99 offset:2048
    s_waitcnt lgkmcnt(14)
    v_mfma_f32_16x16x32_bf16 v[208:211], v[80:83], v[116:119], v[208:211]
    v_mfma_f32_16x16x32_bf16 v[224:227], v[80:83], v[120:123], v[224:227]
    v_mfma_f32_16x16x32_bf16 v[240:243], v[80:83], v[124:127], v[240:243]
    s_waitcnt lgkmcnt(12)
    v_mfma_f32_16x16x32_bf16 v[212:215], v[84:87], v[116:119], v[212:215]
    v_mfma_f32_16x16x32_bf16 v[228:231], v[84:87], v[120:123], v[228:231]
    v_mfma_f32_16x16x32_bf16 v[244:247], v[84:87], v[124:127], v[244:247]
    s_waitcnt lgkmcnt(10)
    v_mfma_f32_16x16x32_bf16 v[216:219], v[88:91], v[116:119], v[216:219]
    v_mfma_f32_16x16x32_bf16 v[232:235], v[88:91], v[120:123], v[232:235]
    v_mfma_f32_16x16x32_bf16 v[248:251], v[88:91], v[124:127], v[248:251]
    s_waitcnt lgkmcnt(8)
    v_mfma_f32_16x16x32_bf16 v[220:223], v[92:95], v[116:119], v[220:223]
    v_mfma_f32_16x16x32_bf16 v[236:239], v[92:95], v[120:123], v[236:239]
    v_mfma_f32_16x16x32_bf16 v[252:255], v[92:95], v[124:127], v[252:255]
    s_waitcnt vmcnt(0)
    s_barrier
    ds_read_b64_tr_b16 v[80:81], v96 offset:16384
    ds_read_b64_tr_b16 v[82:83], v96 offset:18432
    ds_read_b64_tr_b16 v[84:85], v97 offset:16384
    ds_read_b64_tr_b16 v[86:87], v97 offset:18432
    ds_read_b64_tr_b16 v[88:89], v98 offset:16384
    ds_read_b64_tr_b16 v[90:91], v98 offset:18432
    ds_read_b64_tr_b16 v[92:93], v99 offset:16384
    ds_read_b64_tr_b16 v[94:95], v99 offset:18432
    s_waitcnt lgkmcnt(14)
    v_mfma_f32_16x16x32_bf16 v[208:211], v[52:55], v[128:131], v[208:211]
    v_mfma_f32_16x16x32_bf16 v[224:227], v[52:55], v[132:135], v[224:227]
    v_mfma_f32_16x16x32_bf16 v[240:243], v[52:55], v[136:139], v[240:243]
    s_waitcnt lgkmcnt(12)
    v_mfma_f32_16x16x32_bf16 v[212:215], v[56:59], v[128:131], v[212:215]
    v_mfma_f32_16x16x32_bf16 v[228:231], v[56:59], v[132:135], v[228:231]
    v_mfma_f32_16x16x32_bf16 v[244:247], v[56:59], v[136:139], v[244:247]
    s_waitcnt lgkmcnt(10)
    v_mfma_f32_16x16x32_bf16 v[216:219], v[60:63], v[128:131], v[216:219]
    v_mfma_f32_16x16x32_bf16 v[232:235], v[60:63], v[132:135], v[232:235]
    v_mfma_f32_16x16x32_bf16 v[248:251], v[60:63], v[136:139], v[248:251]
    s_waitcnt lgkmcnt(8)
    v_mfma_f32_16x16x32_bf16 v[220:223], v[64:67], v[128:131], v[220:223]
    v_mfma_f32_16x16x32_bf16 v[236:239], v[64:67], v[132:135], v[236:239]
    v_mfma_f32_16x16x32_bf16 v[252:255], v[64:67], v[136:139], v[252:255]
    s_bitcmp0_b32 s46, 1
    s_cbranch_scc1 Loj_30
    s_waitcnt vmcnt(0) lgkmcnt(0)
    v_mov_b32 v12, 163348
    v_mov_b32 v13, 1
    v_cmp_eq_u32 vcc, 0, v0
    s_nop 1
    s_and_saveexec_b64 s[4:5], vcc
    ds_add_rtn_u32 v13, v12, v13
    s_waitcnt lgkmcnt(0)
    s_mov_b64 exec, s[4:5]
    v_readfirstlane_b32 s6, v13
    s_nop 1
    s_cmp_lg_u32 s6, 3
    s_cbranch_scc1 Lop_31
    v_mov_b32 v12, s49
    v_mov_b32 v13, 0
    v_cmp_eq_u32 vcc, 0, v0
    v_mov_b32 v14, 1073741824
    s_nop 0
    v_cndmask_b32 v13, v14, v13, vcc
    s_lshl_b32 s4, s47, 8
    s_lshl_b32 s5, s48, 2
    s_add_u32 s4, s4, s5
    s_add_u32 s4, s4, 10575872
    buffer_store_dword v12, v13, s[20:23], s4 offen sc1
Lfl_32:
Lop_31:
Loj_30:
    ds_read_b64_tr_b16 v[52:53], v4 offset:61440
    ds_read_b64_tr_b16 v[54:55], v4 offset:63488
    ds_read_b64_tr_b16 v[56:57], v5 offset:61440
    ds_read_b64_tr_b16 v[58:59], v5 offset:63488
    ds_read_b64_tr_b16 v[60:61], v6 offset:61440
    ds_read_b64_tr_b16 v[62:63], v6 offset:63488
    ds_read_b64_tr_b16 v[64:65], v7 offset:61440
    ds_read_b64_tr_b16 v[66:67], v7 offset:63488
    s_waitcnt lgkmcnt(14)
    v_mfma_f32_16x16x32_bf16 v[208:211], v[80:83], v[140:143], v[208:211]
    v_mfma_f32_16x16x32_bf16 v[224:227], v[80:83], v[144:147], v[224:227]
    v_mfma_f32_16x16x32_bf16 v[240:243], v[80:83], v[148:151], v[240:243]
    s_waitcnt lgkmcnt(12)
    v_mfma_f32_16x16x32_bf16 v[212:215], v[84:87], v[140:143], v[212:215]
    v_mfma_f32_16x16x32_bf16 v[228:231], v[84:87], v[144:147], v[228:231]
    v_mfma_f32_16x16x32_bf16 v[244:247], v[84:87], v[148:151], v[244:247]
    s_waitcnt lgkmcnt(10)
    v_mfma_f32_16x16x32_bf16 v[216:219], v[88:91], v[140:143], v[216:219]
    v_mfma_f32_16x16x32_bf16 v[232:235], v[88:91], v[144:147], v[232:235]
    v_mfma_f32_16x16x32_bf16 v[248:251], v[88:91], v[148:151], v[248:251]
    s_waitcnt lgkmcnt(8)
    v_mfma_f32_16x16x32_bf16 v[220:223], v[92:95], v[140:143], v[220:223]
    v_mfma_f32_16x16x32_bf16 v[236:239], v[92:95], v[144:147], v[236:239]
    v_mfma_f32_16x16x32_bf16 v[252:255], v[92:95], v[148:151], v[252:255]
    s_waitcnt lgkmcnt(6)
    v_mfma_f32_16x16x32_bf16 v[208:211], v[52:55], v[16:19], v[208:211]
    v_mfma_f32_16x16x32_bf16 v[224:227], v[52:55], v[20:23], v[224:227]
    v_mfma_f32_16x16x32_bf16 v[240:243], v[52:55], v[24:27], v[240:243]
    s_waitcnt lgkmcnt(4)
    v_mfma_f32_16x16x32_bf16 v[212:215], v[56:59], v[16:19], v[212:215]
    v_mfma_f32_16x16x32_bf16 v[228:231], v[56:59], v[20:23], v[228:231]
    v_mfma_f32_16x16x32_bf16 v[244:247], v[56:59], v[24:27], v[244:247]
    s_waitcnt lgkmcnt(2)
    v_mfma_f32_16x16x32_bf16 v[216:219], v[60:63], v[16:19], v[216:219]
    v_mfma_f32_16x16x32_bf16 v[232:235], v[60:63], v[20:23], v[232:235]
    v_mfma_f32_16x16x32_bf16 v[248:251], v[60:63], v[24:27], v[248:251]
    s_waitcnt lgkmcnt(0)
    v_mfma_f32_16x16x32_bf16 v[220:223], v[64:67], v[16:19], v[220:223]
    v_mfma_f32_16x16x32_bf16 v[236:239], v[64:67], v[20:23], v[236:239]
    v_mfma_f32_16x16x32_bf16 v[252:255], v[64:67], v[24:27], v[252:255]
    v_sub_f32 v12, 1.0, v101
    v_pk_mul_f32 v[208:209], v[208:209], v[12:13] op_sel_hi:[1,0]
    v_pk_mul_f32 v[210:211], v[210:211], v[12:13] op_sel_hi:[1,0]
    v_pk_mul_f32 v[212:213], v[212:213], v[12:13] op_sel_hi:[1,0]
    v_pk_mul_f32 v[214:215], v[214:215], v[12:13] op_sel_hi:[1,0]
    v_pk_mul_f32 v[216:217], v[216:217], v[12:13] op_sel_hi:[1,0]
    v_pk_mul_f32 v[218:219], v[218:219], v[12:13] op_sel_hi:[1,0]
    v_pk_mul_f32 v[220:221], v[220:221], v[12:13] op_sel_hi:[1,0]
    v_pk_mul_f32 v[222:223], v[222:223], v[12:13] op_sel_hi:[1,0]
    v_sub_f32 v12, 1.0, v102
    v_pk_mul_f32 v[224:225], v[224:225], v[12:13] op_sel_hi:[1,0]
    v_pk_mul_f32 v[226:227], v[226:227], v[12:13] op_sel_hi:[1,0]
    v_pk_mul_f32 v[228:229], v[228:229], v[12:13] op_sel_hi:[1,0]
    v_pk_mul_f32 v[230:231], v[230:231], v[12:13] op_sel_hi:[1,0]
    v_pk_mul_f32 v[232:233], v[232:233], v[12:13] op_sel_hi:[1,0]
    v_pk_mul_f32 v[234:235], v[234:235], v[12:13] op_sel_hi:[1,0]
    v_pk_mul_f32 v[236:237], v[236:237], v[12:13] op_sel_hi:[1,0]
    v_pk_mul_f32 v[238:239], v[238:239], v[12:13] op_sel_hi:[1,0]
    v_sub_f32 v12, 1.0, v103
    v_pk_mul_f32 v[240:241], v[240:241], v[12:13] op_sel_hi:[1,0]
    v_pk_mul_f32 v[242:243], v[242:243], v[12:13] op_sel_hi:[1,0]
    v_pk_mul_f32 v[244:245], v[244:245], v[12:13] op_sel_hi:[1,0]
    v_pk_mul_f32 v[246:247], v[246:247], v[12:13] op_sel_hi:[1,0]
    v_pk_mul_f32 v[248:249], v[248:249], v[12:13] op_sel_hi:[1,0]
    v_pk_mul_f32 v[250:251], v[250:251], v[12:13] op_sel_hi:[1,0]
    v_pk_mul_f32 v[252:253], v[252:253], v[12:13] op_sel_hi:[1,0]
    v_pk_mul_f32 v[254:255], v[254:255], v[12:13] op_sel_hi:[1,0]
    v_and_b32 v12, 1, v0
    v_lshlrev_b32 v12, 2, v12
    v_bfe_u32 v13, v0, 1, 1
    v_lshl_add_u32 v12, v13, 8, v12
    s_lshl_b32 s56, s45, 9
    s_lshl_b32 s6, s53, 3
    s_add_u32 s56, s56, s6
    v_add_u32 v12, s56, v12
    v_cmp_gt_u32 vcc, 4, v0
    v_mov_b32 v13, 1073741824
    s_nop 0
    v_cndmask_b32 v12, v13, v12, vcc
    s_mov_b32 s4, 0
    s_mov_b32 s5, 10575872
    s_mov_b32 s7, 0xf
Lpoll_33:
    buffer_load_dword v10, v12, s[20:23], s5 offen sc1
    s_waitcnt vmcnt(0)
    v_cmp_eq_u32 vcc, s49, v10
    s_nop 1
    s_and_b32 s6, vcc_lo, s7
    s_cmp_eq_u32 s6, s7
    s_cbranch_scc1 Lpd_34
    s_add_u32 s4, s4, 1
    s_cmp_lt_u32 s4, 40000
    s_sleep 1
    s_cbranch_scc1 Lpoll_33
Lpd_34:
    s_mul_i32 s6, s55, 24
    s_mul_i32 s56, s53, 6
    s_add_u32 s6, s6, s56
    s_lshl_b32 s6, s6, 10
    s_add_u32 s56, s6, 11534336
    buffer_load_dwordx4 v[104:107], v100, s[20:23], s56 offen sc1
    s_add_u32 s56, s6, 11558912
    buffer_load_dwordx4 v[108:111], v100, s[20:23], s56 offen sc1
    s_add_u32 s56, s6, 11583488
    buffer_load_dwordx4 v[112:115], v100, s[20:23], s56 offen sc1
    s_add_u32 s56, s6, 11535360
    buffer_load_dwordx4 v[116:119], v100, s[20:23], s56 offen sc1
    s_add_u32 s56, s6, 11559936
    buffer_load_dwordx4 v[120:123], v100, s[20:23], s56 offen sc1
    s_add_u32 s56, s6, 11584512
    buffer_load_dwordx4 v[124:127], v100, s[20:23], s56 offen sc1
    s_add_u32 s56, s6, 11536384
    buffer_load_dwordx4 v[128:131], v100, s[20:23], s56 offen sc1
    s_add_u32 s56, s6, 11560960
    buffer_load_dwordx4 v[132:135], v100, s[20:23], s56 offen sc1
    s_add_u32 s56, s6, 11585536
    buffer_load_dwordx4 v[136:139], v100, s[20:23], s56 offen sc1
    s_add_u32 s56, s6, 11537408
    buffer_load_dwordx4 v[140:143], v100, s[20:23], s56 offen sc1
    s_add_u32 s56, s6, 11561984
    buffer_load_dwordx4 v[144:147], v100, s[20:23], s56 offen sc1
    s_add_u32 s56, s6, 11586560
    buffer_load_dwordx4 v[148:151], v100, s[20:23], s56 offen sc1
    s_add_u32 s56, s6, 11538432
    buffer_load_dwordx4 v[28:31], v100, s[20:23], s56 offen sc1
    s_add_u32 s56, s6, 11563008
    buffer_load_dwordx4 v[32:35], v100, s[20:23], s56 offen sc1
    s_add_u32 s56, s6, 11587584
    buffer_load_dwordx4 v[36:39], v100, s[20:23], s56 offen sc1
    s_add_u32 s56, s6, 11539456
    buffer_load_dwordx4 v[40:43], v100, s[20:23], s56 offen sc1
    s_add_u32 s56, s6, 11564032
    buffer_load_dwordx4 v[44:47], v100, s[20:23], s56 offen sc1
    s_add_u32 s56, s6, 11588608
    buffer_load_dwordx4 v[48:51], v100, s[20:23], s56 offen sc1
    ds_read_b64_tr_b16 v[80:81], v68
    ds_read_b64_tr_b16 v[82:83], v69
    v_xor_b32 v14, 32, v68
    ds_read_b64_tr_b16 v[84:85], v14
    v_xor_b32 v15, 32, v69
    ds_read_b64_tr_b16 v[86:87], v15
    v_xor_b32 v14, 64, v68
    ds_read_b64_tr_b16 v[88:89], v14
    v_xor_b32 v15, 64, v69
    ds_read_b64_tr_b16 v[90:91], v15
    v_xor_b32 v14, 96, v68
    ds_read_b64_tr_b16 v[92:93], v14
    v_xor_b32 v15, 96, v69
    ds_read_b64_tr_b16 v[94:95], v15
    ds_read_b64_tr_b16 v[52:53], v70
    ds_read_b64_tr_b16 v[54:55], v71
    v_xor_b32 v14, 32, v70
    ds_read_b64_tr_b16 v[56:57], v14
    v_xor_b32 v15, 32, v71
    ds_read_b64_tr_b16 v[58:59], v15
    v_xor_b32 v14, 64, v70
    ds_read_b64_tr_b16 v[60:61], v14
    v_xor_b32 v15, 64, v71
    ds_read_b64_tr_b16 v[62:63], v15
    v_xor_b32 v14, 96, v70
    ds_read_b64_tr_b16 v[64:65], v14
    v_xor_b32 v15, 96, v71
    ds_read_b64_tr_b16 v[66:67], v15
    s_waitcnt vmcnt(15)
    s_waitcnt lgkmcnt(14)
    v_mfma_f32_16x16x32_bf16 v[208:211], v[80:83], v[104:107], v[208:211]
    v_mfma_f32_16x16x32_bf16 v[224:227], v[80:83], v[108:111], v[224:227]
    v_mfma_f32_16x16x32_bf16 v[240:243], v[80:83], v[112:115], v[240:243]
    s_waitcnt lgkmcnt(12)
    v_mfma_f32_16x16x32_bf16 v[212:215], v[84:87], v[104:107], v[212:215]
    v_mfma_f32_16x16x32_bf16 v[228:231], v[84:87], v[108:111], v[228:231]
    v_mfma_f32_16x16x32_bf16 v[244:247], v[84:87], v[112:115], v[244:247]
    s_waitcnt lgkmcnt(10)
    v_mfma_f32_16x16x32_bf16 v[216:219], v[88:91], v[104:107], v[216:219]
    v_mfma_f32_16x16x32_bf16 v[232:235], v[88:91], v[108:111], v[232:235]
    v_mfma_f32_16x16x32_bf16 v[248:251], v[88:91], v[112:115], v[248:251]
    s_waitcnt lgkmcnt(8)
    v_mfma_f32_16x16x32_bf16 v[220:223], v[92:95], v[104:107], v[220:223]
    v_mfma_f32_16x16x32_bf16 v[236:239], v[92:95], v[108:111], v[236:239]
    v_mfma_f32_16x16x32_bf16 v[252:255], v[92:95], v[112:115], v[252:255]
    ds_read_b64_tr_b16 v[80:81], v72
    ds_read_b64_tr_b16 v[82:83], v73
    v_xor_b32 v14, 32, v72
    ds_read_b64_tr_b16 v[84:85], v14
    v_xor_b32 v15, 32, v73
    ds_read_b64_tr_b16 v[86:87], v15
    v_xor_b32 v14, 64, v72
    ds_read_b64_tr_b16 v[88:89], v14
    v_xor_b32 v15, 64, v73
    ds_read_b64_tr_b16 v[90:91], v15
    v_xor_b32 v14, 96, v72
    ds_read_b64_tr_b16 v[92:93], v14
    v_xor_b32 v15, 96, v73
    ds_read_b64_tr_b16 v[94:95], v15
    s_waitcnt vmcnt(12)
    s_waitcnt lgkmcnt(14)
    v_mfma_f32_16x16x32_bf16 v[208:211], v[52:55], v[116:119], v[208:211]
    v_mfma_f32_16x16x32_bf16 v[224:227], v[52:55], v[120:123], v[224:227]
    v_mfma_f32_16x16x32_bf16 v[240:243], v[52:55], v[124:127], v[240:243]
    s_waitcnt lgkmcnt(12)
    v_mfma_f32_16x16x32_bf16 v[212:215], v[56:59], v[116:119], v[212:215]
    v_mfma_f32_16x16x32_bf16 v[228:231], v[56:59], v[120:123], v[228:231]
    v_mfma_f32_16x16x32_bf16 v[244:247], v[56:59], v[124:127], v[244:247]
    s_waitcnt lgkmcnt(10)
    v_mfma_f32_16x16x32_bf16 v[216:219], v[60:63], v[116:119], v[216:219]
    v_mfma_f32_16x16x32_bf16 v[232:235], v[60:63], v[120:123], v[232:235]
    v_mfma_f32_16x16x32_bf16 v[248:251], v[60:63], v[124:127], v[248:251]
    s_waitcnt lgkmcnt(8)
    v_mfma_f32_16x16x32_bf16 v[220:223], v[64:67], v[116:119], v[220:223]
    v_mfma_f32_16x16x32_bf16 v[236:239], v[64:67], v[120:123], v[236:239]
    v_mfma_f32_16x16x32_bf16 v[252:255], v[64:67], v[124:127], v[252:255]
    ds_read_b64_tr_b16 v[52:53], v74
    ds_read_b64_tr_b16 v[54:55], v75
    v_xor_b32 v14, 32, v74
    ds_read_b64_tr_b16 v[56:57], v14
    v_xor_b32 v15, 32, v75
    ds_read_b64_tr_b16 v[58:59], v15
    v_xor_b32 v14, 64, v74
    ds_read_b64_tr_b16 v[60:61], v14
    v_xor_b32 v15, 64, v75
    ds_read_b64_tr_b16 v[62:63], v15
    v_xor_b32 v14, 96, v74
    ds_read_b64_tr_b16 v[64:65], v14
    v_xor_b32 v15, 96, v75
    ds_read_b64_tr_b16 v[66:67], v15
    s_waitcnt vmcnt(9)
    s_waitcnt lgkmcnt(14)
    v_mfma_f32_16x16x32_bf16 v[208:211], v[80:83], v[128:131], v[208:211]
    v_mfma_f32_16x16x32_bf16 v[224:227], v[80:83], v[132:135], v[224:227]
    v_mfma_f32_16x16x32_bf16 v[240:243], v[80:83], v[136:139], v[240:243]
    s_waitcnt lgkmcnt(12)
    v_mfma_f32_16x16x32_bf16 v[212:215], v[84:87], v[128:131], v[212:215]
    v_mfma_f32_16x16x32_bf16 v[228:231], v[84:87], v[132:135], v[228:231]
    v_mfma_f32_16x16x32_bf16 v[244:247], v[84:87], v[136:139], v[244:247]
    s_waitcnt lgkmcnt(10)
    v_mfma_f32_16x16x32_bf16 v[216:219], v[88:91], v[128:131], v[216:219]
    v_mfma_f32_16x16x32_bf16 v[232:235], v[88:91], v[132:135], v[232:235]
    v_mfma_f32_16x16x32_bf16 v[248:251], v[88:91], v[136:139], v[248:251]
    s_waitcnt lgkmcnt(8)
    v_mfma_f32_16x16x32_bf16 v[220:223], v[92:95], v[128:131], v[220:223]
    v_mfma_f32_16x16x32_bf16 v[236:239], v[92:95], v[132:135], v[236:239]
    v_mfma_f32_16x16x32_bf16 v[252:255], v[92:95], v[136:139], v[252:255]
    ds_read_b64_tr_b16 v[80:81], v76
    ds_read_b64_tr_b16 v[82:83], v77
    v_xor_b32 v14, 32, v76
    ds_read_b64_tr_b16 v[84:85], v14
    v_xor_b32 v15, 32, v77
    ds_read_b64_tr_b16 v[86:87], v15
    v_xor_b32 v14, 64, v76
    ds_read_b64_tr_b16 v[88:89], v14
    v_xor_b32 v15, 64, v77
    ds_read_b64_tr_b16 v[90:91], v15
    v_xor_b32 v14, 96, v76
    ds_read_b64_tr_b16 v[92:93], v14
    v_xor_b32 v15, 96, v77
    ds_read_b64_tr_b16 v[94:95], v15
    s_waitcnt vmcnt(6)
    s_waitcnt lgkmcnt(14)
    v_mfma_f32_16x16x32_bf16 v[208:211], v[52:55], v[140:143], v[208:211]
    v_mfma_f32_16x16x32_bf16 v[224:227], v[52:55], v[144:147], v[224:227]
    v_mfma_f32_16x16x32_bf16 v[240:243], v[52:55], v[148:151], v[240:243]
    s_waitcnt lgkmcnt(12)
    v_mfma_f32_16x16x32_bf16 v[212:215], v[56:59], v[140:143], v[212:215]
    v_mfma_f32_16x16x32_bf16 v[228:231], v[56:59], v[144:147], v[228:231]
    v_mfma_f32_16x16x32_bf16 v[244:247], v[56:59], v[148:151], v[244:247]
    s_waitcnt lgkmcnt(10)
    v_mfma_f32_16x16x32_bf16 v[216:219], v[60:63], v[140:143], v[216:219]
    v_mfma_f32_16x16x32_bf16 v[232:235], v[60:63], v[144:147], v[232:235]
    v_mfma_f32_16x16x32_bf16 v[248:251], v[60:63], v[148:151], v[248:251]
    s_waitcnt lgkmcnt(8)
    v_mfma_f32_16x16x32_bf16 v[220:223], v[64:67], v[140:143], v[220:223]
    v_mfma_f32_16x16x32_bf16 v[236:239], v[64:67], v[144:147], v[236:239]
    v_mfma_f32_16x16x32_bf16 v[252:255], v[64:67], v[148:151], v[252:255]
    ds_read_b64_tr_b16 v[52:53], v198
    ds_read_b64_tr_b16 v[54:55], v199
    v_xor_b32 v14, 32, v198
    ds_read_b64_tr_b16 v[56:57], v14
    v_xor_b32 v15, 32, v199
    ds_read_b64_tr_b16 v[58:59], v15
    v_xor_b32 v14, 64, v198
    ds_read_b64_tr_b16 v[60:61], v14
    v_xor_b32 v15, 64, v199
    ds_read_b64_tr_b16 v[62:63], v15
    v_xor_b32 v14, 96, v198
    ds_read_b64_tr_b16 v[64:65], v14
    v_xor_b32 v15, 96, v199
    ds_read_b64_tr_b16 v[66:67], v15
    s_waitcnt vmcnt(3)
    s_waitcnt lgkmcnt(14)
    v_mfma_f32_16x16x32_bf16 v[208:211], v[80:83], v[28:31], v[208:211]
    v_mfma_f32_16x16x32_bf16 v[224:227], v[80:83], v[32:35], v[224:227]
    v_mfma_f32_16x16x32_bf16 v[240:243], v[80:83], v[36:39], v[240:243]
    s_waitcnt lgkmcnt(12)
    v_mfma_f32_16x16x32_bf16 v[212:215], v[84:87], v[28:31], v[212:215]
    v_mfma_f32_16x16x32_bf16 v[228:231], v[84:87], v[32:35], v[228:231]
    v_mfma_f32_16x16x32_bf16 v[244:247], v[84:87], v[36:39], v[244:247]
    s_waitcnt lgkmcnt(10)
    v_mfma_f32_16x16x32_bf16 v[216:219], v[88:91], v[28:31], v[216:219]
    v_mfma_f32_16x16x32_bf16 v[232:235], v[88:91], v[32:35], v[232:235]
    v_mfma_f32_16x16x32_bf16 v[248:251], v[88:91], v[36:39], v[248:251]
    s_waitcnt lgkmcnt(8)
    v_mfma_f32_16x16x32_bf16 v[220:223], v[92:95], v[28:31], v[220:223]
    v_mfma_f32_16x16x32_bf16 v[236:239], v[92:95], v[32:35], v[236:239]
    v_mfma_f32_16x16x32_bf16 v[252:255], v[92:95], v[36:39], v[252:255]
    s_waitcnt vmcnt(0)
    s_waitcnt lgkmcnt(6)
    v_mfma_f32_16x16x32_bf16 v[208:211], v[52:55], v[40:43], v[208:211]
    v_mfma_f32_16x16x32_bf16 v[224:227], v[52:55], v[44:47], v[224:227]
    v_mfma_f32_16x16x32_bf16 v[240:243], v[52:55], v[48:51], v[240:243]
    s_waitcnt lgkmcnt(4)
    v_mfma_f32_16x16x32_bf16 v[212:215], v[56:59], v[40:43], v[212:215]
    v_mfma_f32_16x16x32_bf16 v[228:231], v[56:59], v[44:47], v[228:231]
    v_mfma_f32_16x16x32_bf16 v[244:247], v[56:59], v[48:51], v[244:247]
    s_waitcnt lgkmcnt(2)
    v_mfma_f32_16x16x32_bf16 v[216:219], v[60:63], v[40:43], v[216:219]
    v_mfma_f32_16x16x32_bf16 v[232:235], v[60:63], v[44:47], v[232:235]
    v_mfma_f32_16x16x32_bf16 v[248:251], v[60:63], v[48:51], v[248:251]
    s_waitcnt lgkmcnt(0)
    v_mfma_f32_16x16x32_bf16 v[220:223], v[64:67], v[40:43], v[220:223]
    v_mfma_f32_16x16x32_bf16 v[236:239], v[64:67], v[44:47], v[236:239]
    v_mfma_f32_16x16x32_bf16 v[252:255], v[64:67], v[48:51], v[252:255]
    s_barrier
    s_branch Lfin
LredC:
    s_waitcnt vmcnt(0)
    s_barrier
    s_branch Lred
Lload:
    s_bitcmp1_b32 s46, 1
    s_cbranch_scc1 LldB
    s_sub_u32 s52, s44, 4
    v_lshrrev_b32 v2, 3, v0
    v_and_b32 v3, 7, v0
    v_lshrrev_b32 v4, 4, v0
    s_lshl_b32 s53, s47, 2
    s_add_u32 s53, s53, s52
    s_mul_i32 s53, s53, 40960
    v_xor_b32 v5, v3, v4
    v_lshlrev_b32 v5, 4, v5
    v_mul_u32_u24 v6, 1280, v2
    v_add_u32 v6, s53, v6
    v_add_u32 v10, v6, v5
    v_xor_b32 v5, 64, v5
    v_add_u32 v11, v6, v5
    v_add_u32 v11, 10240, v11
    v_add_u32 v12, 20480, v10
    v_add_u32 v13, 20480, v11
    s_lshl_b32 s54, s52, 10
    s_lshl_b32 s55, s52, 12
    s_and_b32 s3, s46, 3
    s_mul_i32 s3, s3, 3
    s_lshr_b32 s4, s46, 2
    s_mul_i32 s4, s4, 1
    s_add_u32 s3, s3, s4
    s_cmp_ge_u32 s3, 10
    s_cselect_b32 s4, 10, 0
    s_sub_u32 s3, s3, s4
    s_cmp_ge_u32 s3, 10
    s_cselect_b32 s4, 10, 0
    s_sub_u32 s3, s3, s4
    s_lshl_b32 s56, s3, 7
    s_mul_i32 s57, s3, 245760
    s_mul_i32 s58, s3, 196608
    s_waitcnt lgkmcnt(0)
    s_mov_b32 s8, s64
    s_and_b32 s9, s65, 0xffff
    s_mov_b32 s10, 2621440
    s_mov_b32 s11, 0x00020000
    s_add_u32 m0, s55, 0
    s_nop 0
    buffer_load_dwordx4 v10, s[8:11], s56 offen lds
    s_add_u32 m0, s55, 1024
    s_nop 0
    buffer_load_dwordx4 v11, s[8:11], s56 offen lds
    s_add_u32 m0, s55, 2048
    s_nop 0
    buffer_load_dwordx4 v12, s[8:11], s56 offen lds
    s_add_u32 m0, s55, 3072
    s_nop 0
    buffer_load_dwordx4 v13, s[8:11], s56 offen lds
    s_mov_b32 s12, s66
    s_and_b32 s13, s67, 0xffff
    s_mov_b32 s14, 2457600
    s_mov_b32 s15, 0x00020000
    s_mul_i32 s59, s48, 160
    s_add_u32 s59, s59, 1280
    s_mov_b32 s60, 6554
    s_mov_b32 s61, 3840
    s_add_u32 s62, s52, 0
    s_cmp_ge_u32 s62, 10
    s_cselect_b32 s63, 10, 0
    s_cselect_b32 s50, 1280, 0
    s_sub_u32 s62, s62, s63
    s_lshl_b32 s62, s62, 6
    v_add_u32 v5, s62, v0
    v_mul_lo_u32 v6, v5, s60
    v_lshrrev_b32 v6, 16, v6
    v_mul_u32_u24 v7, 10, v6
    v_sub_u32 v7, v5, v7
    v_and_b32 v9, 4, v6
    v_and_b32 v19, 8, v6
    v_and_b32 v8, 0x33, v6
    v_lshl_or_b32 v8, v9, 1, v8
    v_lshrrev_b32 v19, 1, v19
    v_or_b32 v8, v8, v19
    v_mul_lo_u32 v8, v8, s61
    v_lshl_add_u32 v8, v7, 4, v8
    s_add_u32 s50, s50, s59
    v_add_u32 v14, s50, v8
    s_add_u32 m0, s54, 16384
    s_nop 0
    buffer_load_dwordx4 v14, s[12:15], s57 offen lds
    s_add_u32 s62, s52, 4
    s_cmp_ge_u32 s62, 10
    s_cselect_b32 s63, 10, 0
    s_cselect_b32 s50, 1280, 0
    s_sub_u32 s62, s62, s63
    s_lshl_b32 s62, s62, 6
    v_add_u32 v5, s62, v0
    v_mul_lo_u32 v6, v5, s60
    v_lshrrev_b32 v6, 16, v6
    v_mul_u32_u24 v7, 10, v6
    v_sub_u32 v7, v5, v7
    v_and_b32 v9, 4, v6
    v_and_b32 v19, 8, v6
    v_and_b32 v8, 0x33, v6
    v_lshl_or_b32 v8, v9, 1, v8
    v_lshrrev_b32 v19, 1, v19
    v_or_b32 v8, v8, v19
    v_mul_lo_u32 v8, v8, s61
    v_lshl_add_u32 v8, v7, 4, v8
    s_add_u32 s50, s50, s59
    v_add_u32 v15, s50, v8
    s_add_u32 m0, s54, 20480
    s_nop 0
    buffer_load_dwordx4 v15, s[12:15], s57 offen lds
    s_add_u32 s62, s52, 8
    s_cmp_ge_u32 s62, 10
    s_cselect_b32 s63, 10, 0
    s_cselect_b32 s50, 1280, 0
    s_sub_u32 s62, s62, s63
    s_lshl_b32 s62, s62, 6
    v_add_u32 v5, s62, v0
    v_mul_lo_u32 v6, v5, s60
    v_lshrrev_b32 v6, 16, v6
    v_mul_u32_u24 v7, 10, v6
    v_sub_u32 v7, v5, v7
    v_and_b32 v9, 4, v6
    v_and_b32 v19, 8, v6
    v_and_b32 v8, 0x33, v6
    v_lshl_or_b32 v8, v9, 1, v8
    v_lshrrev_b32 v19, 1, v19
    v_or_b32 v8, v8, v19
    v_mul_lo_u32 v8, v8, s61
    v_lshl_add_u32 v8, v7, 4, v8
    s_add_u32 s50, s50, s59
    v_add_u32 v16, s50, v8
    s_add_u32 m0, s54, 24576
    s_nop 0
    buffer_load_dwordx4 v16, s[12:15], s57 offen lds
    s_add_u32 s62, s52, 12
    s_cmp_ge_u32 s62, 10
    s_cselect_b32 s63, 10, 0
    s_cselect_b32 s50, 1280, 0
    s_sub_u32 s62, s62, s63
    s_lshl_b32 s62, s62, 6
    v_add_u32 v5, s62, v0
    v_mul_lo_u32 v6, v5, s60
    v_lshrrev_b32 v6, 16, v6
    v_mul_u32_u24 v7, 10, v6
    v_sub_u32 v7, v5, v7
    v_and_b32 v9, 4, v6
    v_and_b32 v19, 8, v6
    v_and_b32 v8, 0x33, v6
    v_lshl_or_b32 v8, v9, 1, v8
    v_lshrrev_b32 v19, 1, v19
    v_or_b32 v8, v8, v19
    v_mul_lo_u32 v8, v8, s61
    v_lshl_add_u32 v8, v7, 4, v8
    s_add_u32 s50, s50, s59
    v_add_u32 v17, s50, v8
    s_add_u32 m0, s54, 28672
    s_nop 0
    buffer_load_dwordx4 v17, s[12:15], s57 offen lds
    s_add_u32 s62, s52, 16
    s_cmp_ge_u32 s62, 10
    s_cselect_b32 s63, 10, 0
    s_cselect_b32 s50, 1280, 0
    s_sub_u32 s62, s62, s63
    s_lshl_b32 s62, s62, 6
    v_add_u32 v5, s62, v0
    v_mul_lo_u32 v6, v5, s60
    v_lshrrev_b32 v6, 16, v6
    v_mul_u32_u24 v7, 10, v6
    v_sub_u32 v7, v5, v7
    v_and_b32 v9, 4, v6
    v_and_b32 v19, 8, v6
    v_and_b32 v8, 0x33, v6
    v_lshl_or_b32 v8, v9, 1, v8
    v_lshrrev_b32 v19, 1, v19
    v_or_b32 v8, v8, v19
    v_mul_lo_u32 v8, v8, s61
    v_lshl_add_u32 v8, v7, 4, v8
    s_add_u32 s50, s50, s59
    v_add_u32 v18, s50, v8
    s_add_u32 m0, s54, 32768
    s_nop 0
    buffer_load_dwordx4 v18, s[12:15], s57 offen lds
    s_mov_b32 s16, s72
    s_and_b32 s17, s73, 0xffff
    s_mov_b32 s18, 1966080
    s_mov_b32 s19, 0x00020000
    v_lshlrev_b32 v5, 1, v4
    v_xor_b32 v5, v3, v5
    v_lshlrev_b32 v5, 4, v5
    s_lshl_b32 s59, s48, 7
    s_mov_b32 s61, 3072
    s_add_u32 s62, s52, 0
    s_lshl_b32 s62, s62, 3
    v_add_u32 v6, s62, v2
    v_and_b32 v9, 4, v6
    v_and_b32 v19, 8, v6
    v_and_b32 v8, 0x33, v6
    v_lshl_or_b32 v8, v9, 1, v8
    v_lshrrev_b32 v19, 1, v19
    v_or_b32 v8, v8, v19
    v_mul_lo_u32 v8, v8, s61
    v_add_u32 v8, v8, v5
    v_add_u32 v20, s59, v8
    s_add_u32 s62, s52, 4
    s_lshl_b32 s62, s62, 3
    v_add_u32 v6, s62, v2
    v_and_b32 v9, 4, v6
    v_and_b32 v19, 8, v6
    v_and_b32 v8, 0x33, v6
    v_lshl_or_b32 v8, v9, 1, v8
    v_lshrrev_b32 v19, 1, v19
    v_or_b32 v8, v8, v19
    v_mul_lo_u32 v8, v8, s61
    v_add_u32 v8, v8, v5
    v_add_u32 v21, s59, v8
    s_add_u32 m0, s54, 36864
    s_nop 0
    buffer_load_dwordx4 v20, s[16:19], s58 offen lds
    s_add_u32 m0, s54, 40960
    s_nop 0
    buffer_load_dwordx4 v21, s[16:19], s58 offen lds
    s_mov_b32 s20, s82
    s_and_b32 s21, s83, 0xffff
    s_mov_b32 s22, 15204352
    s_mov_b32 s23, 0x00020000
    s_mov_b32 s24, s76
    s_and_b32 s25, s77, 0xffff
    s_mov_b32 s26, 1280
    s_mov_b32 s27, 0x00020000
    s_mov_b32 s28, s74
    s_and_b32 s29, s75, 0xffff
    s_mov_b32 s30, 1966080
    s_mov_b32 s31, 0x00020000
    s_mov_b32 s32, s68
    s_and_b32 s33, s69, 0xffff
    s_mov_b32 s34, 819200
    s_mov_b32 s35, 0x00020000
    s_mov_b32 s36, s78
    s_and_b32 s37, s79, 0xffff
    s_mov_b32 s38, 2621440
    s_mov_b32 s39, 0x00020000
    s_add_u32 s56, s56, 128
    s_add_u32 s57, s57, 245760
    s_add_u32 s58, s58, 196608
    s_cmp_ge_u32 s56, 1280
    s_cselect_b32 s56, 0, s56
    s_cselect_b32 s57, 0, s57
    s_cselect_b32 s58, 0, s58
    s_add_u32 s54, s54, 45056
    s_add_u32 s55, s55, 45056
    s_cmp_ge_u32 s54, 135168
    s_cselect_b32 s62, 135168, 0
    s_sub_u32 s54, s54, s62
    s_sub_u32 s55, s55, s62
    s_add_u32 m0, s55, 0
    s_nop 0
    buffer_load_dwordx4 v10, s[8:11], s56 offen lds
    s_add_u32 m0, s55, 1024
    s_nop 0
    buffer_load_dwordx4 v11, s[8:11], s56 offen lds
    s_add_u32 m0, s55, 2048
    s_nop 0
    buffer_load_dwordx4 v12, s[8:11], s56 offen lds
    s_add_u32 m0, s55, 3072
    s_nop 0
    buffer_load_dwordx4 v13, s[8:11], s56 offen lds
    s_add_u32 m0, s54, 16384
    s_nop 0
    buffer_load_dwordx4 v14, s[12:15], s57 offen lds
    s_add_u32 m0, s54, 20480
    s_nop 0
    buffer_load_dwordx4 v15, s[12:15], s57 offen lds
    s_add_u32 m0, s54, 24576
    s_nop 0
    buffer_load_dwordx4 v16, s[12:15], s57 offen lds
    s_add_u32 m0, s54, 28672
    s_nop 0
    buffer_load_dwordx4 v17, s[12:15], s57 offen lds
    s_add_u32 m0, s54, 32768
    s_nop 0
    buffer_load_dwordx4 v18, s[12:15], s57 offen lds
    s_add_u32 m0, s54, 36864
    s_nop 0
    buffer_load_dwordx4 v20, s[16:19], s58 offen lds
    s_add_u32 m0, s54, 40960
    s_nop 0
    buffer_load_dwordx4 v21, s[16:19], s58 offen lds
    s_waitcnt vmcnt(11)
    s_barrier
    s_add_u32 s56, s56, 128
    s_add_u32 s57, s57, 245760
    s_add_u32 s58, s58, 196608
    s_cmp_ge_u32 s56, 1280
    s_cselect_b32 s56, 0, s56
    s_cselect_b32 s57, 0, s57
    s_cselect_b32 s58, 0, s58
    s_add_u32 s54, s54, 45056
    s_add_u32 s55, s55, 45056
    s_cmp_ge_u32 s54, 135168
    s_cselect_b32 s62, 135168, 0
    s_sub_u32 s54, s54, s62
    s_sub_u32 s55, s55, s62
    s_add_u32 m0, s55, 0
    s_nop 0
    buffer_load_dwordx4 v10, s[8:11], s56 offen lds
    s_add_u32 m0, s55, 1024
    s_nop 0
    buffer_load_dwordx4 v11, s[8:11], s56 offen lds
    s_add_u32 m0, s55, 2048
    s_nop 0
    buffer_load_dwordx4 v12, s[8:11], s56 offen lds
    s_add_u32 m0, s55, 3072
    s_nop 0
    buffer_load_dwordx4 v13, s[8:11], s56 offen lds
    s_add_u32 m0, s54, 16384
    s_nop 0
    buffer_load_dwordx4 v14, s[12:15], s57 offen lds
    s_add_u32 m0, s54, 20480
    s_nop 0
    buffer_load_dwordx4 v15, s[12:15], s57 offen lds
    s_add_u32 m0, s54, 24576
    s_nop 0
    buffer_load_dwordx4 v16, s[12:15], s57 offen lds
    s_add_u32 m0, s54, 28672
    s_nop 0
    buffer_load_dwordx4 v17, s[12:15], s57 offen lds
    s_add_u32 m0, s54, 32768
    s_nop 0
    buffer_load_dwordx4 v18, s[12:15], s57 offen lds
    s_add_u32 m0, s54, 36864
    s_nop 0
    buffer_load_dwordx4 v20, s[16:19], s58 offen lds
    s_add_u32 m0, s54, 40960
    s_nop 0
    buffer_load_dwordx4 v21, s[16:19], s58 offen lds
    v_mov_b32 v25, 1073741824
    s_cmp_eq_u32 s52, 1
    s_cbranch_scc1 Lwu_35
    s_cmp_eq_u32 s52, 2
    s_cbranch_scc1 Lwu_36
    s_cmp_eq_u32 s52, 3
    s_cbranch_scc1 Lwu_37
    s_getpc_b64 s[4:5]
Lpc_A:
    s_sub_u32 s4, s4, Lpc_A-gated_mix__linear_attn_block__dense_activation_relu__prompt_kernel
    s_subb_u32 s5, s5, 0
    v_and_b32 v26, 15, v0
    s_lshl_b32 s6, s46, 4
    v_add_u32 v26, s6, v26
    v_lshlrev_b32 v26, 7, v26
    v_min_u32 v26, Lcode_end-gated_mix__linear_attn_block__dense_activation_relu__prompt_kernel-4, v26
    global_load_dword v24, v26, s[4:5]
    buffer_load_dword v24, v25, s[20:23], 0 offen
    s_branch Lwu_38
Lwu_35:
    v_lshlrev_b32 v26, 7, v0
    v_cmp_gt_u32 vcc, 60, v0
    s_nop 1
    v_cndmask_b32 v27, v25, v26, vcc
    s_mul_i32 s6, s2, 7680
    buffer_load_dword v24, v27, s[28:31], s6 offen
    v_cmp_gt_u32 vcc, 25, v0
    s_nop 1
    v_cndmask_b32 v27, v25, v26, vcc
    s_mul_i32 s6, s2, 3200
    buffer_load_dword v24, v27, s[32:35], s6 offen
    s_branch Lwu_38
Lwu_36:
    v_lshlrev_b32 v26, 21, v0
    v_min_u32 v26, 1073741824, v26
    buffer_load_dword v24, v26, s[20:23], 0 offen
    buffer_load_dword v24, v26, s[36:39], 0 offen
    s_branch Lwu_38
Lwu_37:
    buffer_load_dword v24, v25, s[20:23], 0 offen
    buffer_load_dword v24, v25, s[20:23], 0 offen
Lwu_38:
    s_waitcnt vmcnt(13)
    s_barrier
    s_add_u32 s56, s56, 128
    s_add_u32 s57, s57, 245760
    s_add_u32 s58, s58, 196608
    s_cmp_ge_u32 s56, 1280
    s_cselect_b32 s56, 0, s56
    s_cselect_b32 s57, 0, s57
    s_cselect_b32 s58, 0, s58
    s_add_u32 s54, s54, 45056
    s_add_u32 s55, s55, 45056
    s_cmp_ge_u32 s54, 135168
    s_cselect_b32 s62, 135168, 0
    s_sub_u32 s54, s54, s62
    s_sub_u32 s55, s55, s62
    s_add_u32 m0, s55, 0
    s_nop 0
    buffer_load_dwordx4 v10, s[8:11], s56 offen lds
    s_add_u32 m0, s55, 1024
    s_nop 0
    buffer_load_dwordx4 v11, s[8:11], s56 offen lds
    s_add_u32 m0, s55, 2048
    s_nop 0
    buffer_load_dwordx4 v12, s[8:11], s56 offen lds
    s_add_u32 m0, s55, 3072
    s_nop 0
    buffer_load_dwordx4 v13, s[8:11], s56 offen lds
    s_add_u32 m0, s54, 16384
    s_nop 0
    buffer_load_dwordx4 v14, s[12:15], s57 offen lds
    s_add_u32 m0, s54, 20480
    s_nop 0
    buffer_load_dwordx4 v15, s[12:15], s57 offen lds
    s_add_u32 m0, s54, 24576
    s_nop 0
    buffer_load_dwordx4 v16, s[12:15], s57 offen lds
    s_add_u32 m0, s54, 28672
    s_nop 0
    buffer_load_dwordx4 v17, s[12:15], s57 offen lds
    s_add_u32 m0, s54, 32768
    s_nop 0
    buffer_load_dwordx4 v18, s[12:15], s57 offen lds
    s_add_u32 m0, s54, 36864
    s_nop 0
    buffer_load_dwordx4 v20, s[16:19], s58 offen lds
    s_add_u32 m0, s54, 40960
    s_nop 0
    buffer_load_dwordx4 v21, s[16:19], s58 offen lds
    s_waitcnt vmcnt(13)
    s_barrier
    s_add_u32 s56, s56, 128
    s_add_u32 s57, s57, 245760
    s_add_u32 s58, s58, 196608
    s_cmp_ge_u32 s56, 1280
    s_cselect_b32 s56, 0, s56
    s_cselect_b32 s57, 0, s57
    s_cselect_b32 s58, 0, s58
    s_add_u32 s54, s54, 45056
    s_add_u32 s55, s55, 45056
    s_cmp_ge_u32 s54, 135168
    s_cselect_b32 s62, 135168, 0
    s_sub_u32 s54, s54, s62
    s_sub_u32 s55, s55, s62
    s_add_u32 m0, s55, 0
    s_nop 0
    buffer_load_dwordx4 v10, s[8:11], s56 offen lds
    s_add_u32 m0, s55, 1024
    s_nop 0
    buffer_load_dwordx4 v11, s[8:11], s56 offen lds
    s_add_u32 m0, s55, 2048
    s_nop 0
    buffer_load_dwordx4 v12, s[8:11], s56 offen lds
    s_add_u32 m0, s55, 3072
    s_nop 0
    buffer_load_dwordx4 v13, s[8:11], s56 offen lds
    s_add_u32 m0, s54, 16384
    s_nop 0
    buffer_load_dwordx4 v14, s[12:15], s57 offen lds
    s_add_u32 m0, s54, 20480
    s_nop 0
    buffer_load_dwordx4 v15, s[12:15], s57 offen lds
    s_add_u32 m0, s54, 24576
    s_nop 0
    buffer_load_dwordx4 v16, s[12:15], s57 offen lds
    s_add_u32 m0, s54, 28672
    s_nop 0
    buffer_load_dwordx4 v17, s[12:15], s57 offen lds
    s_add_u32 m0, s54, 32768
    s_nop 0
    buffer_load_dwordx4 v18, s[12:15], s57 offen lds
    s_add_u32 m0, s54, 36864
    s_nop 0
    buffer_load_dwordx4 v20, s[16:19], s58 offen lds
    s_add_u32 m0, s54, 40960
    s_nop 0
    buffer_load_dwordx4 v21, s[16:19], s58 offen lds
    s_mov_b32 s63, 3
Lld_39:
    s_waitcnt vmcnt(11)
    s_barrier
    s_add_u32 s56, s56, 128
    s_add_u32 s57, s57, 245760
    s_add_u32 s58, s58, 196608
    s_cmp_ge_u32 s56, 1280
    s_cselect_b32 s56, 0, s56
    s_cselect_b32 s57, 0, s57
    s_cselect_b32 s58, 0, s58
    s_add_u32 s54, s54, 45056
    s_add_u32 s55, s55, 45056
    s_cmp_ge_u32 s54, 135168
    s_cselect_b32 s62, 135168, 0
    s_sub_u32 s54, s54, s62
    s_sub_u32 s55, s55, s62
    s_add_u32 m0, s55, 0
    s_nop 0
    buffer_load_dwordx4 v10, s[8:11], s56 offen lds
    s_add_u32 m0, s55, 1024
    s_nop 0
    buffer_load_dwordx4 v11, s[8:11], s56 offen lds
    s_add_u32 m0, s55, 2048
    s_nop 0
    buffer_load_dwordx4 v12, s[8:11], s56 offen lds
    s_add_u32 m0, s55, 3072
    s_nop 0
    buffer_load_dwordx4 v13, s[8:11], s56 offen lds
    s_add_u32 m0, s54, 16384
    s_nop 0
    buffer_load_dwordx4 v14, s[12:15], s57 offen lds
    s_add_u32 m0, s54, 20480
    s_nop 0
    buffer_load_dwordx4 v15, s[12:15], s57 offen lds
    s_add_u32 m0, s54, 24576
    s_nop 0
    buffer_load_dwordx4 v16, s[12:15], s57 offen lds
    s_add_u32 m0, s54, 28672
    s_nop 0
    buffer_load_dwordx4 v17, s[12:15], s57 offen lds
    s_add_u32 m0, s54, 32768
    s_nop 0
    buffer_load_dwordx4 v18, s[12:15], s57 offen lds
    s_add_u32 m0, s54, 36864
    s_nop 0
    buffer_load_dwordx4 v20, s[16:19], s58 offen lds
    s_add_u32 m0, s54, 40960
    s_nop 0
    buffer_load_dwordx4 v21, s[16:19], s58 offen lds
    s_add_u32 s63, s63, 1
    s_cmp_le_u32 s63, 7
    s_cbranch_scc1 Lld_39
    s_branch Lldtail
LldB:
    s_sub_u32 s52, s44, 4
    v_lshrrev_b32 v2, 3, v0
    v_and_b32 v3, 7, v0
    v_lshrrev_b32 v4, 4, v0
    s_lshl_b32 s53, s47, 2
    s_add_u32 s53, s53, s52
    s_mul_i32 s53, s53, 40960
    v_xor_b32 v5, v3, v4
    v_lshlrev_b32 v5, 4, v5
    v_mul_u32_u24 v6, 1280, v2
    v_add_u32 v6, s53, v6
    v_add_u32 v10, v6, v5
    v_xor_b32 v5, 64, v5
    v_add_u32 v11, v6, v5
    v_add_u32 v11, 10240, v11
    v_add_u32 v12, 20480, v10
    v_add_u32 v13, 20480, v11
    s_lshl_b32 s54, s52, 10
    s_lshl_b32 s55, s52, 12
    s_and_b32 s3, s46, 3
    s_mul_i32 s3, s3, 3
    s_lshr_b32 s4, s46, 2
    s_mul_i32 s4, s4, 1
    s_add_u32 s3, s3, s4
    s_cmp_ge_u32 s3, 10
    s_cselect_b32 s4, 10, 0
    s_sub_u32 s3, s3, s4
    s_cmp_ge_u32 s3, 10
    s_cselect_b32 s4, 10, 0
    s_sub_u32 s3, s3, s4
    s_lshl_b32 s56, s3, 7
    s_mul_i32 s57, s3, 245760
    s_mul_i32 s58, s3, 196608
    s_waitcnt lgkmcnt(0)
    s_mov_b32 s8, s64
    s_and_b32 s9, s65, 0xffff
    s_mov_b32 s10, 2621440
    s_mov_b32 s11, 0x00020000
    s_add_u32 m0, s55, 0
    s_nop 0
    buffer_load_dwordx4 v10, s[8:11], s56 offen lds
    s_add_u32 m0, s55, 1024
    s_nop 0
    buffer_load_dwordx4 v11, s[8:11], s56 offen lds
    s_add_u32 m0, s55, 2048
    s_nop 0
    buffer_load_dwordx4 v12, s[8:11], s56 offen lds
    s_add_u32 m0, s55, 3072
    s_nop 0
    buffer_load_dwordx4 v13, s[8:11], s56 offen lds
    s_mov_b32 s12, s66
    s_and_b32 s13, s67, 0xffff
    s_mov_b32 s14, 2457600
    s_mov_b32 s15, 0x00020000
    s_mul_i32 s59, s48, 160
    s_mov_b32 s60, 6554
    s_mov_b32 s61, 3840
    s_add_u32 s62, s52, 0
    s_lshl_b32 s62, s62, 6
    v_add_u32 v5, s62, v0
    v_mul_lo_u32 v6, v5, s60
    v_lshrrev_b32 v6, 16, v6
    v_mul_u32_u24 v7, 10, v6
    v_sub_u32 v7, v5, v7
    v_and_b32 v9, 4, v6
    v_and_b32 v19, 8, v6
    v_and_b32 v8, 0x33, v6
    v_lshl_or_b32 v8, v9, 1, v8
    v_lshrrev_b32 v19, 1, v19
    v_or_b32 v8, v8, v19
    v_mul_lo_u32 v8, v8, s61
    v_lshl_add_u32 v8, v7, 4, v8
    v_add_u32 v14, s59, v8
    s_add_u32 m0, s54, 16384
    s_nop 0
    buffer_load_dwordx4 v14, s[12:15], s57 offen lds
    s_add_u32 s62, s52, 4
    s_lshl_b32 s62, s62, 6
    v_add_u32 v5, s62, v0
    v_mul_lo_u32 v6, v5, s60
    v_lshrrev_b32 v6, 16, v6
    v_mul_u32_u24 v7, 10, v6
    v_sub_u32 v7, v5, v7
    v_and_b32 v9, 4, v6
    v_and_b32 v19, 8, v6
    v_and_b32 v8, 0x33, v6
    v_lshl_or_b32 v8, v9, 1, v8
    v_lshrrev_b32 v19, 1, v19
    v_or_b32 v8, v8, v19
    v_mul_lo_u32 v8, v8, s61
    v_lshl_add_u32 v8, v7, 4, v8
    v_add_u32 v15, s59, v8
    s_add_u32 m0, s54, 20480
    s_nop 0
    buffer_load_dwordx4 v15, s[12:15], s57 offen lds
    s_add_u32 s62, s52, 8
    s_lshl_b32 s62, s62, 6
    v_add_u32 v5, s62, v0
    v_mul_lo_u32 v6, v5, s60
    v_lshrrev_b32 v6, 16, v6
    v_mul_u32_u24 v7, 10, v6
    v_sub_u32 v7, v5, v7
    v_and_b32 v9, 4, v6
    v_and_b32 v19, 8, v6
    v_and_b32 v8, 0x33, v6
    v_lshl_or_b32 v8, v9, 1, v8
    v_lshrrev_b32 v19, 1, v19
    v_or_b32 v8, v8, v19
    v_mul_lo_u32 v8, v8, s61
    v_lshl_add_u32 v8, v7, 4, v8
    v_add_u32 v16, s59, v8
    s_cmp_ge_u32 s52, 2
    s_cselect_b32 s50, 1073741824, 0
    v_add_u32 v16, s50, v16
    s_add_u32 m0, s54, 24576
    s_nop 0
    buffer_load_dwordx4 v16, s[12:15], s57 offen lds
    s_mov_b32 s16, s72
    s_and_b32 s17, s73, 0xffff
    s_mov_b32 s18, 1966080
    s_mov_b32 s19, 0x00020000
    v_lshlrev_b32 v5, 1, v4
    v_xor_b32 v5, v3, v5
    v_lshlrev_b32 v5, 4, v5
    s_lshl_b32 s59, s48, 8
    s_add_u32 s59, s59, 1024
    s_mov_b32 s61, 3072
    s_add_u32 s62, s52, 0
    s_lshl_b32 s62, s62, 3
    v_add_u32 v6, s62, v2
    v_and_b32 v9, 4, v6
    v_and_b32 v19, 8, v6
    v_and_b32 v8, 0x33, v6
    v_lshl_or_b32 v8, v9, 1, v8
    v_lshrrev_b32 v19, 1, v19
    v_or_b32 v8, v8, v19
    v_mul_lo_u32 v8, v8, s61
    v_add_u32 v8, v8, v5
    v_add_u32 v20, s59, v8
    v_add_u32 v22, 128, v20
    s_add_u32 s62, s52, 4
    s_lshl_b32 s62, s62, 3
    v_add_u32 v6, s62, v2
    v_and_b32 v9, 4, v6
    v_and_b32 v19, 8, v6
    v_and_b32 v8, 0x33, v6
    v_lshl_or_b32 v8, v9, 1, v8
    v_lshrrev_b32 v19, 1, v19
    v_or_b32 v8, v8, v19
    v_mul_lo_u32 v8, v8, s61
    v_add_u32 v8, v8, v5
    v_add_u32 v21, s59, v8
    v_add_u32 v23, 128, v21
    s_add_u32 m0, s54, 28672
    s_nop 0
    buffer_load_dwordx4 v20, s[16:19], s58 offen lds
    s_add_u32 m0, s54, 32768
    s_nop 0
    buffer_load_dwordx4 v21, s[16:19], s58 offen lds
    s_add_u32 m0, s54, 36864
    s_nop 0
    buffer_load_dwordx4 v22, s[16:19], s58 offen lds
    s_add_u32 m0, s54, 40960
    s_nop 0
    buffer_load_dwordx4 v23, s[16:19], s58 offen lds
    s_mov_b32 s20, s82
    s_and_b32 s21, s83, 0xffff
    s_mov_b32 s22, 15204352
    s_mov_b32 s23, 0x00020000
    s_mov_b32 s24, s76
    s_and_b32 s25, s77, 0xffff
    s_mov_b32 s26, 1280
    s_mov_b32 s27, 0x00020000
    s_mov_b32 s28, s74
    s_and_b32 s29, s75, 0xffff
    s_mov_b32 s30, 1966080
    s_mov_b32 s31, 0x00020000
    s_mov_b32 s32, s68
    s_and_b32 s33, s69, 0xffff
    s_mov_b32 s34, 819200
    s_mov_b32 s35, 0x00020000
    s_mov_b32 s36, s78
    s_and_b32 s37, s79, 0xffff
    s_mov_b32 s38, 2621440
    s_mov_b32 s39, 0x00020000
    s_cmp_lg_u32 s52, 0
    s_cbranch_scc1 Lgw_40
    v_lshlrev_b32 v5, 4, v0
    s_mov_b32 m0, 135168
    v_add_u32 v6, 1024, v5
    buffer_load_dwordx4 v5, s[24:27], 0 offen lds
    s_mov_b32 m0, 136192
    s_nop 0
    buffer_load_dwordx4 v6, s[24:27], 0 offen lds
Lgw_40:
    s_add_u32 s56, s56, 128
    s_add_u32 s57, s57, 245760
    s_add_u32 s58, s58, 196608
    s_cmp_ge_u32 s56, 1280
    s_cselect_b32 s56, 0, s56
    s_cselect_b32 s57, 0, s57
    s_cselect_b32 s58, 0, s58
    s_add_u32 s54, s54, 45056
    s_add_u32 s55, s55, 45056
    s_cmp_ge_u32 s54, 135168
    s_cselect_b32 s62, 135168, 0
    s_sub_u32 s54, s54, s62
    s_sub_u32 s55, s55, s62
    s_add_u32 m0, s55, 0
    s_nop 0
    buffer_load_dwordx4 v10, s[8:11], s56 offen lds
    s_add_u32 m0, s55, 1024
    s_nop 0
    buffer_load_dwordx4 v11, s[8:11], s56 offen lds
    s_add_u32 m0, s55, 2048
    s_nop 0
    buffer_load_dwordx4 v12, s[8:11], s56 offen lds
    s_add_u32 m0, s55, 3072
    s_nop 0
    buffer_load_dwordx4 v13, s[8:11], s56 offen lds
    s_add_u32 m0, s54, 16384
    s_nop 0
    buffer_load_dwordx4 v14, s[12:15], s57 offen lds
    s_add_u32 m0, s54, 20480
    s_nop 0
    buffer_load_dwordx4 v15, s[12:15], s57 offen lds
    s_add_u32 m0, s54, 24576
    s_nop 0
    buffer_load_dwordx4 v16, s[12:15], s57 offen lds
    s_add_u32 m0, s54, 28672
    s_nop 0
    buffer_load_dwordx4 v20, s[16:19], s58 offen lds
    s_add_u32 m0, s54, 32768
    s_nop 0
    buffer_load_dwordx4 v21, s[16:19], s58 offen lds
    s_add_u32 m0, s54, 36864
    s_nop 0
    buffer_load_dwordx4 v22, s[16:19], s58 offen lds
    s_add_u32 m0, s54, 40960
    s_nop 0
    buffer_load_dwordx4 v23, s[16:19], s58 offen lds
    s_waitcnt vmcnt(11)
    s_barrier
    s_add_u32 s56, s56, 128
    s_add_u32 s57, s57, 245760
    s_add_u32 s58, s58, 196608
    s_cmp_ge_u32 s56, 1280
    s_cselect_b32 s56, 0, s56
    s_cselect_b32 s57, 0, s57
    s_cselect_b32 s58, 0, s58
    s_add_u32 s54, s54, 45056
    s_add_u32 s55, s55, 45056
    s_cmp_ge_u32 s54, 135168
    s_cselect_b32 s62, 135168, 0
    s_sub_u32 s54, s54, s62
    s_sub_u32 s55, s55, s62
    s_add_u32 m0, s55, 0
    s_nop 0
    buffer_load_dwordx4 v10, s[8:11], s56 offen lds
    s_add_u32 m0, s55, 1024
    s_nop 0
    buffer_load_dwordx4 v11, s[8:11], s56 offen lds
    s_add_u32 m0, s55, 2048
    s_nop 0
    buffer_load_dwordx4 v12, s[8:11], s56 offen lds
    s_add_u32 m0, s55, 3072
    s_nop 0
    buffer_load_dwordx4 v13, s[8:11], s56 offen lds
    s_add_u32 m0, s54, 16384
    s_nop 0
    buffer_load_dwordx4 v14, s[12:15], s57 offen lds
    s_add_u32 m0, s54, 20480
    s_nop 0
    buffer_load_dwordx4 v15, s[12:15], s57 offen lds
    s_add_u32 m0, s54, 24576
    s_nop 0
    buffer_load_dwordx4 v16, s[12:15], s57 offen lds
    s_add_u32 m0, s54, 28672
    s_nop 0
    buffer_load_dwordx4 v20, s[16:19], s58 offen lds
    s_add_u32 m0, s54, 32768
    s_nop 0
    buffer_load_dwordx4 v21, s[16:19], s58 offen lds
    s_add_u32 m0, s54, 36864
    s_nop 0
    buffer_load_dwordx4 v22, s[16:19], s58 offen lds
    s_add_u32 m0, s54, 40960
    s_nop 0
    buffer_load_dwordx4 v23, s[16:19], s58 offen lds
    v_mov_b32 v25, 1073741824
    s_cmp_eq_u32 s52, 1
    s_cbranch_scc1 Lwu_41
    s_cmp_eq_u32 s52, 2
    s_cbranch_scc1 Lwu_42
    s_cmp_eq_u32 s52, 3
    s_cbranch_scc1 Lwu_43
    s_getpc_b64 s[4:5]
Lpc_B:
    s_sub_u32 s4, s4, Lpc_B-gated_mix__linear_attn_block__dense_activation_relu__prompt_kernel
    s_subb_u32 s5, s5, 0
    v_and_b32 v26, 15, v0
    s_lshl_b32 s6, s46, 4
    v_add_u32 v26, s6, v26
    v_lshlrev_b32 v26, 7, v26
    v_min_u32 v26, Lcode_end-gated_mix__linear_attn_block__dense_activation_relu__prompt_kernel-4, v26
    global_load_dword v24, v26, s[4:5]
    buffer_load_dword v24, v25, s[20:23], 0 offen
    s_branch Lwu_44
Lwu_41:
    v_lshlrev_b32 v26, 7, v0
    v_cmp_gt_u32 vcc, 60, v0
    s_nop 1
    v_cndmask_b32 v27, v25, v26, vcc
    s_mul_i32 s6, s2, 7680
    buffer_load_dword v24, v27, s[28:31], s6 offen
    v_cmp_gt_u32 vcc, 25, v0
    s_nop 1
    v_cndmask_b32 v27, v25, v26, vcc
    s_mul_i32 s6, s2, 3200
    buffer_load_dword v24, v27, s[32:35], s6 offen
    s_branch Lwu_44
Lwu_42:
    v_lshlrev_b32 v26, 21, v0
    v_min_u32 v26, 1073741824, v26
    buffer_load_dword v24, v26, s[20:23], 0 offen
    buffer_load_dword v24, v26, s[36:39], 0 offen
    s_branch Lwu_44
Lwu_43:
    buffer_load_dword v24, v25, s[20:23], 0 offen
    buffer_load_dword v24, v25, s[20:23], 0 offen
Lwu_44:
    s_waitcnt vmcnt(13)
    s_barrier
    s_add_u32 s56, s56, 128
    s_add_u32 s57, s57, 245760
    s_add_u32 s58, s58, 196608
    s_cmp_ge_u32 s56, 1280
    s_cselect_b32 s56, 0, s56
    s_cselect_b32 s57, 0, s57
    s_cselect_b32 s58, 0, s58
    s_add_u32 s54, s54, 45056
    s_add_u32 s55, s55, 45056
    s_cmp_ge_u32 s54, 135168
    s_cselect_b32 s62, 135168, 0
    s_sub_u32 s54, s54, s62
    s_sub_u32 s55, s55, s62
    s_add_u32 m0, s55, 0
    s_nop 0
    buffer_load_dwordx4 v10, s[8:11], s56 offen lds
    s_add_u32 m0, s55, 1024
    s_nop 0
    buffer_load_dwordx4 v11, s[8:11], s56 offen lds
    s_add_u32 m0, s55, 2048
    s_nop 0
    buffer_load_dwordx4 v12, s[8:11], s56 offen lds
    s_add_u32 m0, s55, 3072
    s_nop 0
    buffer_load_dwordx4 v13, s[8:11], s56 offen lds
    s_add_u32 m0, s54, 16384
    s_nop 0
    buffer_load_dwordx4 v14, s[12:15], s57 offen lds
    s_add_u32 m0, s54, 20480
    s_nop 0
    buffer_load_dwordx4 v15, s[12:15], s57 offen lds
    s_add_u32 m0, s54, 24576
    s_nop 0
    buffer_load_dwordx4 v16, s[12:15], s57 offen lds
    s_add_u32 m0, s54, 28672
    s_nop 0
    buffer_load_dwordx4 v20, s[16:19], s58 offen lds
    s_add_u32 m0, s54, 32768
    s_nop 0
    buffer_load_dwordx4 v21, s[16:19], s58 offen lds
    s_add_u32 m0, s54, 36864
    s_nop 0
    buffer_load_dwordx4 v22, s[16:19], s58 offen lds
    s_add_u32 m0, s54, 40960
    s_nop 0
    buffer_load_dwordx4 v23, s[16:19], s58 offen lds
    s_waitcnt vmcnt(13)
    s_barrier
    s_add_u32 s56, s56, 128
    s_add_u32 s57, s57, 245760
    s_add_u32 s58, s58, 196608
    s_cmp_ge_u32 s56, 1280
    s_cselect_b32 s56, 0, s56
    s_cselect_b32 s57, 0, s57
    s_cselect_b32 s58, 0, s58
    s_add_u32 s54, s54, 45056
    s_add_u32 s55, s55, 45056
    s_cmp_ge_u32 s54, 135168
    s_cselect_b32 s62, 135168, 0
    s_sub_u32 s54, s54, s62
    s_sub_u32 s55, s55, s62
    s_add_u32 m0, s55, 0
    s_nop 0
    buffer_load_dwordx4 v10, s[8:11], s56 offen lds
    s_add_u32 m0, s55, 1024
    s_nop 0
    buffer_load_dwordx4 v11, s[8:11], s56 offen lds
    s_add_u32 m0, s55, 2048
    s_nop 0
    buffer_load_dwordx4 v12, s[8:11], s56 offen lds
    s_add_u32 m0, s55, 3072
    s_nop 0
    buffer_load_dwordx4 v13, s[8:11], s56 offen lds
    s_add_u32 m0, s54, 16384
    s_nop 0
    buffer_load_dwordx4 v14, s[12:15], s57 offen lds
    s_add_u32 m0, s54, 20480
    s_nop 0
    buffer_load_dwordx4 v15, s[12:15], s57 offen lds
    s_add_u32 m0, s54, 24576
    s_nop 0
    buffer_load_dwordx4 v16, s[12:15], s57 offen lds
    s_add_u32 m0, s54, 28672
    s_nop 0
    buffer_load_dwordx4 v20, s[16:19], s58 offen lds
    s_add_u32 m0, s54, 32768
    s_nop 0
    buffer_load_dwordx4 v21, s[16:19], s58 offen lds
    s_add_u32 m0, s54, 36864
    s_nop 0
    buffer_load_dwordx4 v22, s[16:19], s58 offen lds
    s_add_u32 m0, s54, 40960
    s_nop 0
    buffer_load_dwordx4 v23, s[16:19], s58 offen lds
    s_mov_b32 s63, 3
Lld_45:
    s_waitcnt vmcnt(11)
    s_barrier
    s_add_u32 s56, s56, 128
    s_add_u32 s57, s57, 245760
    s_add_u32 s58, s58, 196608
    s_cmp_ge_u32 s56, 1280
    s_cselect_b32 s56, 0, s56
    s_cselect_b32 s57, 0, s57
    s_cselect_b32 s58, 0, s58
    s_add_u32 s54, s54, 45056
    s_add_u32 s55, s55, 45056
    s_cmp_ge_u32 s54, 135168
    s_cselect_b32 s62, 135168, 0
    s_sub_u32 s54, s54, s62
    s_sub_u32 s55, s55, s62
    s_add_u32 m0, s55, 0
    s_nop 0
    buffer_load_dwordx4 v10, s[8:11], s56 offen lds
    s_add_u32 m0, s55, 1024
    s_nop 0
    buffer_load_dwordx4 v11, s[8:11], s56 offen lds
    s_add_u32 m0, s55, 2048
    s_nop 0
    buffer_load_dwordx4 v12, s[8:11], s56 offen lds
    s_add_u32 m0, s55, 3072
    s_nop 0
    buffer_load_dwordx4 v13, s[8:11], s56 offen lds
    s_add_u32 m0, s54, 16384
    s_nop 0
    buffer_load_dwordx4 v14, s[12:15], s57 offen lds
    s_add_u32 m0, s54, 20480
    s_nop 0
    buffer_load_dwordx4 v15, s[12:15], s57 offen lds
    s_add_u32 m0, s54, 24576
    s_nop 0
    buffer_load_dwordx4 v16, s[12:15], s57 offen lds
    s_add_u32 m0, s54, 28672
    s_nop 0
    buffer_load_dwordx4 v20, s[16:19], s58 offen lds
    s_add_u32 m0, s54, 32768
    s_nop 0
    buffer_load_dwordx4 v21, s[16:19], s58 offen lds
    s_add_u32 m0, s54, 36864
    s_nop 0
    buffer_load_dwordx4 v22, s[16:19], s58 offen lds
    s_add_u32 m0, s54, 40960
    s_nop 0
    buffer_load_dwordx4 v23, s[16:19], s58 offen lds
    s_add_u32 s63, s63, 1
    s_cmp_le_u32 s63, 7
    s_cbranch_scc1 Lld_45
Lldtail:
    s_cmp_ge_u32 s46, 30
    s_cbranch_scc1 Lldred
    s_mul_i32 s50, s46, 86
    s_lshr_b32 s50, s50, 8
    s_mul_i32 s51, s50, 3
    s_sub_u32 s51, s46, s51
    s_mul_i32 s52, s51, 5
    s_lshl_b32 s56, s45, 4
    s_add_u32 s52, s52, s56
    s_and_b32 s53, s44, 3
    s_lshr_b32 s54, s44, 2
    s_mul_i32 s55, s54, 3
    s_add_u32 s55, s55, s52
    v_lshrrev_b32 v5, 3, v0
    v_and_b32 v6, 7, v0
    v_lshrrev_b32 v2, 4, v0
    v_lshlrev_b32 v7, 1, v2
    v_xor_b32 v7, v6, v7
    v_mul_u32_u24 v8, 1280, v5
    s_lshl_b32 s56, s50, 7
    v_add_u32 v8, s56, v8
    v_lshl_add_u32 v78, v7, 4, v8
    s_mul_i32 s57, s53, 491520
    s_add_u32 s63, s57, 491520
    s_mul_i32 s56, s50, 40960
    s_add_u32 s57, s57, s56
    s_lshl_b32 s58, s53, 12
    s_mul_i32 s59, s53, 204800
    s_mul_i32 s60, s53, 20480
    s_add_u32 s60, s60, 45056
    s_waitcnt vmcnt(11)
    s_barrier
    s_add_u32 m0, s58, 45056
    s_add_u32 s56, s57, 0
    buffer_load_dwordx4 v78, s[28:31], s56 offen lds
    s_add_u32 m0, s58, 46080
    s_add_u32 s56, s57, 10240
    buffer_load_dwordx4 v78, s[28:31], s56 offen lds
    s_add_u32 m0, s58, 47104
    s_add_u32 s56, s57, 20480
    buffer_load_dwordx4 v78, s[28:31], s56 offen lds
    s_add_u32 m0, s58, 48128
    s_add_u32 s56, s57, 30720
    buffer_load_dwordx4 v78, s[28:31], s56 offen lds
    s_add_u32 s57, s57, 40960
    s_cmp_ge_u32 s57, s63
    s_cselect_b32 s56, 491520, 0
    s_sub_u32 s57, s57, s56
    s_add_u32 m0, s58, 61440
    s_add_u32 s56, s57, 0
    buffer_load_dwordx4 v78, s[28:31], s56 offen lds
    s_add_u32 m0, s58, 62464
    s_add_u32 s56, s57, 10240
    buffer_load_dwordx4 v78, s[28:31], s56 offen lds
    s_add_u32 m0, s58, 63488
    s_add_u32 s56, s57, 20480
    buffer_load_dwordx4 v78, s[28:31], s56 offen lds
    s_add_u32 m0, s58, 64512
    s_add_u32 s56, s57, 30720
    buffer_load_dwordx4 v78, s[28:31], s56 offen lds
    s_add_u32 s57, s57, 40960
    s_cmp_ge_u32 s57, s63
    s_cselect_b32 s56, 491520, 0
    s_sub_u32 s57, s57, s56
    s_waitcnt vmcnt(8)
    s_barrier
    s_add_u32 m0, s58, 77824
    s_add_u32 s56, s57, 0
    buffer_load_dwordx4 v78, s[28:31], s56 offen lds
    s_add_u32 m0, s58, 78848
    s_add_u32 s56, s57, 10240
    buffer_load_dwordx4 v78, s[28:31], s56 offen lds
    s_add_u32 m0, s58, 79872
    s_add_u32 s56, s57, 20480
    buffer_load_dwordx4 v78, s[28:31], s56 offen lds
    s_add_u32 m0, s58, 80896
    s_add_u32 s56, s57, 30720
    buffer_load_dwordx4 v78, s[28:31], s56 offen lds
    s_add_u32 s57, s57, 40960
    s_cmp_ge_u32 s57, s63
    s_cselect_b32 s56, 491520, 0
    s_sub_u32 s57, s57, s56
    s_add_u32 m0, s58, 94208
    s_add_u32 s56, s57, 0
    buffer_load_dwordx4 v78, s[28:31], s56 offen lds
    s_add_u32 m0, s58, 95232
    s_add_u32 s56, s57, 10240
    buffer_load_dwordx4 v78, s[28:31], s56 offen lds
    s_add_u32 m0, s58, 96256
    s_add_u32 s56, s57, 20480
    buffer_load_dwordx4 v78, s[28:31], s56 offen lds
    s_add_u32 m0, s58, 97280
    s_add_u32 s56, s57, 30720
    buffer_load_dwordx4 v78, s[28:31], s56 offen lds
    s_add_u32 s57, s57, 40960
    s_cmp_ge_u32 s57, s63
    s_cselect_b32 s56, 491520, 0
    s_sub_u32 s57, s57, s56
    s_add_u32 m0, s58, 110592
    s_add_u32 s56, s57, 0
    buffer_load_dwordx4 v78, s[28:31], s56 offen lds
    s_add_u32 m0, s58, 111616
    s_add_u32 s56, s57, 10240
    buffer_load_dwordx4 v78, s[28:31], s56 offen lds
    s_add_u32 m0, s58, 112640
    s_add_u32 s56, s57, 20480
    buffer_load_dwordx4 v78, s[28:31], s56 offen lds
    s_add_u32 m0, s58, 113664
    s_add_u32 s56, s57, 30720
    buffer_load_dwordx4 v78, s[28:31], s56 offen lds
    s_add_u32 s57, s57, 40960
    s_cmp_ge_u32 s57, s63
    s_cselect_b32 s56, 491520, 0
    s_sub_u32 s57, s57, s56
    s_barrier
    s_add_u32 m0, s58, 0
    s_add_u32 s56, s57, 0
    buffer_load_dwordx4 v78, s[28:31], s56 offen lds
    s_add_u32 m0, s58, 1024
    s_add_u32 s56, s57, 10240
    buffer_load_dwordx4 v78, s[28:31], s56 offen lds
    s_add_u32 m0, s58, 2048
    s_add_u32 s56, s57, 20480
    buffer_load_dwordx4 v78, s[28:31], s56 offen lds
    s_add_u32 m0, s58, 3072
    s_add_u32 s56, s57, 30720
    buffer_load_dwordx4 v78, s[28:31], s56 offen lds
    s_add_u32 s57, s57, 40960
    s_cmp_ge_u32 s57, s63
    s_cselect_b32 s56, 491520, 0
    s_sub_u32 s57, s57, s56
    s_add_u32 m0, s58, 16384
    s_add_u32 s56, s57, 0
    buffer_load_dwordx4 v78, s[28:31], s56 offen lds
    s_add_u32 m0, s58, 17408
    s_add_u32 s56, s57, 10240
    buffer_load_dwordx4 v78, s[28:31], s56 offen lds
    s_add_u32 m0, s58, 18432
    s_add_u32 s56, s57, 20480
    buffer_load_dwordx4 v78, s[28:31], s56 offen lds
    s_add_u32 m0, s58, 19456
    s_add_u32 s56, s57, 30720
    buffer_load_dwordx4 v78, s[28:31], s56 offen lds
    s_add_u32 s57, s57, 40960
    s_cmp_ge_u32 s57, s63
    s_cselect_b32 s56, 491520, 0
    s_sub_u32 s57, s57, s56
    v_mov_b32 v5, 163344
    ds_read_b32 v5, v5
    s_waitcnt lgkmcnt(0)
    v_readfirstlane_b32 s49, v5
    s_cmp_lt_u32 s51, 2
    s_cbranch_scc1 Lp2L2
    v_and_b32 v1, 15, v0
    v_lshrrev_b32 v2, 4, v0
    v_bfe_u32 v3, v0, 2, 2
    v_and_b32 v4, 3, v0
    v_lshlrev_b32 v100, 4, v0
    v_mov_b32 v5, 1073741824
    v_cmp_gt_u32 vcc, 48, v0
    s_nop 1
    v_cndmask_b32 v79, v5, v100, vcc
    v_lshrrev_b32 v6, 2, v1
    v_lshlrev_b32 v6, 1, v6
    v_and_b32 v7, 1, v1
    v_add_u32 v6, v6, v7
    v_lshlrev_b32 v6, 4, v6
    v_lshl_add_u32 v6, v2, 7, v6
    v_add_u32 v6, 768, v6
    v_cndmask_b32 v6, v5, v6, vcc
    v_and_b32 v7, 2, v1
    v_cmp_eq_u32 vcc, 0, v7
    s_nop 1
    v_cndmask_b32 v204, v5, v6, vcc
    v_and_b32 v6, 1, v2
    v_lshrrev_b32 v7, 1, v3
    v_lshlrev_b32 v7, 1, v7
    v_lshl_add_u32 v7, v6, 2, v7
    v_lshl_add_u32 v8, v2, 2, v3
    v_and_b32 v9, 1, v4
    v_lshlrev_b32 v9, 3, v9
    v_lshl_add_u32 v9, v8, 7, v9
    s_lshl_b32 s56, s53, 12
    v_add_u32 v9, s56, v9
    v_lshrrev_b32 v8, 1, v4
    v_add_u32 v12, 0, v8
    v_xor_b32 v12, v12, v7
    v_lshl_add_u32 v96, v12, 4, v9
    v_add_u32 v12, 2, v8
    v_xor_b32 v12, v12, v7
    v_lshl_add_u32 v97, v12, 4, v9
    v_add_u32 v12, 4, v8
    v_xor_b32 v12, v12, v7
    v_lshl_add_u32 v98, v12, 4, v9
    v_add_u32 v12, 6, v8
    v_xor_b32 v12, v12, v7
    v_lshl_add_u32 v99, v12, 4, v9
    v_add_u32 v200, 0x20000, v96
    v_add_u32 v201, 0x20000, v97
    v_add_u32 v202, 0x20000, v98
    v_add_u32 v203, 0x20000, v99
    v_mov_b32 v208, 0
    v_mov_b32 v209, 0
    v_mov_b32 v210, 0
    v_mov_b32 v211, 0
    v_mov_b32 v212, 0
    v_mov_b32 v213, 0
    v_mov_b32 v214, 0
    v_mov_b32 v215, 0
    v_mov_b32 v216, 0
    v_mov_b32 v217, 0
    v_mov_b32 v218, 0
    v_mov_b32 v219, 0
    v_mov_b32 v220, 0
    v_mov_b32 v221, 0
    v_mov_b32 v222, 0
    v_mov_b32 v223, 0
    v_mov_b32 v224, 0
    v_mov_b32 v225, 0
    v_mov_b32 v226, 0
    v_mov_b32 v227, 0
    v_mov_b32 v228, 0
    v_mov_b32 v229, 0
    v_mov_b32 v230, 0
    v_mov_b32 v231, 0
    v_mov_b32 v232, 0
    v_mov_b32 v233, 0
    v_mov_b32 v234, 0
    v_mov_b32 v235, 0
    v_mov_b32 v236, 0
    v_mov_b32 v237, 0
    v_mov_b32 v238, 0
    v_mov_b32 v239, 0
    v_mov_b32 v240, 0
    v_mov_b32 v241, 0
    v_mov_b32 v242, 0
    v_mov_b32 v243, 0
    v_mov_b32 v244, 0
    v_mov_b32 v245, 0
    v_mov_b32 v246, 0
    v_mov_b32 v247, 0
    v_mov_b32 v248, 0
    v_mov_b32 v249, 0
    v_mov_b32 v250, 0
    v_mov_b32 v251, 0
    v_mov_b32 v252, 0
    v_mov_b32 v253, 0
    v_mov_b32 v254, 0
    v_mov_b32 v255, 0
    v_mul_u32_u24 v12, 5, v2
    s_mul_i32 s56, s53, 20480
    s_add_u32 s56, s56, 45056
    v_lshlrev_b32 v13, 3, v4
    v_add_u32 v13, s56, v13
    v_add_u32 v14, 0, v3
    v_mul_u32_u24 v15, 52, v14
    v_lshrrev_b32 v15, 8, v15
    v_mul_u32_u24 v15, 15, v15
    v_add3_u32 v14, v14, v15, v12
    v_bfe_u32 v15, v14, 1, 2
    v_lshlrev_b32 v15, 5, v15
    v_lshl_add_u32 v14, v14, 7, v15
    v_add_u32 v68, v14, v13
    v_add_u32 v14, 4, v3
    v_mul_u32_u24 v15, 52, v14
    v_lshrrev_b32 v15, 8, v15
    v_mul_u32_u24 v15, 15, v15
    v_add3_u32 v14, v14, v15, v12
    v_bfe_u32 v15, v14, 1, 2
    v_lshlrev_b32 v15, 5, v15
    v_lshl_add_u32 v14, v14, 7, v15
    v_add_u32 v69, v14, v13
    v_add_u32 v14, 8, v3
    v_mul_u32_u24 v15, 52, v14
    v_lshrrev_b32 v15, 8, v15
    v_mul_u32_u24 v15, 15, v15
    v_add3_u32 v14, v14, v15, v12
    v_bfe_u32 v15, v14, 1, 2
    v_lshlrev_b32 v15, 5, v15
    v_lshl_add_u32 v14, v14, 7, v15
    v_add_u32 v70, v14, v13
    v_add_u32 v14, 12, v3
    v_mul_u32_u24 v15, 52, v14
    v_lshrrev_b32 v15, 8, v15
    v_mul_u32_u24 v15, 15, v15
    v_add3_u32 v14, v14, v15, v12
    v_bfe_u32 v15, v14, 1, 2
    v_lshlrev_b32 v15, 5, v15
    v_lshl_add_u32 v14, v14, 7, v15
    v_add_u32 v71, v14, v13
    v_add_u32 v14, 16, v3
    v_mul_u32_u24 v15, 52, v14
    v_lshrrev_b32 v15, 8, v15
    v_mul_u32_u24 v15, 15, v15
    v_add3_u32 v14, v14, v15, v12
    v_bfe_u32 v15, v14, 1, 2
    v_lshlrev_b32 v15, 5, v15
    v_lshl_add_u32 v14, v14, 7, v15
    v_add_u32 v72, v14, v13
    v_mov_b32 v14, 0
    v_add_u32 v14, v14, v12
    v_bfe_u32 v15, v14, 1, 2
    v_lshlrev_b32 v15, 5, v15
    v_lshl_add_u32 v14, v14, 7, v15
    v_add_u32 v73, v14, v13
    v_add_u32 v14, 0, v3
    v_mul_u32_u24 v15, 52, v14
    v_lshrrev_b32 v15, 8, v15
    v_mul_u32_u24 v15, 15, v15
    v_add3_u32 v14, v14, v15, v12
    v_add_u32 v14, 80, v14
    v_bfe_u32 v15, v14, 1, 2
    v_lshlrev_b32 v15, 5, v15
    v_lshl_add_u32 v14, v14, 7, v15
    v_add_u32 v74, v14, v13
    v_add_u32 v14, 4, v3
    v_mul_u32_u24 v15, 52, v14
    v_lshrrev_b32 v15, 8, v15
    v_mul_u32_u24 v15, 15, v15
    v_add3_u32 v14, v14, v15, v12
    v_add_u32 v14, 80, v14
    v_bfe_u32 v15, v14, 1, 2
    v_lshlrev_b32 v15, 5, v15
    v_lshl_add_u32 v14, v14, 7, v15
    v_add_u32 v75, v14, v13
    v_add_u32 v14, 8, v3
    v_mul_u32_u24 v15, 52, v14
    v_lshrrev_b32 v15, 8, v15
    v_mul_u32_u24 v15, 15, v15
    v_add3_u32 v14, v14, v15, v12
    v_add_u32 v14, 80, v14
    v_bfe_u32 v15, v14, 1, 2
    v_lshlrev_b32 v15, 5, v15
    v_lshl_add_u32 v14, v14, 7, v15
    v_add_u32 v76, v14, v13
    v_add_u32 v14, 12, v3
    v_mul_u32_u24 v15, 52, v14
    v_lshrrev_b32 v15, 8, v15
    v_mul_u32_u24 v15, 15, v15
    v_add3_u32 v14, v14, v15, v12
    v_add_u32 v14, 80, v14
    v_bfe_u32 v15, v14, 1, 2
    v_lshlrev_b32 v15, 5, v15
    v_lshl_add_u32 v14, v14, 7, v15
    v_add_u32 v77, v14, v13
    v_add_u32 v14, 16, v3
    v_mul_u32_u24 v15, 52, v14
    v_lshrrev_b32 v15, 8, v15
    v_mul_u32_u24 v15, 15, v15
    v_add3_u32 v14, v14, v15, v12
    v_add_u32 v14, 80, v14
    v_bfe_u32 v15, v14, 1, 2
    v_lshlrev_b32 v15, 5, v15
    v_lshl_add_u32 v14, v14, 7, v15
    v_add_u32 v198, v14, v13
    v_mov_b32 v14, 80
    v_add_u32 v14, v14, v12
    v_bfe_u32 v15, v14, 1, 2
    v_lshlrev_b32 v15, 5, v15
    v_lshl_add_u32 v14, v14, 7, v15
    v_add_u32 v199, v14, v13
    v_lshlrev_b32 v11, 2, v1
    v_add_u32 v4, 0x10000, v96
    v_add_u32 v5, 0x10000, v97
    v_add_u32 v6, 0x10000, v98
    v_add_u32 v7, 0x10000, v99
    s_mul_i32 s3, s55, 48
    s_mul_i32 s56, s53, 12
    s_add_u32 s3, s3, s56
    s_lshl_b32 s3, s3, 10
    s_lshl_b32 s61, s50, 10
    s_mul_i32 s62, s55, 20480
    s_mul_i32 s56, s53, 5120
    s_add_u32 s62, s62, s56
    v_lshrrev_b32 v12, 4, v0
    v_lshlrev_b32 v12, 8, v12
    v_and_b32 v13, 15, v0
    v_lshl_add_u32 v12, v13, 2, v12
    s_lshl_b32 s56, s45, 9
    v_add_u32 v12, s56, v12
    v_cmp_gt_u32 vcc, 32, v0
    v_mov_b32 v13, 1073741824
    s_nop 0
    v_cndmask_b32 v12, v13, v12, vcc
    s_mov_b32 s4, 0
    s_mov_b32 s5, 10551296
    s_mov_b32 s7, 0xffffffff
Lpoll_46:
    buffer_load_dword v14, v12, s[20:23], s5 offen sc1
    s_waitcnt vmcnt(0)
    v_cmp_eq_u32 vcc, s49, v14
    s_nop 1
    s_and_b32 s6, vcc_lo, s7
    s_cmp_eq_u32 s6, s7
    s_cbranch_scc1 Lpd_47
    s_add_u32 s4, s4, 1
    s_cmp_lt_u32 s4, 40000
    s_sleep 1
    s_cbranch_scc1 Lpoll_46
Lpd_47:
    v_mov_b32 v12, 163352
    v_mov_b32 v13, 1
    v_cmp_eq_u32 vcc, 0, v0
    s_nop 1
    s_and_saveexec_b64 s[4:5], vcc
    ds_add_u32 v12, v13
    s_mov_b64 exec, s[4:5]
    v_mov_b32 v12, 163352
    s_mov_b32 s4, 0
Llw_48:
    ds_read_b32 v13, v12
    s_waitcnt lgkmcnt(0)
    v_readfirstlane_b32 s5, v13
    s_nop 1
    s_cmp_ge_u32 s5, 4
    s_cbranch_scc1 Llwd_49
    s_add_u32 s4, s4, 1
    s_cmp_lt_u32 s4, 160000
    s_cbranch_scc1 Llw_48
Llwd_49:
    s_add_u32 s6, s3, s61
    s_add_u32 s56, s6, 0
    buffer_load_dwordx4 v[104:107], v100, s[20:23], s56 offen sc1
    s_add_u32 s56, s6, 49152
    buffer_load_dwordx4 v[108:111], v100, s[20:23], s56 offen sc1
    s_add_u32 s56, s6, 98304
    buffer_load_dwordx4 v[112:115], v100, s[20:23], s56 offen sc1
    s_add_u32 s61, s61, 1024
    s_cmp_ge_u32 s61, 12288
    s_cselect_b32 s56, 12288, 0
    s_sub_u32 s61, s61, s56
    s_add_u32 s6, s3, s61
    s_add_u32 s56, s6, 0
    buffer_load_dwordx4 v[116:119], v100, s[20:23], s56 offen sc1
    s_add_u32 s56, s6, 49152
    buffer_load_dwordx4 v[120:123], v100, s[20:23], s56 offen sc1
    s_add_u32 s56, s6, 98304
    buffer_load_dwordx4 v[124:127], v100, s[20:23], s56 offen sc1
    s_add_u32 s61, s61, 1024
    s_cmp_ge_u32 s61, 12288
    s_cselect_b32 s56, 12288, 0
    s_sub_u32 s61, s61, s56
    s_add_u32 s6, s3, s61
    s_add_u32 s56, s6, 0
    buffer_load_dwordx4 v[128:131], v100, s[20:23], s56 offen sc1
    s_add_u32 s56, s6, 49152
    buffer_load_dwordx4 v[132:135], v100, s[20:23], s56 offen sc1
    s_add_u32 s56, s6, 98304
    buffer_load_dwordx4 v[136:139], v100, s[20:23], s56 offen sc1
    s_add_u32 s61, s61, 1024
    s_cmp_ge_u32 s61, 12288
    s_cselect_b32 s56, 12288, 0
    s_sub_u32 s61, s61, s56
    s_add_u32 s6, s3, s61
    s_add_u32 s56, s6, 0
    buffer_load_dwordx4 v[140:143], v100, s[20:23], s56 offen sc1
    s_add_u32 s56, s6, 49152
    buffer_load_dwordx4 v[144:147], v100, s[20:23], s56 offen sc1
    s_add_u32 s56, s6, 98304
    buffer_load_dwordx4 v[148:151], v100, s[20:23], s56 offen sc1
    s_add_u32 s61, s61, 1024
    s_cmp_ge_u32 s61, 12288
    s_cselect_b32 s56, 12288, 0
    s_sub_u32 s61, s61, s56
    s_add_u32 s6, s3, s61
    s_add_u32 s56, s6, 0
    buffer_load_dwordx4 v[16:19], v100, s[20:23], s56 offen sc1
    s_add_u32 s56, s6, 49152
    buffer_load_dwordx4 v[20:23], v100, s[20:23], s56 offen sc1
    s_add_u32 s56, s6, 98304
    buffer_load_dwordx4 v[24:27], v100, s[20:23], s56 offen sc1
    s_add_u32 s61, s61, 1024
    s_cmp_ge_u32 s61, 12288
    s_cselect_b32 s56, 12288, 0
    s_sub_u32 s61, s61, s56
    s_add_u32 s6, s3, s61
    s_add_u32 s56, s6, 0
    buffer_load_dwordx4 v[28:31], v100, s[20:23], s56 offen sc1
    s_add_u32 s56, s6, 49152
    buffer_load_dwordx4 v[32:35], v100, s[20:23], s56 offen sc1
    s_add_u32 s56, s6, 98304
    buffer_load_dwordx4 v[36:39], v100, s[20:23], s56 offen sc1
    s_add_u32 s61, s61, 1024
    s_cmp_ge_u32 s61, 12288
    s_cselect_b32 s56, 12288, 0
    s_sub_u32 s61, s61, s56
    s_add_u32 s6, s3, s61
    s_add_u32 s56, s6, 0
    buffer_load_dwordx4 v[40:43], v100, s[20:23], s56 offen sc1
    s_add_u32 s56, s6, 49152
    buffer_load_dwordx4 v[44:47], v100, s[20:23], s56 offen sc1
    s_add_u32 s56, s6, 98304
    buffer_load_dwordx4 v[48:51], v100, s[20:23], s56 offen sc1
    s_add_u32 s61, s61, 1024
    s_cmp_ge_u32 s61, 12288
    s_cselect_b32 s56, 12288, 0
    s_sub_u32 s61, s61, s56
    s_lshl_b32 s6, s55, 6
    s_add_u32 s56, s6, 9437184
    buffer_load_dword v101, v11, s[20:23], s56 offen sc1
    s_add_u32 s56, s6, 9437248
    buffer_load_dword v102, v11, s[20:23], s56 offen sc1
    s_add_u32 s56, s6, 9437312
    buffer_load_dword v103, v11, s[20:23], s56 offen sc1
    v_mov_b32 v12, 163356
    s_mov_b32 s4, 0
Llw_50:
    ds_read_b32 v13, v12
    s_waitcnt lgkmcnt(0)
    v_readfirstlane_b32 s5, v13
    s_nop 1
    s_cmp_ge_u32 s5, 4
    s_cbranch_scc1 Llwd_51
    s_add_u32 s4, s4, 1
    s_cmp_lt_u32 s4, 160000
    s_cbranch_scc1 Llw_50
Llwd_51:
    s_add_u32 m0, s58, 129024
    s_add_u32 s56, s57, 20480
    buffer_load_dwordx4 v78, s[28:31], s56 offen lds
    s_add_u32 m0, s58, 130048
    s_add_u32 s56, s57, 30720
    buffer_load_dwordx4 v78, s[28:31], s56 offen lds
    s_add_u32 s57, s57, 40960
    s_cmp_ge_u32 s57, s63
    s_cselect_b32 s56, 491520, 0
    s_sub_u32 s57, s57, s56
    s_add_u32 m0, s58, 145408
    s_add_u32 s56, s57, 20480
    buffer_load_dwordx4 v78, s[28:31], s56 offen lds
    s_add_u32 m0, s58, 146432
    s_add_u32 s56, s57, 30720
    buffer_load_dwordx4 v78, s[28:31], s56 offen lds
    s_add_u32 s57, s57, 40960
    s_cmp_ge_u32 s57, s63
    s_cselect_b32 s56, 491520, 0
    s_sub_u32 s57, s57, s56
    ds_read_b64_tr_b16 v[80:81], v96 offset:45056
    ds_read_b64_tr_b16 v[82:83], v96 offset:47104
    ds_read_b64_tr_b16 v[84:85], v97 offset:45056
    ds_read_b64_tr_b16 v[86:87], v97 offset:47104
    ds_read_b64_tr_b16 v[88:89], v98 offset:45056
    ds_read_b64_tr_b16 v[90:91], v98 offset:47104
    ds_read_b64_tr_b16 v[92:93], v99 offset:45056
    ds_read_b64_tr_b16 v[94:95], v99 offset:47104
    ds_read_b64_tr_b16 v[52:53], v96 offset:61440
    ds_read_b64_tr_b16 v[54:55], v96 offset:63488
    ds_read_b64_tr_b16 v[56:57], v97 offset:61440
    ds_read_b64_tr_b16 v[58:59], v97 offset:63488
    ds_read_b64_tr_b16 v[60:61], v98 offset:61440
    ds_read_b64_tr_b16 v[62:63], v98 offset:63488
    ds_read_b64_tr_b16 v[64:65], v99 offset:61440
    ds_read_b64_tr_b16 v[66:67], v99 offset:63488
    s_waitcnt vmcnt(25)
    s_waitcnt lgkmcnt(14)
    v_mfma_f32_16x16x32_bf16 v[208:211], v[80:83], v[104:107], v[208:211]
    v_mfma_f32_16x16x32_bf16 v[224:227], v[80:83], v[108:111], v[224:227]
    v_mfma_f32_16x16x32_bf16 v[240:243], v[80:83], v[112:115], v[240:243]
    s_waitcnt lgkmcnt(12)
    v_mfma_f32_16x16x32_bf16 v[212:215], v[84:87], v[104:107], v[212:215]
    v_mfma_f32_16x16x32_bf16 v[228:231], v[84:87], v[108:111], v[228:231]
    v_mfma_f32_16x16x32_bf16 v[244:247], v[84:87], v[112:115], v[244:247]
    s_waitcnt lgkmcnt(10)
    v_mfma_f32_16x16x32_bf16 v[216:219], v[88:91], v[104:107], v[216:219]
    v_mfma_f32_16x16x32_bf16 v[232:235], v[88:91], v[108:111], v[232:235]
    v_mfma_f32_16x16x32_bf16 v[248:251], v[88:91], v[112:115], v[248:251]
    s_waitcnt lgkmcnt(8)
    v_mfma_f32_16x16x32_bf16 v[220:223], v[92:95], v[104:107], v[220:223]
    v_mfma_f32_16x16x32_bf16 v[236:239], v[92:95], v[108:111], v[236:239]
    v_mfma_f32_16x16x32_bf16 v[252:255], v[92:95], v[112:115], v[252:255]
    s_add_u32 s6, s3, s61
    s_add_u32 s56, s6, 0
    buffer_load_dwordx4 v[104:107], v100, s[20:23], s56 offen sc1
    s_add_u32 s56, s6, 49152
    buffer_load_dwordx4 v[108:111], v100, s[20:23], s56 offen sc1
    s_add_u32 s56, s6, 98304
    buffer_load_dwordx4 v[112:115], v100, s[20:23], s56 offen sc1
    s_add_u32 s61, s61, 1024
    s_cmp_ge_u32 s61, 12288
    s_cselect_b32 s56, 12288, 0
    s_sub_u32 s61, s61, s56
    ds_read_b64_tr_b16 v[80:81], v4 offset:12288
    ds_read_b64_tr_b16 v[82:83], v4 offset:14336
    ds_read_b64_tr_b16 v[84:85], v5 offset:12288
    ds_read_b64_tr_b16 v[86:87], v5 offset:14336
    ds_read_b64_tr_b16 v[88:89], v6 offset:12288
    ds_read_b64_tr_b16 v[90:91], v6 offset:14336
    ds_read_b64_tr_b16 v[92:93], v7 offset:12288
    ds_read_b64_tr_b16 v[94:95], v7 offset:14336
    s_waitcnt vmcnt(25)
    s_waitcnt lgkmcnt(14)
    v_mfma_f32_16x16x32_bf16 v[208:211], v[52:55], v[116:119], v[208:211]
    v_mfma_f32_16x16x32_bf16 v[224:227], v[52:55], v[120:123], v[224:227]
    v_mfma_f32_16x16x32_bf16 v[240:243], v[52:55], v[124:127], v[240:243]
    s_waitcnt lgkmcnt(12)
    v_mfma_f32_16x16x32_bf16 v[212:215], v[56:59], v[116:119], v[212:215]
    v_mfma_f32_16x16x32_bf16 v[228:231], v[56:59], v[120:123], v[228:231]
    v_mfma_f32_16x16x32_bf16 v[244:247], v[56:59], v[124:127], v[244:247]
    s_waitcnt lgkmcnt(10)
    v_mfma_f32_16x16x32_bf16 v[216:219], v[60:63], v[116:119], v[216:219]
    v_mfma_f32_16x16x32_bf16 v[232:235], v[60:63], v[120:123], v[232:235]
    v_mfma_f32_16x16x32_bf16 v[248:251], v[60:63], v[124:127], v[248:251]
    s_waitcnt lgkmcnt(8)
    v_mfma_f32_16x16x32_bf16 v[220:223], v[64:67], v[116:119], v[220:223]
    v_mfma_f32_16x16x32_bf16 v[236:239], v[64:67], v[120:123], v[236:239]
    v_mfma_f32_16x16x32_bf16 v[252:255], v[64:67], v[124:127], v[252:255]
    s_add_u32 s6, s3, s61
    s_add_u32 s56, s6, 0
    buffer_load_dwordx4 v[116:119], v100, s[20:23], s56 offen sc1
    s_add_u32 s56, s6, 49152
    buffer_load_dwordx4 v[120:123], v100, s[20:23], s56 offen sc1
    s_add_u32 s56, s6, 98304
    buffer_load_dwordx4 v[124:127], v100, s[20:23], s56 offen sc1
    s_add_u32 s61, s61, 1024
    s_cmp_ge_u32 s61, 12288
    s_cselect_b32 s56, 12288, 0
    s_sub_u32 s61, s61, s56
    ds_read_b64_tr_b16 v[52:53], v4 offset:28672
    ds_read_b64_tr_b16 v[54:55], v4 offset:30720
    ds_read_b64_tr_b16 v[56:57], v5 offset:28672
    ds_read_b64_tr_b16 v[58:59], v5 offset:30720
    ds_read_b64_tr_b16 v[60:61], v6 offset:28672
    ds_read_b64_tr_b16 v[62:63], v6 offset:30720
    ds_read_b64_tr_b16 v[64:65], v7 offset:28672
    ds_read_b64_tr_b16 v[66:67], v7 offset:30720
    s_waitcnt vmcnt(25)
    s_waitcnt lgkmcnt(14)
    v_mfma_f32_16x16x32_bf16 v[208:211], v[80:83], v[128:131], v[208:211]
    v_mfma_f32_16x16x32_bf16 v[224:227], v[80:83], v[132:135], v[224:227]
    v_mfma_f32_16x16x32_bf16 v[240:243], v[80:83], v[136:139], v[240:243]
    s_waitcnt lgkmcnt(12)
    v_mfma_f32_16x16x32_bf16 v[212:215], v[84:87], v[128:131], v[212:215]
    v_mfma_f32_16x16x32_bf16 v[228:231], v[84:87], v[132:135], v[228:231]
    v_mfma_f32_16x16x32_bf16 v[244:247], v[84:87], v[136:139], v[244:247]
    s_waitcnt lgkmcnt(10)
    v_mfma_f32_16x16x32_bf16 v[216:219], v[88:91], v[128:131], v[216:219]
    v_mfma_f32_16x16x32_bf16 v[232:235], v[88:91], v[132:135], v[232:235]
    v_mfma_f32_16x16x32_bf16 v[248:251], v[88:91], v[136:139], v[248:251]
    s_waitcnt lgkmcnt(8)
    v_mfma_f32_16x16x32_bf16 v[220:223], v[92:95], v[128:131], v[220:223]
    v_mfma_f32_16x16x32_bf16 v[236:239], v[92:95], v[132:135], v[236:239]
    v_mfma_f32_16x16x32_bf16 v[252:255], v[92:95], v[136:139], v[252:255]
    s_add_u32 s6, s3, s61
    s_add_u32 s56, s6, 0
    buffer_load_dwordx4 v[128:131], v100, s[20:23], s56 offen sc1
    s_add_u32 s56, s6, 49152
    buffer_load_dwordx4 v[132:135], v100, s[20:23], s56 offen sc1
    s_add_u32 s56, s6, 98304
    buffer_load_dwordx4 v[136:139], v100, s[20:23], s56 offen sc1
    s_add_u32 s61, s61, 1024
    s_cmp_ge_u32 s61, 12288
    s_cselect_b32 s56, 12288, 0
    s_sub_u32 s61, s61, s56
    ds_read_b64_tr_b16 v[80:81], v4 offset:45056
    ds_read_b64_tr_b16 v[82:83], v4 offset:47104
    ds_read_b64_tr_b16 v[84:85], v5 offset:45056
    ds_read_b64_tr_b16 v[86:87], v5 offset:47104
    ds_read_b64_tr_b16 v[88:89], v6 offset:45056
    ds_read_b64_tr_b16 v[90:91], v6 offset:47104
    ds_read_b64_tr_b16 v[92:93], v7 offset:45056
    ds_read_b64_tr_b16 v[94:95], v7 offset:47104
    s_waitcnt vmcnt(25)
    s_waitcnt lgkmcnt(14)
    v_mfma_f32_16x16x32_bf16 v[208:211], v[52:55], v[140:143], v[208:211]
    v_mfma_f32_16x16x32_bf16 v[224:227], v[52:55], v[144:147], v[224:227]
    v_mfma_f32_16x16x32_bf16 v[240:243], v[52:55], v[148:151], v[240:243]
    s_waitcnt lgkmcnt(12)
    v_mfma_f32_16x16x32_bf16 v[212:215], v[56:59], v[140:143], v[212:215]
    v_mfma_f32_16x16x32_bf16 v[228:231], v[56:59], v[144:147], v[228:231]
    v_mfma_f32_16x16x32_bf16 v[244:247], v[56:59], v[148:151], v[244:247]
    s_waitcnt lgkmcnt(10)
    v_mfma_f32_16x16x32_bf16 v[216:219], v[60:63], v[140:143], v[216:219]
    v_mfma_f32_16x16x32_bf16 v[232:235], v[60:63], v[144:147], v[232:235]
    v_mfma_f32_16x16x32_bf16 v[248:251], v[60:63], v[148:151], v[248:251]
    s_waitcnt lgkmcnt(8)
    v_mfma_f32_16x16x32_bf16 v[220:223], v[64:67], v[140:143], v[220:223]
    v_mfma_f32_16x16x32_bf16 v[236:239], v[64:67], v[144:147], v[236:239]
    v_mfma_f32_16x16x32_bf16 v[252:255], v[64:67], v[148:151], v[252:255]
    s_add_u32 s6, s3, s61
    s_add_u32 s56, s6, 0
    buffer_load_dwordx4 v[140:143], v100, s[20:23], s56 offen sc1
    s_add_u32 s56, s6, 49152
    buffer_load_dwordx4 v[144:147], v100, s[20:23], s56 offen sc1
    s_add_u32 s56, s6, 98304
    buffer_load_dwordx4 v[148:151], v100, s[20:23], s56 offen sc1
    s_add_u32 s61, s61, 1024
    s_cmp_ge_u32 s61, 12288
    s_cselect_b32 s56, 12288, 0
    s_sub_u32 s61, s61, s56
    ds_read_b64_tr_b16 v[52:53], v96 offset:0
    ds_read_b64_tr_b16 v[54:55], v96 offset:2048
    ds_read_b64_tr_b16 v[56:57], v97 offset:0
    ds_read_b64_tr_b16 v[58:59], v97 offset:2048
    ds_read_b64_tr_b16 v[60:61], v98 offset:0
    ds_read_b64_tr_b16 v[62:63], v98 offset:2048
    ds_read_b64_tr_b16 v[64:65], v99 offset:0
    ds_read_b64_tr_b16 v[66:67], v99 offset:2048
    s_waitcnt vmcnt(25)
    s_waitcnt lgkmcnt(14)
    v_mfma_f32_16x16x32_bf16 v[208:211], v[80:83], v[16:19], v[208:211]
    v_mfma_f32_16x16x32_bf16 v[224:227], v[80:83], v[20:23], v[224:227]
    v_mfma_f32_16x16x32_bf16 v[240:243], v[80:83], v[24:27], v[240:243]
    s_waitcnt lgkmcnt(12)
    v_mfma_f32_16x16x32_bf16 v[212:215], v[84:87], v[16:19], v[212:215]
    v_mfma_f32_16x16x32_bf16 v[228:231], v[84:87], v[20:23], v[228:231]
    v_mfma_f32_16x16x32_bf16 v[244:247], v[84:87], v[24:27], v[244:247]
    s_waitcnt lgkmcnt(10)
    v_mfma_f32_16x16x32_bf16 v[216:219], v[88:91], v[16:19], v[216:219]
    v_mfma_f32_16x16x32_bf16 v[232:235], v[88:91], v[20:23], v[232:235]
    v_mfma_f32_16x16x32_bf16 v[248:251], v[88:91], v[24:27], v[248:251]
    s_waitcnt lgkmcnt(8)
    v_mfma_f32_16x16x32_bf16 v[220:223], v[92:95], v[16:19], v[220:223]
    v_mfma_f32_16x16x32_bf16 v[236:239], v[92:95], v[20:23], v[236:239]
    v_mfma_f32_16x16x32_bf16 v[252:255], v[92:95], v[24:27], v[252:255]
    s_add_u32 s6, s3, s61
    s_add_u32 s56, s6, 0
    buffer_load_dwordx4 v[16:19], v100, s[20:23], s56 offen sc1
    s_add_u32 s56, s6, 49152
    buffer_load_dwordx4 v[20:23], v100, s[20:23], s56 offen sc1
    s_add_u32 s56, s6, 98304
    buffer_load_dwordx4 v[24:27], v100, s[20:23], s56 offen sc1
    s_add_u32 s61, s61, 1024
    s_cmp_ge_u32 s61, 12288
    s_cselect_b32 s56, 12288, 0
    s_sub_u32 s61, s61, s56
    s_barrier
    s_add_u32 m0, s60, 10240
    s_add_u32 s56, s59, 102400
    buffer_load_dwordx4 v78, s[32:35], s56 offen lds
    s_add_u32 m0, s60, 11264
    s_add_u32 s56, s59, 112640
    buffer_load_dwordx4 v78, s[32:35], s56 offen lds
    s_add_u32 m0, s60, 12288
    s_add_u32 s56, s59, 122880
    buffer_load_dwordx4 v78, s[32:35], s56 offen lds
    s_add_u32 m0, s60, 13312
    s_add_u32 s56, s59, 133120
    buffer_load_dwordx4 v78, s[32:35], s56 offen lds
    s_add_u32 m0, s60, 14336
    s_add_u32 s56, s59, 143360
    buffer_load_dwordx4 v78, s[32:35], s56 offen lds
    s_add_u32 m0, s60, 15360
    s_add_u32 s56, s59, 153600
    buffer_load_dwordx4 v78, s[32:35], s56 offen lds
    s_add_u32 m0, s60, 16384
    s_add_u32 s56, s59, 163840
    buffer_load_dwordx4 v78, s[32:35], s56 offen lds
    s_add_u32 m0, s60, 17408
    s_add_u32 s56, s59, 174080
    buffer_load_dwordx4 v78, s[32:35], s56 offen lds
    s_add_u32 m0, s60, 18432
    s_add_u32 s56, s59, 184320
    buffer_load_dwordx4 v78, s[32:35], s56 offen lds
    s_add_u32 m0, s60, 19456
    s_add_u32 s56, s59, 194560
    buffer_load_dwordx4 v78, s[32:35], s56 offen lds
    ds_read_b64_tr_b16 v[80:81], v96 offset:16384
    ds_read_b64_tr_b16 v[82:83], v96 offset:18432
    ds_read_b64_tr_b16 v[84:85], v97 offset:16384
    ds_read_b64_tr_b16 v[86:87], v97 offset:18432
    ds_read_b64_tr_b16 v[88:89], v98 offset:16384
    ds_read_b64_tr_b16 v[90:91], v98 offset:18432
    ds_read_b64_tr_b16 v[92:93], v99 offset:16384
    ds_read_b64_tr_b16 v[94:95], v99 offset:18432
    s_waitcnt vmcnt(35)
    s_waitcnt lgkmcnt(14)
    v_mfma_f32_16x16x32_bf16 v[208:211], v[52:55], v[28:31], v[208:211]
    v_mfma_f32_16x16x32_bf16 v[224:227], v[52:55], v[32:35], v[224:227]
    v_mfma_f32_16x16x32_bf16 v[240:243], v[52:55], v[36:39], v[240:243]
    s_waitcnt lgkmcnt(12)
    v_mfma_f32_16x16x32_bf16 v[212:215], v[56:59], v[28:31], v[212:215]
    v_mfma_f32_16x16x32_bf16 v[228:231], v[56:59], v[32:35], v[228:231]
    v_mfma_f32_16x16x32_bf16 v[244:247], v[56:59], v[36:39], v[244:247]
    s_waitcnt lgkmcnt(10)
    v_mfma_f32_16x16x32_bf16 v[216:219], v[60:63], v[28:31], v[216:219]
    v_mfma_f32_16x16x32_bf16 v[232:235], v[60:63], v[32:35], v[232:235]
    v_mfma_f32_16x16x32_bf16 v[248:251], v[60:63], v[36:39], v[248:251]
    s_waitcnt lgkmcnt(8)
    v_mfma_f32_16x16x32_bf16 v[220:223], v[64:67], v[28:31], v[220:223]
    v_mfma_f32_16x16x32_bf16 v[236:239], v[64:67], v[32:35], v[236:239]
    v_mfma_f32_16x16x32_bf16 v[252:255], v[64:67], v[36:39], v[252:255]
    s_waitcnt vmcnt(25)
    s_barrier
    s_add_u32 m0, s58, 2048
    s_add_u32 s56, s57, 20480
    buffer_load_dwordx4 v78, s[28:31], s56 offen lds
    s_add_u32 m0, s58, 3072
    s_add_u32 s56, s57, 30720
    buffer_load_dwordx4 v78, s[28:31], s56 offen lds
    s_add_u32 s57, s57, 40960
    s_cmp_ge_u32 s57, s63
    s_cselect_b32 s56, 491520, 0
    s_sub_u32 s57, s57, s56
    ds_read_b64_tr_b16 v[52:53], v4 offset:61440
    ds_read_b64_tr_b16 v[54:55], v4 offset:63488
    ds_read_b64_tr_b16 v[56:57], v5 offset:61440
    ds_read_b64_tr_b16 v[58:59], v5 offset:63488
    ds_read_b64_tr_b16 v[60:61], v6 offset:61440
    ds_read_b64_tr_b16 v[62:63], v6 offset:63488
    ds_read_b64_tr_b16 v[64:65], v7 offset:61440
    ds_read_b64_tr_b16 v[66:67], v7 offset:63488
    s_waitcnt lgkmcnt(14)
    v_mfma_f32_16x16x32_bf16 v[208:211], v[80:83], v[40:43], v[208:211]
    v_mfma_f32_16x16x32_bf16 v[224:227], v[80:83], v[44:47], v[224:227]
    v_mfma_f32_16x16x32_bf16 v[240:243], v[80:83], v[48:51], v[240:243]
    s_waitcnt lgkmcnt(12)
    v_mfma_f32_16x16x32_bf16 v[212:215], v[84:87], v[40:43], v[212:215]
    v_mfma_f32_16x16x32_bf16 v[228:231], v[84:87], v[44:47], v[228:231]
    v_mfma_f32_16x16x32_bf16 v[244:247], v[84:87], v[48:51], v[244:247]
    s_waitcnt lgkmcnt(10)
    v_mfma_f32_16x16x32_bf16 v[216:219], v[88:91], v[40:43], v[216:219]
    v_mfma_f32_16x16x32_bf16 v[232:235], v[88:91], v[44:47], v[232:235]
    v_mfma_f32_16x16x32_bf16 v[248:251], v[88:91], v[48:51], v[248:251]
    s_waitcnt lgkmcnt(8)
    v_mfma_f32_16x16x32_bf16 v[220:223], v[92:95], v[40:43], v[220:223]
    v_mfma_f32_16x16x32_bf16 v[236:239], v[92:95], v[44:47], v[236:239]
    v_mfma_f32_16x16x32_bf16 v[252:255], v[92:95], v[48:51], v[252:255]
    s_barrier
    s_add_u32 m0, s58, 18432
    s_add_u32 s56, s57, 20480
    buffer_load_dwordx4 v78, s[28:31], s56 offen lds
    s_add_u32 m0, s58, 19456
    s_add_u32 s56, s57, 30720
    buffer_load_dwordx4 v78, s[28:31], s56 offen lds
    s_add_u32 s57, s57, 40960
    s_cmp_ge_u32 s57, s63
    s_cselect_b32 s56, 491520, 0
    s_sub_u32 s57, s57, s56
    ds_read_b64_tr_b16 v[80:81], v200 offset:12288
    ds_read_b64_tr_b16 v[82:83], v200 offset:14336
    ds_read_b64_tr_b16 v[84:85], v201 offset:12288
    ds_read_b64_tr_b16 v[86:87], v201 offset:14336
    ds_read_b64_tr_b16 v[88:89], v202 offset:12288
    ds_read_b64_tr_b16 v[90:91], v202 offset:14336
    ds_read_b64_tr_b16 v[92:93], v203 offset:12288
    ds_read_b64_tr_b16 v[94:95], v203 offset:14336
    s_waitcnt vmcnt(26)
    s_waitcnt lgkmcnt(14)
    v_mfma_f32_16x16x32_bf16 v[208:211], v[52:55], v[104:107], v[208:211]
    v_mfma_f32_16x16x32_bf16 v[224:227], v[52:55], v[108:111], v[224:227]
    v_mfma_f32_16x16x32_bf16 v[240:243], v[52:55], v[112:115], v[240:243]
    s_waitcnt lgkmcnt(12)
    v_mfma_f32_16x16x32_bf16 v[212:215], v[56:59], v[104:107], v[212:215]
    v_mfma_f32_16x16x32_bf16 v[228:231], v[56:59], v[108:111], v[228:231]
    v_mfma_f32_16x16x32_bf16 v[244:247], v[56:59], v[112:115], v[244:247]
    s_waitcnt lgkmcnt(10)
    v_mfma_f32_16x16x32_bf16 v[216:219], v[60:63], v[104:107], v[216:219]
    v_mfma_f32_16x16x32_bf16 v[232:235], v[60:63], v[108:111], v[232:235]
    v_mfma_f32_16x16x32_bf16 v[248:251], v[60:63], v[112:115], v[248:251]
    s_waitcnt lgkmcnt(8)
    v_mfma_f32_16x16x32_bf16 v[220:223], v[64:67], v[104:107], v[220:223]
    v_mfma_f32_16x16x32_bf16 v[236:239], v[64:67], v[108:111], v[236:239]
    v_mfma_f32_16x16x32_bf16 v[252:255], v[64:67], v[112:115], v[252:255]
    s_waitcnt vmcnt(2)
    s_barrier
    s_add_u32 m0, s58, 129024
    s_add_u32 s56, s57, 20480
    buffer_load_dwordx4 v78, s[28:31], s56 offen lds
    s_add_u32 m0, s58, 130048
    s_add_u32 s56, s57, 30720
    buffer_load_dwordx4 v78, s[28:31], s56 offen lds
    s_add_u32 s57, s57, 40960
    s_cmp_ge_u32 s57, s63
    s_cselect_b32 s56, 491520, 0
    s_sub_u32 s57, s57, s56
    ds_read_b64_tr_b16 v[52:53], v96 offset:0
    ds_read_b64_tr_b16 v[54:55], v96 offset:2048
    ds_read_b64_tr_b16 v[56:57], v97 offset:0
    ds_read_b64_tr_b16 v[58:59], v97 offset:2048
    ds_read_b64_tr_b16 v[60:61], v98 offset:0
    ds_read_b64_tr_b16 v[62:63], v98 offset:2048
    ds_read_b64_tr_b16 v[64:65], v99 offset:0
    ds_read_b64_tr_b16 v[66:67], v99 offset:2048
    s_waitcnt lgkmcnt(14)
    v_mfma_f32_16x16x32_bf16 v[208:211], v[80:83], v[116:119], v[208:211]
    v_mfma_f32_16x16x32_bf16 v[224:227], v[80:83], v[120:123], v[224:227]
    v_mfma_f32_16x16x32_bf16 v[240:243], v[80:83], v[124:127], v[240:243]
    s_waitcnt lgkmcnt(12)
    v_mfma_f32_16x16x32_bf16 v[212:215], v[84:87], v[116:119], v[212:215]
    v_mfma_f32_16x16x32_bf16 v[228:231], v[84:87], v[120:123], v[228:231]
    v_mfma_f32_16x16x32_bf16 v[244:247], v[84:87], v[124:127], v[244:247]
    s_waitcnt lgkmcnt(10)
    v_mfma_f32_16x16x32_bf16 v[216:219], v[88:91], v[116:119], v[216:219]
    v_mfma_f32_16x16x32_bf16 v[232:235], v[88:91], v[120:123], v[232:235]
    v_mfma_f32_16x16x32_bf16 v[248:251], v[88:91], v[124:127], v[248:251]
    s_waitcnt lgkmcnt(8)
    v_mfma_f32_16x16x32_bf16 v[220:223], v[92:95], v[116:119], v[220:223]
    v_mfma_f32_16x16x32_bf16 v[236:239], v[92:95], v[120:123], v[236:239]
    v_mfma_f32_16x16x32_bf16 v[252:255], v[92:95], v[124:127], v[252:255]
    s_waitcnt vmcnt(0)
    s_barrier
    ds_read_b64_tr_b16 v[80:81], v96 offset:16384
    ds_read_b64_tr_b16 v[82:83], v96 offset:18432
    ds_read_b64_tr_b16 v[84:85], v97 offset:16384
    ds_read_b64_tr_b16 v[86:87], v97 offset:18432
    ds_read_b64_tr_b16 v[88:89], v98 offset:16384
    ds_read_b64_tr_b16 v[90:91], v98 offset:18432
    ds_read_b64_tr_b16 v[92:93], v99 offset:16384
    ds_read_b64_tr_b16 v[94:95], v99 offset:18432
    s_waitcnt lgkmcnt(14)
    v_mfma_f32_16x16x32_bf16 v[208:211], v[52:55], v[128:131], v[208:211]
    v_mfma_f32_16x16x32_bf16 v[224:227], v[52:55], v[132:135], v[224:227]
    v_mfma_f32_16x16x32_bf16 v[240:243], v[52:55], v[136:139], v[240:243]
    s_waitcnt lgkmcnt(12)
    v_mfma_f32_16x16x32_bf16 v[212:215], v[56:59], v[128:131], v[212:215]
    v_mfma_f32_16x16x32_bf16 v[228:231], v[56:59], v[132:135], v[228:231]
    v_mfma_f32_16x16x32_bf16 v[244:247], v[56:59], v[136:139], v[244:247]
    s_waitcnt lgkmcnt(10)
    v_mfma_f32_16x16x32_bf16 v[216:219], v[60:63], v[128:131], v[216:219]
    v_mfma_f32_16x16x32_bf16 v[232:235], v[60:63], v[132:135], v[232:235]
    v_mfma_f32_16x16x32_bf16 v[248:251], v[60:63], v[136:139], v[248:251]
    s_waitcnt lgkmcnt(8)
    v_mfma_f32_16x16x32_bf16 v[220:223], v[64:67], v[128:131], v[220:223]
    v_mfma_f32_16x16x32_bf16 v[236:239], v[64:67], v[132:135], v[236:239]
    v_mfma_f32_16x16x32_bf16 v[252:255], v[64:67], v[136:139], v[252:255]
    ds_read_b64_tr_b16 v[52:53], v4 offset:61440
    ds_read_b64_tr_b16 v[54:55], v4 offset:63488
    ds_read_b64_tr_b16 v[56:57], v5 offset:61440
    ds_read_b64_tr_b16 v[58:59], v5 offset:63488
    ds_read_b64_tr_b16 v[60:61], v6 offset:61440
    ds_read_b64_tr_b16 v[62:63], v6 offset:63488
    ds_read_b64_tr_b16 v[64:65], v7 offset:61440
    ds_read_b64_tr_b16 v[66:67], v7 offset:63488
    s_waitcnt lgkmcnt(14)
    v_mfma_f32_16x16x32_bf16 v[208:211], v[80:83], v[140:143], v[208:211]
    v_mfma_f32_16x16x32_bf16 v[224:227], v[80:83], v[144:147], v[224:227]
    v_mfma_f32_16x16x32_bf16 v[240:243], v[80:83], v[148:151], v[240:243]
    s_waitcnt lgkmcnt(12)
    v_mfma_f32_16x16x32_bf16 v[212:215], v[84:87], v[140:143], v[212:215]
    v_mfma_f32_16x16x32_bf16 v[228:231], v[84:87], v[144:147], v[228:231]
    v_mfma_f32_16x16x32_bf16 v[244:247], v[84:87], v[148:151], v[244:247]
    s_waitcnt lgkmcnt(10)
    v_mfma_f32_16x16x32_bf16 v[216:219], v[88:91], v[140:143], v[216:219]
    v_mfma_f32_16x16x32_bf16 v[232:235], v[88:91], v[144:147], v[232:235]
    v_mfma_f32_16x16x32_bf16 v[248:251], v[88:91], v[148:151], v[248:251]
    s_waitcnt lgkmcnt(8)
    v_mfma_f32_16x16x32_bf16 v[220:223], v[92:95], v[140:143], v[220:223]
    v_mfma_f32_16x16x32_bf16 v[236:239], v[92:95], v[144:147], v[236:239]
    v_mfma_f32_16x16x32_bf16 v[252:255], v[92:95], v[148:151], v[252:255]
    s_waitcnt lgkmcnt(6)
    v_mfma_f32_16x16x32_bf16 v[208:211], v[52:55], v[16:19], v[208:211]
    v_mfma_f32_16x16x32_bf16 v[224:227], v[52:55], v[20:23], v[224:227]
    v_mfma_f32_16x16x32_bf16 v[240:243], v[52:55], v[24:27], v[240:243]
    s_waitcnt lgkmcnt(4)
    v_mfma_f32_16x16x32_bf16 v[212:215], v[56:59], v[16:19], v[212:215]
    v_mfma_f32_16x16x32_bf16 v[228:231], v[56:59], v[20:23], v[228:231]
    v_mfma_f32_16x16x32_bf16 v[244:247], v[56:59], v[24:27], v[244:247]
    s_waitcnt lgkmcnt(2)
    v_mfma_f32_16x16x32_bf16 v[216:219], v[60:63], v[16:19], v[216:219]
    v_mfma_f32_16x16x32_bf16 v[232:235], v[60:63], v[20:23], v[232:235]
    v_mfma_f32_16x16x32_bf16 v[248:251], v[60:63], v[24:27], v[248:251]
    s_waitcnt lgkmcnt(0)
    v_mfma_f32_16x16x32_bf16 v[220:223], v[64:67], v[16:19], v[220:223]
    v_mfma_f32_16x16x32_bf16 v[236:239], v[64:67], v[20:23], v[236:239]
    v_mfma_f32_16x16x32_bf16 v[252:255], v[64:67], v[24:27], v[252:255]
    v_sub_f32 v12, 1.0, v101
    v_pk_mul_f32 v[208:209], v[208:209], v[12:13] op_sel_hi:[1,0]
    v_pk_mul_f32 v[210:211], v[210:211], v[12:13] op_sel_hi:[1,0]
    v_pk_mul_f32 v[212:213], v[212:213], v[12:13] op_sel_hi:[1,0]
    v_pk_mul_f32 v[214:215], v[214:215], v[12:13] op_sel_hi:[1,0]
    v_pk_mul_f32 v[216:217], v[216:217], v[12:13] op_sel_hi:[1,0]
    v_pk_mul_f32 v[218:219], v[218:219], v[12:13] op_sel_hi:[1,0]
    v_pk_mul_f32 v[220:221], v[220:221], v[12:13] op_sel_hi:[1,0]
    v_pk_mul_f32 v[222:223], v[222:223], v[12:13] op_sel_hi:[1,0]
    v_sub_f32 v12, 1.0, v102
    v_pk_mul_f32 v[224:225], v[224:225], v[12:13] op_sel_hi:[1,0]
    v_pk_mul_f32 v[226:227], v[226:227], v[12:13] op_sel_hi:[1,0]
    v_pk_mul_f32 v[228:229], v[228:229], v[12:13] op_sel_hi:[1,0]
    v_pk_mul_f32 v[230:231], v[230:231], v[12:13] op_sel_hi:[1,0]
    v_pk_mul_f32 v[232:233], v[232:233], v[12:13] op_sel_hi:[1,0]
    v_pk_mul_f32 v[234:235], v[234:235], v[12:13] op_sel_hi:[1,0]
    v_pk_mul_f32 v[236:237], v[236:237], v[12:13] op_sel_hi:[1,0]
    v_pk_mul_f32 v[238:239], v[238:239], v[12:13] op_sel_hi:[1,0]
    v_sub_f32 v12, 1.0, v103
    v_pk_mul_f32 v[240:241], v[240:241], v[12:13] op_sel_hi:[1,0]
    v_pk_mul_f32 v[242:243], v[242:243], v[12:13] op_sel_hi:[1,0]
    v_pk_mul_f32 v[244:245], v[244:245], v[12:13] op_sel_hi:[1,0]
    v_pk_mul_f32 v[246:247], v[246:247], v[12:13] op_sel_hi:[1,0]
    v_pk_mul_f32 v[248:249], v[248:249], v[12:13] op_sel_hi:[1,0]
    v_pk_mul_f32 v[250:251], v[250:251], v[12:13] op_sel_hi:[1,0]
    v_pk_mul_f32 v[252:253], v[252:253], v[12:13] op_sel_hi:[1,0]
    v_pk_mul_f32 v[254:255], v[254:255], v[12:13] op_sel_hi:[1,0]
    v_and_b32 v12, 1, v0
    v_lshlrev_b32 v12, 2, v12
    v_bfe_u32 v13, v0, 1, 1
    v_lshl_add_u32 v12, v13, 8, v12
    s_lshl_b32 s56, s45, 9
    s_lshl_b32 s6, s53, 3
    s_add_u32 s56, s56, s6
    v_add_u32 v12, s56, v12
    v_cmp_gt_u32 vcc, 4, v0
    v_mov_b32 v13, 1073741824
    s_nop 0
    v_cndmask_b32 v12, v13, v12, vcc
    s_mov_b32 s4, 0
    s_mov_b32 s5, 10575872
    s_mov_b32 s7, 0xf
Lpoll_52:
    buffer_load_dword v10, v12, s[20:23], s5 offen sc1
    s_waitcnt vmcnt(0)
    v_cmp_eq_u32 vcc, s49, v10
    s_nop 1
    s_and_b32 s6, vcc_lo, s7
    s_cmp_eq_u32 s6, s7
    s_cbranch_scc1 Lpd_53
    s_add_u32 s4, s4, 1
    s_cmp_lt_u32 s4, 40000
    s_sleep 1
    s_cbranch_scc1 Lpoll_52
Lpd_53:
    s_mul_i32 s6, s55, 24
    s_mul_i32 s56, s53, 6
    s_add_u32 s6, s6, s56
    s_lshl_b32 s6, s6, 10
    s_add_u32 s56, s6, 11534336
    buffer_load_dwordx4 v[104:107], v100, s[20:23], s56 offen sc1
    s_add_u32 s56, s6, 11558912
    buffer_load_dwordx4 v[108:111], v100, s[20:23], s56 offen sc1
    s_add_u32 s56, s6, 11583488
    buffer_load_dwordx4 v[112:115], v100, s[20:23], s56 offen sc1
    s_add_u32 s56, s6, 11535360
    buffer_load_dwordx4 v[116:119], v100, s[20:23], s56 offen sc1
    s_add_u32 s56, s6, 11559936
    buffer_load_dwordx4 v[120:123], v100, s[20:23], s56 offen sc1
    s_add_u32 s56, s6, 11584512
    buffer_load_dwordx4 v[124:127], v100, s[20:23], s56 offen sc1
    s_add_u32 s56, s6, 11536384
    buffer_load_dwordx4 v[128:131], v100, s[20:23], s56 offen sc1
    s_add_u32 s56, s6, 11560960
    buffer_load_dwordx4 v[132:135], v100, s[20:23], s56 offen sc1
    s_add_u32 s56, s6, 11585536
    buffer_load_dwordx4 v[136:139], v100, s[20:23], s56 offen sc1
    s_add_u32 s56, s6, 11537408
    buffer_load_dwordx4 v[140:143], v100, s[20:23], s56 offen sc1
    s_add_u32 s56, s6, 11561984
    buffer_load_dwordx4 v[144:147], v100, s[20:23], s56 offen sc1
    s_add_u32 s56, s6, 11586560
    buffer_load_dwordx4 v[148:151], v100, s[20:23], s56 offen sc1
    s_add_u32 s56, s6, 11538432
    buffer_load_dwordx4 v[28:31], v100, s[20:23], s56 offen sc1
    s_add_u32 s56, s6, 11563008
    buffer_load_dwordx4 v[32:35], v100, s[20:23], s56 offen sc1
    s_add_u32 s56, s6, 11587584
    buffer_load_dwordx4 v[36:39], v100, s[20:23], s56 offen sc1
    s_add_u32 s56, s6, 11539456
    buffer_load_dwordx4 v[40:43], v100, s[20:23], s56 offen sc1
    s_add_u32 s56, s6, 11564032
    buffer_load_dwordx4 v[44:47], v100, s[20:23], s56 offen sc1
    s_add_u32 s56, s6, 11588608
    buffer_load_dwordx4 v[48:51], v100, s[20:23], s56 offen sc1
    ds_read_b64_tr_b16 v[80:81], v68
    ds_read_b64_tr_b16 v[82:83], v69
    v_xor_b32 v14, 32, v68
    ds_read_b64_tr_b16 v[84:85], v14
    v_xor_b32 v15, 32, v69
    ds_read_b64_tr_b16 v[86:87], v15
    v_xor_b32 v14, 64, v68
    ds_read_b64_tr_b16 v[88:89], v14
    v_xor_b32 v15, 64, v69
    ds_read_b64_tr_b16 v[90:91], v15
    v_xor_b32 v14, 96, v68
    ds_read_b64_tr_b16 v[92:93], v14
    v_xor_b32 v15, 96, v69
    ds_read_b64_tr_b16 v[94:95], v15
    ds_read_b64_tr_b16 v[52:53], v70
    ds_read_b64_tr_b16 v[54:55], v71
    v_xor_b32 v14, 32, v70
    ds_read_b64_tr_b16 v[56:57], v14
    v_xor_b32 v15, 32, v71
    ds_read_b64_tr_b16 v[58:59], v15
    v_xor_b32 v14, 64, v70
    ds_read_b64_tr_b16 v[60:61], v14
    v_xor_b32 v15, 64, v71
    ds_read_b64_tr_b16 v[62:63], v15
    v_xor_b32 v14, 96, v70
    ds_read_b64_tr_b16 v[64:65], v14
    v_xor_b32 v15, 96, v71
    ds_read_b64_tr_b16 v[66:67], v15
    s_waitcnt vmcnt(15)
    s_waitcnt lgkmcnt(14)
    v_mfma_f32_16x16x32_bf16 v[208:211], v[80:83], v[104:107], v[208:211]
    v_mfma_f32_16x16x32_bf16 v[224:227], v[80:83], v[108:111], v[224:227]
    v_mfma_f32_16x16x32_bf16 v[240:243], v[80:83], v[112:115], v[240:243]
    s_waitcnt lgkmcnt(12)
    v_mfma_f32_16x16x32_bf16 v[212:215], v[84:87], v[104:107], v[212:215]
    v_mfma_f32_16x16x32_bf16 v[228:231], v[84:87], v[108:111], v[228:231]
    v_mfma_f32_16x16x32_bf16 v[244:247], v[84:87], v[112:115], v[244:247]
    s_waitcnt lgkmcnt(10)
    v_mfma_f32_16x16x32_bf16 v[216:219], v[88:91], v[104:107], v[216:219]
    v_mfma_f32_16x16x32_bf16 v[232:235], v[88:91], v[108:111], v[232:235]
    v_mfma_f32_16x16x32_bf16 v[248:251], v[88:91], v[112:115], v[248:251]
    s_waitcnt lgkmcnt(8)
    v_mfma_f32_16x16x32_bf16 v[220:223], v[92:95], v[104:107], v[220:223]
    v_mfma_f32_16x16x32_bf16 v[236:239], v[92:95], v[108:111], v[236:239]
    v_mfma_f32_16x16x32_bf16 v[252:255], v[92:95], v[112:115], v[252:255]
    ds_read_b64_tr_b16 v[80:81], v72
    ds_read_b64_tr_b16 v[82:83], v73
    v_xor_b32 v14, 32, v72
    ds_read_b64_tr_b16 v[84:85], v14
    v_xor_b32 v15, 32, v73
    ds_read_b64_tr_b16 v[86:87], v15
    v_xor_b32 v14, 64, v72
    ds_read_b64_tr_b16 v[88:89], v14
    v_xor_b32 v15, 64, v73
    ds_read_b64_tr_b16 v[90:91], v15
    v_xor_b32 v14, 96, v72
    ds_read_b64_tr_b16 v[92:93], v14
    v_xor_b32 v15, 96, v73
    ds_read_b64_tr_b16 v[94:95], v15
    s_waitcnt vmcnt(12)
    s_waitcnt lgkmcnt(14)
    v_mfma_f32_16x16x32_bf16 v[208:211], v[52:55], v[116:119], v[208:211]
    v_mfma_f32_16x16x32_bf16 v[224:227], v[52:55], v[120:123], v[224:227]
    v_mfma_f32_16x16x32_bf16 v[240:243], v[52:55], v[124:127], v[240:243]
    s_waitcnt lgkmcnt(12)
    v_mfma_f32_16x16x32_bf16 v[212:215], v[56:59], v[116:119], v[212:215]
    v_mfma_f32_16x16x32_bf16 v[228:231], v[56:59], v[120:123], v[228:231]
    v_mfma_f32_16x16x32_bf16 v[244:247], v[56:59], v[124:127], v[244:247]
    s_waitcnt lgkmcnt(10)
    v_mfma_f32_16x16x32_bf16 v[216:219], v[60:63], v[116:119], v[216:219]
    v_mfma_f32_16x16x32_bf16 v[232:235], v[60:63], v[120:123], v[232:235]
    v_mfma_f32_16x16x32_bf16 v[248:251], v[60:63], v[124:127], v[248:251]
    s_waitcnt lgkmcnt(8)
    v_mfma_f32_16x16x32_bf16 v[220:223], v[64:67], v[116:119], v[220:223]
    v_mfma_f32_16x16x32_bf16 v[236:239], v[64:67], v[120:123], v[236:239]
    v_mfma_f32_16x16x32_bf16 v[252:255], v[64:67], v[124:127], v[252:255]
    ds_read_b64_tr_b16 v[52:53], v74
    ds_read_b64_tr_b16 v[54:55], v75
    v_xor_b32 v14, 32, v74
    ds_read_b64_tr_b16 v[56:57], v14
    v_xor_b32 v15, 32, v75
    ds_read_b64_tr_b16 v[58:59], v15
    v_xor_b32 v14, 64, v74
    ds_read_b64_tr_b16 v[60:61], v14
    v_xor_b32 v15, 64, v75
    ds_read_b64_tr_b16 v[62:63], v15
    v_xor_b32 v14, 96, v74
    ds_read_b64_tr_b16 v[64:65], v14
    v_xor_b32 v15, 96, v75
    ds_read_b64_tr_b16 v[66:67], v15
    s_waitcnt vmcnt(9)
    s_waitcnt lgkmcnt(14)
    v_mfma_f32_16x16x32_bf16 v[208:211], v[80:83], v[128:131], v[208:211]
    v_mfma_f32_16x16x32_bf16 v[224:227], v[80:83], v[132:135], v[224:227]
    v_mfma_f32_16x16x32_bf16 v[240:243], v[80:83], v[136:139], v[240:243]
    s_waitcnt lgkmcnt(12)
    v_mfma_f32_16x16x32_bf16 v[212:215], v[84:87], v[128:131], v[212:215]
    v_mfma_f32_16x16x32_bf16 v[228:231], v[84:87], v[132:135], v[228:231]
    v_mfma_f32_16x16x32_bf16 v[244:247], v[84:87], v[136:139], v[244:247]
    s_waitcnt lgkmcnt(10)
    v_mfma_f32_16x16x32_bf16 v[216:219], v[88:91], v[128:131], v[216:219]
    v_mfma_f32_16x16x32_bf16 v[232:235], v[88:91], v[132:135], v[232:235]
    v_mfma_f32_16x16x32_bf16 v[248:251], v[88:91], v[136:139], v[248:251]
    s_waitcnt lgkmcnt(8)
    v_mfma_f32_16x16x32_bf16 v[220:223], v[92:95], v[128:131], v[220:223]
    v_mfma_f32_16x16x32_bf16 v[236:239], v[92:95], v[132:135], v[236:239]
    v_mfma_f32_16x16x32_bf16 v[252:255], v[92:95], v[136:139], v[252:255]
    ds_read_b64_tr_b16 v[80:81], v76
    ds_read_b64_tr_b16 v[82:83], v77
    v_xor_b32 v14, 32, v76
    ds_read_b64_tr_b16 v[84:85], v14
    v_xor_b32 v15, 32, v77
    ds_read_b64_tr_b16 v[86:87], v15
    v_xor_b32 v14, 64, v76
    ds_read_b64_tr_b16 v[88:89], v14
    v_xor_b32 v15, 64, v77
    ds_read_b64_tr_b16 v[90:91], v15
    v_xor_b32 v14, 96, v76
    ds_read_b64_tr_b16 v[92:93], v14
    v_xor_b32 v15, 96, v77
    ds_read_b64_tr_b16 v[94:95], v15
    s_waitcnt vmcnt(6)
    s_waitcnt lgkmcnt(14)
    v_mfma_f32_16x16x32_bf16 v[208:211], v[52:55], v[140:143], v[208:211]
    v_mfma_f32_16x16x32_bf16 v[224:227], v[52:55], v[144:147], v[224:227]
    v_mfma_f32_16x16x32_bf16 v[240:243], v[52:55], v[148:151], v[240:243]
    s_waitcnt lgkmcnt(12)
    v_mfma_f32_16x16x32_bf16 v[212:215], v[56:59], v[140:143], v[212:215]
    v_mfma_f32_16x16x32_bf16 v[228:231], v[56:59], v[144:147], v[228:231]
    v_mfma_f32_16x16x32_bf16 v[244:247], v[56:59], v[148:151], v[244:247]
    s_waitcnt lgkmcnt(10)
    v_mfma_f32_16x16x32_bf16 v[216:219], v[60:63], v[140:143], v[216:219]
    v_mfma_f32_16x16x32_bf16 v[232:235], v[60:63], v[144:147], v[232:235]
    v_mfma_f32_16x16x32_bf16 v[248:251], v[60:63], v[148:151], v[248:251]
    s_waitcnt lgkmcnt(8)
    v_mfma_f32_16x16x32_bf16 v[220:223], v[64:67], v[140:143], v[220:223]
    v_mfma_f32_16x16x32_bf16 v[236:239], v[64:67], v[144:147], v[236:239]
    v_mfma_f32_16x16x32_bf16 v[252:255], v[64:67], v[148:151], v[252:255]
    ds_read_b64_tr_b16 v[52:53], v198
    ds_read_b64_tr_b16 v[54:55], v199
    v_xor_b32 v14, 32, v198
    ds_read_b64_tr_b16 v[56:57], v14
    v_xor_b32 v15, 32, v199
    ds_read_b64_tr_b16 v[58:59], v15
    v_xor_b32 v14, 64, v198
    ds_read_b64_tr_b16 v[60:61], v14
    v_xor_b32 v15, 64, v199
    ds_read_b64_tr_b16 v[62:63], v15
    v_xor_b32 v14, 96, v198
    ds_read_b64_tr_b16 v[64:65], v14
    v_xor_b32 v15, 96, v199
    ds_read_b64_tr_b16 v[66:67], v15
    s_waitcnt vmcnt(3)
    s_waitcnt lgkmcnt(14)
    v_mfma_f32_16x16x32_bf16 v[208:211], v[80:83], v[28:31], v[208:211]
    v_mfma_f32_16x16x32_bf16 v[224:227], v[80:83], v[32:35], v[224:227]
    v_mfma_f32_16x16x32_bf16 v[240:243], v[80:83], v[36:39], v[240:243]
    s_waitcnt lgkmcnt(12)
    v_mfma_f32_16x16x32_bf16 v[212:215], v[84:87], v[28:31], v[212:215]
    v_mfma_f32_16x16x32_bf16 v[228:231], v[84:87], v[32:35], v[228:231]
    v_mfma_f32_16x16x32_bf16 v[244:247], v[84:87], v[36:39], v[244:247]
    s_waitcnt lgkmcnt(10)
    v_mfma_f32_16x16x32_bf16 v[216:219], v[88:91], v[28:31], v[216:219]
    v_mfma_f32_16x16x32_bf16 v[232:235], v[88:91], v[32:35], v[232:235]
    v_mfma_f32_16x16x32_bf16 v[248:251], v[88:91], v[36:39], v[248:251]
    s_waitcnt lgkmcnt(8)
    v_mfma_f32_16x16x32_bf16 v[220:223], v[92:95], v[28:31], v[220:223]
    v_mfma_f32_16x16x32_bf16 v[236:239], v[92:95], v[32:35], v[236:239]
    v_mfma_f32_16x16x32_bf16 v[252:255], v[92:95], v[36:39], v[252:255]
    s_waitcnt vmcnt(0)
    s_waitcnt lgkmcnt(6)
    v_mfma_f32_16x16x32_bf16 v[208:211], v[52:55], v[40:43], v[208:211]
    v_mfma_f32_16x16x32_bf16 v[224:227], v[52:55], v[44:47], v[224:227]
    v_mfma_f32_16x16x32_bf16 v[240:243], v[52:55], v[48:51], v[240:243]
    s_waitcnt lgkmcnt(4)
    v_mfma_f32_16x16x32_bf16 v[212:215], v[56:59], v[40:43], v[212:215]
    v_mfma_f32_16x16x32_bf16 v[228:231], v[56:59], v[44:47], v[228:231]
    v_mfma_f32_16x16x32_bf16 v[244:247], v[56:59], v[48:51], v[244:247]
    s_waitcnt lgkmcnt(2)
    v_mfma_f32_16x16x32_bf16 v[216:219], v[60:63], v[40:43], v[216:219]
    v_mfma_f32_16x16x32_bf16 v[232:235], v[60:63], v[44:47], v[232:235]
    v_mfma_f32_16x16x32_bf16 v[248:251], v[60:63], v[48:51], v[248:251]
    s_waitcnt lgkmcnt(0)
    v_mfma_f32_16x16x32_bf16 v[220:223], v[64:67], v[40:43], v[220:223]
    v_mfma_f32_16x16x32_bf16 v[236:239], v[64:67], v[44:47], v[236:239]
    v_mfma_f32_16x16x32_bf16 v[252:255], v[64:67], v[48:51], v[252:255]
    s_barrier
    s_branch Lfin
Lp2L2:
    v_and_b32 v1, 15, v0
    v_lshrrev_b32 v2, 4, v0
    v_bfe_u32 v3, v0, 2, 2
    v_and_b32 v4, 3, v0
    v_lshlrev_b32 v100, 4, v0
    v_mov_b32 v5, 1073741824
    v_cmp_gt_u32 vcc, 48, v0
    s_nop 1
    v_cndmask_b32 v79, v5, v100, vcc
    v_lshrrev_b32 v6, 2, v1
    v_lshlrev_b32 v6, 1, v6
    v_and_b32 v7, 1, v1
    v_add_u32 v6, v6, v7
    v_lshlrev_b32 v6, 4, v6
    v_lshl_add_u32 v6, v2, 7, v6
    v_add_u32 v6, 768, v6
    v_cndmask_b32 v6, v5, v6, vcc
    v_and_b32 v7, 2, v1
    v_cmp_eq_u32 vcc, 0, v7
    s_nop 1
    v_cndmask_b32 v204, v5, v6, vcc
    v_and_b32 v6, 1, v2
    v_lshrrev_b32 v7, 1, v3
    v_lshlrev_b32 v7, 1, v7
    v_lshl_add_u32 v7, v6, 2, v7
    v_lshl_add_u32 v8, v2, 2, v3
    v_and_b32 v9, 1, v4
    v_lshlrev_b32 v9, 3, v9
    v_lshl_add_u32 v9, v8, 7, v9
    s_lshl_b32 s56, s53, 12
    v_add_u32 v9, s56, v9
    v_lshrrev_b32 v8, 1, v4
    v_add_u32 v12, 0, v8
    v_xor_b32 v12, v12, v7
    v_lshl_add_u32 v96, v12, 4, v9
    v_add_u32 v12, 2, v8
    v_xor_b32 v12, v12, v7
    v_lshl_add_u32 v97, v12, 4, v9
    v_add_u32 v12, 4, v8
    v_xor_b32 v12, v12, v7
    v_lshl_add_u32 v98, v12, 4, v9
    v_add_u32 v12, 6, v8
    v_xor_b32 v12, v12, v7
    v_lshl_add_u32 v99, v12, 4, v9
    v_add_u32 v200, 0x20000, v96
    v_add_u32 v201, 0x20000, v97
    v_add_u32 v202, 0x20000, v98
    v_add_u32 v203, 0x20000, v99
    v_mov_b32 v208, 0
    v_mov_b32 v209, 0
    v_mov_b32 v210, 0
    v_mov_b32 v211, 0
    v_mov_b32 v212, 0
    v_mov_b32 v213, 0
    v_mov_b32 v214, 0
    v_mov_b32 v215, 0
    v_mov_b32 v216, 0
    v_mov_b32 v217, 0
    v_mov_b32 v218, 0
    v_mov_b32 v219, 0
    v_mov_b32 v220, 0
    v_mov_b32 v221, 0
    v_mov_b32 v222, 0
    v_mov_b32 v223, 0
    v_mov_b32 v224, 0
    v_mov_b32 v225, 0
    v_mov_b32 v226, 0
    v_mov_b32 v227, 0
    v_mov_b32 v228, 0
    v_mov_b32 v229, 0
    v_mov_b32 v230, 0
    v_mov_b32 v231, 0
    v_mov_b32 v232, 0
    v_mov_b32 v233, 0
    v_mov_b32 v234, 0
    v_mov_b32 v235, 0
    v_mov_b32 v236, 0
    v_mov_b32 v237, 0
    v_mov_b32 v238, 0
    v_mov_b32 v239, 0
    v_mul_u32_u24 v12, 5, v2
    s_mul_i32 s56, s53, 20480
    s_add_u32 s56, s56, 45056
    v_lshlrev_b32 v13, 3, v4
    v_add_u32 v13, s56, v13
    v_add_u32 v14, 0, v3
    v_mul_u32_u24 v15, 52, v14
    v_lshrrev_b32 v15, 8, v15
    v_mul_u32_u24 v15, 15, v15
    v_add3_u32 v14, v14, v15, v12
    v_bfe_u32 v15, v14, 1, 2
    v_lshlrev_b32 v15, 5, v15
    v_lshl_add_u32 v14, v14, 7, v15
    v_add_u32 v68, v14, v13
    v_add_u32 v14, 4, v3
    v_mul_u32_u24 v15, 52, v14
    v_lshrrev_b32 v15, 8, v15
    v_mul_u32_u24 v15, 15, v15
    v_add3_u32 v14, v14, v15, v12
    v_bfe_u32 v15, v14, 1, 2
    v_lshlrev_b32 v15, 5, v15
    v_lshl_add_u32 v14, v14, 7, v15
    v_add_u32 v69, v14, v13
    v_add_u32 v14, 8, v3
    v_mul_u32_u24 v15, 52, v14
    v_lshrrev_b32 v15, 8, v15
    v_mul_u32_u24 v15, 15, v15
    v_add3_u32 v14, v14, v15, v12
    v_bfe_u32 v15, v14, 1, 2
    v_lshlrev_b32 v15, 5, v15
    v_lshl_add_u32 v14, v14, 7, v15
    v_add_u32 v70, v14, v13
    v_add_u32 v14, 12, v3
    v_mul_u32_u24 v15, 52, v14
    v_lshrrev_b32 v15, 8, v15
    v_mul_u32_u24 v15, 15, v15
    v_add3_u32 v14, v14, v15, v12
    v_bfe_u32 v15, v14, 1, 2
    v_lshlrev_b32 v15, 5, v15
    v_lshl_add_u32 v14, v14, 7, v15
    v_add_u32 v71, v14, v13
    v_add_u32 v14, 16, v3
    v_mul_u32_u24 v15, 52, v14
    v_lshrrev_b32 v15, 8, v15
    v_mul_u32_u24 v15, 15, v15
    v_add3_u32 v14, v14, v15, v12
    v_bfe_u32 v15, v14, 1, 2
    v_lshlrev_b32 v15, 5, v15
    v_lshl_add_u32 v14, v14, 7, v15
    v_add_u32 v72, v14, v13
    v_mov_b32 v14, 0
    v_add_u32 v14, v14, v12
    v_bfe_u32 v15, v14, 1, 2
    v_lshlrev_b32 v15, 5, v15
    v_lshl_add_u32 v14, v14, 7, v15
    v_add_u32 v73, v14, v13
    v_add_u32 v14, 0, v3
    v_mul_u32_u24 v15, 52, v14
    v_lshrrev_b32 v15, 8, v15
    v_mul_u32_u24 v15, 15, v15
    v_add3_u32 v14, v14, v15, v12
    v_add_u32 v14, 80, v14
    v_bfe_u32 v15, v14, 1, 2
    v_lshlrev_b32 v15, 5, v15
    v_lshl_add_u32 v14, v14, 7, v15
    v_add_u32 v74, v14, v13
    v_add_u32 v14, 4, v3
    v_mul_u32_u24 v15, 52, v14
    v_lshrrev_b32 v15, 8, v15
    v_mul_u32_u24 v15, 15, v15
    v_add3_u32 v14, v14, v15, v12
    v_add_u32 v14, 80, v14
    v_bfe_u32 v15, v14, 1, 2
    v_lshlrev_b32 v15, 5, v15
    v_lshl_add_u32 v14, v14, 7, v15
    v_add_u32 v75, v14, v13
    v_add_u32 v14, 8, v3
    v_mul_u32_u24 v15, 52, v14
    v_lshrrev_b32 v15, 8, v15
    v_mul_u32_u24 v15, 15, v15
    v_add3_u32 v14, v14, v15, v12
    v_add_u32 v14, 80, v14
    v_bfe_u32 v15, v14, 1, 2
    v_lshlrev_b32 v15, 5, v15
    v_lshl_add_u32 v14, v14, 7, v15
    v_add_u32 v76, v14, v13
    v_add_u32 v14, 12, v3
    v_mul_u32_u24 v15, 52, v14
    v_lshrrev_b32 v15, 8, v15
    v_mul_u32_u24 v15, 15, v15
    v_add3_u32 v14, v14, v15, v12
    v_add_u32 v14, 80, v14
    v_bfe_u32 v15, v14, 1, 2
    v_lshlrev_b32 v15, 5, v15
    v_lshl_add_u32 v14, v14, 7, v15
    v_add_u32 v77, v14, v13
    v_add_u32 v14, 16, v3
    v_mul_u32_u24 v15, 52, v14
    v_lshrrev_b32 v15, 8, v15
    v_mul_u32_u24 v15, 15, v15
    v_add3_u32 v14, v14, v15, v12
    v_add_u32 v14, 80, v14
    v_bfe_u32 v15, v14, 1, 2
    v_lshlrev_b32 v15, 5, v15
    v_lshl_add_u32 v14, v14, 7, v15
    v_add_u32 v198, v14, v13
    v_mov_b32 v14, 80
    v_add_u32 v14, v14, v12
    v_bfe_u32 v15, v14, 1, 2
    v_lshlrev_b32 v15, 5, v15
    v_lshl_add_u32 v14, v14, 7, v15
    v_add_u32 v199, v14, v13
    v_lshlrev_b32 v11, 2, v1
    v_add_u32 v4, 0x10000, v96
    v_add_u32 v5, 0x10000, v97
    v_add_u32 v6, 0x10000, v98
    v_add_u32 v7, 0x10000, v99
    s_mul_i32 s3, s55, 48
    s_mul_i32 s56, s53, 12
    s_add_u32 s3, s3, s56
    s_lshl_b32 s3, s3, 10
    s_lshl_b32 s61, s50, 10
    s_mul_i32 s62, s55, 20480
    s_mul_i32 s56, s53, 5120
    s_add_u32 s62, s62, s56
    v_lshrrev_b32 v12, 4, v0
    v_lshlrev_b32 v12, 8, v12
    v_and_b32 v13, 15, v0
    v_lshl_add_u32 v12, v13, 2, v12
    s_lshl_b32 s56, s45, 9
    v_add_u32 v12, s56, v12
    v_cmp_gt_u32 vcc, 32, v0
    v_mov_b32 v13, 1073741824
    s_nop 0
    v_cndmask_b32 v12, v13, v12, vcc
    s_mov_b32 s4, 0
    s_mov_b32 s5, 10551296
    s_mov_b32 s7, 0xffffffff
Lpoll_54:
    buffer_load_dword v14, v12, s[20:23], s5 offen sc1
    s_waitcnt vmcnt(0)
    v_cmp_eq_u32 vcc, s49, v14
    s_nop 1
    s_and_b32 s6, vcc_lo, s7
    s_cmp_eq_u32 s6, s7
    s_cbranch_scc1 Lpd_55
    s_add_u32 s4, s4, 1
    s_cmp_lt_u32 s4, 40000
    s_sleep 1
    s_cbranch_scc1 Lpoll_54
Lpd_55:
    v_mov_b32 v12, 163352
    v_mov_b32 v13, 1
    v_cmp_eq_u32 vcc, 0, v0
    s_nop 1
    s_and_saveexec_b64 s[4:5], vcc
    ds_add_u32 v12, v13
    s_mov_b64 exec, s[4:5]
    v_mov_b32 v12, 163352
    s_mov_b32 s4, 0
Llw_56:
    ds_read_b32 v13, v12
    s_waitcnt lgkmcnt(0)
    v_readfirstlane_b32 s5, v13
    s_nop 1
    s_cmp_ge_u32 s5, 4
    s_cbranch_scc1 Llwd_57
    s_add_u32 s4, s4, 1
    s_cmp_lt_u32 s4, 160000
    s_cbranch_scc1 Llw_56
Llwd_57:
    s_add_u32 s6, s3, s61
    s_add_u32 s56, s6, 0
    buffer_load_dwordx4 v[104:107], v100, s[20:23], s56 offen sc1
    s_add_u32 s56, s6, 49152
    buffer_load_dwordx4 v[108:111], v100, s[20:23], s56 offen sc1
    s_add_u32 s61, s61, 1024
    s_cmp_ge_u32 s61, 12288
    s_cselect_b32 s56, 12288, 0
    s_sub_u32 s61, s61, s56
    s_add_u32 s6, s3, s61
    s_add_u32 s56, s6, 0
    buffer_load_dwordx4 v[116:119], v100, s[20:23], s56 offen sc1
    s_add_u32 s56, s6, 49152
    buffer_load_dwordx4 v[120:123], v100, s[20:23], s56 offen sc1
    s_add_u32 s61, s61, 1024
    s_cmp_ge_u32 s61, 12288
    s_cselect_b32 s56, 12288, 0
    s_sub_u32 s61, s61, s56
    s_add_u32 s6, s3, s61
    s_add_u32 s56, s6, 0
    buffer_load_dwordx4 v[128:131], v100, s[20:23], s56 offen sc1
    s_add_u32 s56, s6, 49152
    buffer_load_dwordx4 v[132:135], v100, s[20:23], s56 offen sc1
    s_add_u32 s61, s61, 1024
    s_cmp_ge_u32 s61, 12288
    s_cselect_b32 s56, 12288, 0
    s_sub_u32 s61, s61, s56
    s_add_u32 s6, s3, s61
    s_add_u32 s56, s6, 0
    buffer_load_dwordx4 v[140:143], v100, s[20:23], s56 offen sc1
    s_add_u32 s56, s6, 49152
    buffer_load_dwordx4 v[144:147], v100, s[20:23], s56 offen sc1
    s_add_u32 s61, s61, 1024
    s_cmp_ge_u32 s61, 12288
    s_cselect_b32 s56, 12288, 0
    s_sub_u32 s61, s61, s56
    s_add_u32 s6, s3, s61
    s_add_u32 s56, s6, 0
    buffer_load_dwordx4 v[16:19], v100, s[20:23], s56 offen sc1
    s_add_u32 s56, s6, 49152
    buffer_load_dwordx4 v[20:23], v100, s[20:23], s56 offen sc1
    s_add_u32 s61, s61, 1024
    s_cmp_ge_u32 s61, 12288
    s_cselect_b32 s56, 12288, 0
    s_sub_u32 s61, s61, s56
    s_add_u32 s6, s3, s61
    s_add_u32 s56, s6, 0
    buffer_load_dwordx4 v[28:31], v100, s[20:23], s56 offen sc1
    s_add_u32 s56, s6, 49152
    buffer_load_dwordx4 v[32:35], v100, s[20:23], s56 offen sc1
    s_add_u32 s61, s61, 1024
    s_cmp_ge_u32 s61, 12288
    s_cselect_b32 s56, 12288, 0
    s_sub_u32 s61, s61, s56
    s_add_u32 s6, s3, s61
    s_add_u32 s56, s6, 0
    buffer_load_dwordx4 v[40:43], v100, s[20:23], s56 offen sc1
    s_add_u32 s56, s6, 49152
    buffer_load_dwordx4 v[44:47], v100, s[20:23], s56 offen sc1
    s_add_u32 s61, s61, 1024
    s_cmp_ge_u32 s61, 12288
    s_cselect_b32 s56, 12288, 0
    s_sub_u32 s61, s61, s56
    s_lshl_b32 s6, s55, 6
    s_add_u32 s56, s6, 9437184
    buffer_load_dword v101, v11, s[20:23], s56 offen sc1
    s_add_u32 s56, s6, 9437248
    buffer_load_dword v102, v11, s[20:23], s56 offen sc1
    v_mov_b32 v12, 163356
    s_mov_b32 s4, 0
Llw_58:
    ds_read_b32 v13, v12
    s_waitcnt lgkmcnt(0)
    v_readfirstlane_b32 s5, v13
    s_nop 1
    s_cmp_ge_u32 s5, 4
    s_cbranch_scc1 Llwd_59
    s_add_u32 s4, s4, 1
    s_cmp_lt_u32 s4, 160000
    s_cbranch_scc1 Llw_58
Llwd_59:
    s_add_u32 m0, s58, 129024
    s_add_u32 s56, s57, 20480
    buffer_load_dwordx4 v78, s[28:31], s56 offen lds
    s_add_u32 m0, s58, 130048
    s_add_u32 s56, s57, 30720
    buffer_load_dwordx4 v78, s[28:31], s56 offen lds
    s_add_u32 s57, s57, 40960
    s_cmp_ge_u32 s57, s63
    s_cselect_b32 s56, 491520, 0
    s_sub_u32 s57, s57, s56
    s_add_u32 m0, s58, 145408
    s_add_u32 s56, s57, 20480
    buffer_load_dwordx4 v78, s[28:31], s56 offen lds
    s_add_u32 m0, s58, 146432
    s_add_u32 s56, s57, 30720
    buffer_load_dwordx4 v78, s[28:31], s56 offen lds
    s_add_u32 s57, s57, 40960
    s_cmp_ge_u32 s57, s63
    s_cselect_b32 s56, 491520, 0
    s_sub_u32 s57, s57, s56
    ds_read_b64_tr_b16 v[80:81], v96 offset:45056
    ds_read_b64_tr_b16 v[82:83], v96 offset:47104
    ds_read_b64_tr_b16 v[84:85], v97 offset:45056
    ds_read_b64_tr_b16 v[86:87], v97 offset:47104
    ds_read_b64_tr_b16 v[88:89], v98 offset:45056
    ds_read_b64_tr_b16 v[90:91], v98 offset:47104
    ds_read_b64_tr_b16 v[92:93], v99 offset:45056
    ds_read_b64_tr_b16 v[94:95], v99 offset:47104
    ds_read_b64_tr_b16 v[52:53], v96 offset:61440
    ds_read_b64_tr_b16 v[54:55], v96 offset:63488
    ds_read_b64_tr_b16 v[56:57], v97 offset:61440
    ds_read_b64_tr_b16 v[58:59], v97 offset:63488
    ds_read_b64_tr_b16 v[60:61], v98 offset:61440
    ds_read_b64_tr_b16 v[62:63], v98 offset:63488
    ds_read_b64_tr_b16 v[64:65], v99 offset:61440
    ds_read_b64_tr_b16 v[66:67], v99 offset:63488
    s_waitcnt vmcnt(18)
    s_waitcnt lgkmcnt(14)
    v_mfma_f32_16x16x32_bf16 v[208:211], v[80:83], v[104:107], v[208:211]
    v_mfma_f32_16x16x32_bf16 v[224:227], v[80:83], v[108:111], v[224:227]
    s_waitcnt lgkmcnt(12)
    v_mfma_f32_16x16x32_bf16 v[212:215], v[84:87], v[104:107], v[212:215]
    v_mfma_f32_16x16x32_bf16 v[228:231], v[84:87], v[108:111], v[228:231]
    s_waitcnt lgkmcnt(10)
    v_mfma_f32_16x16x32_bf16 v[216:219], v[88:91], v[104:107], v[216:219]
    v_mfma_f32_16x16x32_bf16 v[232:235], v[88:91], v[108:111], v[232:235]
    s_waitcnt lgkmcnt(8)
    v_mfma_f32_16x16x32_bf16 v[220:223], v[92:95], v[104:107], v[220:223]
    v_mfma_f32_16x16x32_bf16 v[236:239], v[92:95], v[108:111], v[236:239]
    s_add_u32 s6, s3, s61
    s_add_u32 s56, s6, 0
    buffer_load_dwordx4 v[104:107], v100, s[20:23], s56 offen sc1
    s_add_u32 s56, s6, 49152
    buffer_load_dwordx4 v[108:111], v100, s[20:23], s56 offen sc1
    s_add_u32 s61, s61, 1024
    s_cmp_ge_u32 s61, 12288
    s_cselect_b32 s56, 12288, 0
    s_sub_u32 s61, s61, s56
    ds_read_b64_tr_b16 v[80:81], v4 offset:12288
    ds_read_b64_tr_b16 v[82:83], v4 offset:14336
    ds_read_b64_tr_b16 v[84:85], v5 offset:12288
    ds_read_b64_tr_b16 v[86:87], v5 offset:14336
    ds_read_b64_tr_b16 v[88:89], v6 offset:12288
    ds_read_b64_tr_b16 v[90:91], v6 offset:14336
    ds_read_b64_tr_b16 v[92:93], v7 offset:12288
    ds_read_b64_tr_b16 v[94:95], v7 offset:14336
    s_waitcnt vmcnt(18)
    s_waitcnt lgkmcnt(14)
    v_mfma_f32_16x16x32_bf16 v[208:211], v[52:55], v[116:119], v[208:211]
    v_mfma_f32_16x16x32_bf16 v[224:227], v[52:55], v[120:123], v[224:227]
    s_waitcnt lgkmcnt(12)
    v_mfma_f32_16x16x32_bf16 v[212:215], v[56:59], v[116:119], v[212:215]
    v_mfma_f32_16x16x32_bf16 v[228:231], v[56:59], v[120:123], v[228:231]
    s_waitcnt lgkmcnt(10)
    v_mfma_f32_16x16x32_bf16 v[216:219], v[60:63], v[116:119], v[216:219]
    v_mfma_f32_16x16x32_bf16 v[232:235], v[60:63], v[120:123], v[232:235]
    s_waitcnt lgkmcnt(8)
    v_mfma_f32_16x16x32_bf16 v[220:223], v[64:67], v[116:119], v[220:223]
    v_mfma_f32_16x16x32_bf16 v[236:239], v[64:67], v[120:123], v[236:239]
    s_add_u32 s6, s3, s61
    s_add_u32 s56, s6, 0
    buffer_load_dwordx4 v[116:119], v100, s[20:23], s56 offen sc1
    s_add_u32 s56, s6, 49152
    buffer_load_dwordx4 v[120:123], v100, s[20:23], s56 offen sc1
    s_add_u32 s61, s61, 1024
    s_cmp_ge_u32 s61, 12288
    s_cselect_b32 s56, 12288, 0
    s_sub_u32 s61, s61, s56
    ds_read_b64_tr_b16 v[52:53], v4 offset:28672
    ds_read_b64_tr_b16 v[54:55], v4 offset:30720
    ds_read_b64_tr_b16 v[56:57], v5 offset:28672
    ds_read_b64_tr_b16 v[58:59], v5 offset:30720
    ds_read_b64_tr_b16 v[60:61], v6 offset:28672
    ds_read_b64_tr_b16 v[62:63], v6 offset:30720
    ds_read_b64_tr_b16 v[64:65], v7 offset:28672
    ds_read_b64_tr_b16 v[66:67], v7 offset:30720
    s_waitcnt vmcnt(18)
    s_waitcnt lgkmcnt(14)
    v_mfma_f32_16x16x32_bf16 v[208:211], v[80:83], v[128:131], v[208:211]
    v_mfma_f32_16x16x32_bf16 v[224:227], v[80:83], v[132:135], v[224:227]
    s_waitcnt lgkmcnt(12)
    v_mfma_f32_16x16x32_bf16 v[212:215], v[84:87], v[128:131], v[212:215]
    v_mfma_f32_16x16x32_bf16 v[228:231], v[84:87], v[132:135], v[228:231]
    s_waitcnt lgkmcnt(10)
    v_mfma_f32_16x16x32_bf16 v[216:219], v[88:91], v[128:131], v[216:219]
    v_mfma_f32_16x16x32_bf16 v[232:235], v[88:91], v[132:135], v[232:235]
    s_waitcnt lgkmcnt(8)
    v_mfma_f32_16x16x32_bf16 v[220:223], v[92:95], v[128:131], v[220:223]
    v_mfma_f32_16x16x32_bf16 v[236:239], v[92:95], v[132:135], v[236:239]
    s_add_u32 s6, s3, s61
    s_add_u32 s56, s6, 0
    buffer_load_dwordx4 v[128:131], v100, s[20:23], s56 offen sc1
    s_add_u32 s56, s6, 49152
    buffer_load_dwordx4 v[132:135], v100, s[20:23], s56 offen sc1
    s_add_u32 s61, s61, 1024
    s_cmp_ge_u32 s61, 12288
    s_cselect_b32 s56, 12288, 0
    s_sub_u32 s61, s61, s56
    ds_read_b64_tr_b16 v[80:81], v4 offset:45056
    ds_read_b64_tr_b16 v[82:83], v4 offset:47104
    ds_read_b64_tr_b16 v[84:85], v5 offset:45056
    ds_read_b64_tr_b16 v[86:87], v5 offset:47104
    ds_read_b64_tr_b16 v[88:89], v6 offset:45056
    ds_read_b64_tr_b16 v[90:91], v6 offset:47104
    ds_read_b64_tr_b16 v[92:93], v7 offset:45056
    ds_read_b64_tr_b16 v[94:95], v7 offset:47104
    s_waitcnt vmcnt(18)
    s_waitcnt lgkmcnt(14)
    v_mfma_f32_16x16x32_bf16 v[208:211], v[52:55], v[140:143], v[208:211]
    v_mfma_f32_16x16x32_bf16 v[224:227], v[52:55], v[144:147], v[224:227]
    s_waitcnt lgkmcnt(12)
    v_mfma_f32_16x16x32_bf16 v[212:215], v[56:59], v[140:143], v[212:215]
    v_mfma_f32_16x16x32_bf16 v[228:231], v[56:59], v[144:147], v[228:231]
    s_waitcnt lgkmcnt(10)
    v_mfma_f32_16x16x32_bf16 v[216:219], v[60:63], v[140:143], v[216:219]
    v_mfma_f32_16x16x32_bf16 v[232:235], v[60:63], v[144:147], v[232:235]
    s_waitcnt lgkmcnt(8)
    v_mfma_f32_16x16x32_bf16 v[220:223], v[64:67], v[140:143], v[220:223]
    v_mfma_f32_16x16x32_bf16 v[236:239], v[64:67], v[144:147], v[236:239]
    s_add_u32 s6, s3, s61
    s_add_u32 s56, s6, 0
    buffer_load_dwordx4 v[140:143], v100, s[20:23], s56 offen sc1
    s_add_u32 s56, s6, 49152
    buffer_load_dwordx4 v[144:147], v100, s[20:23], s56 offen sc1
    s_add_u32 s61, s61, 1024
    s_cmp_ge_u32 s61, 12288
    s_cselect_b32 s56, 12288, 0
    s_sub_u32 s61, s61, s56
    ds_read_b64_tr_b16 v[52:53], v96 offset:0
    ds_read_b64_tr_b16 v[54:55], v96 offset:2048
    ds_read_b64_tr_b16 v[56:57], v97 offset:0
    ds_read_b64_tr_b16 v[58:59], v97 offset:2048
    ds_read_b64_tr_b16 v[60:61], v98 offset:0
    ds_read_b64_tr_b16 v[62:63], v98 offset:2048
    ds_read_b64_tr_b16 v[64:65], v99 offset:0
    ds_read_b64_tr_b16 v[66:67], v99 offset:2048
    s_waitcnt vmcnt(18)
    s_waitcnt lgkmcnt(14)
    v_mfma_f32_16x16x32_bf16 v[208:211], v[80:83], v[16:19], v[208:211]
    v_mfma_f32_16x16x32_bf16 v[224:227], v[80:83], v[20:23], v[224:227]
    s_waitcnt lgkmcnt(12)
    v_mfma_f32_16x16x32_bf16 v[212:215], v[84:87], v[16:19], v[212:215]
    v_mfma_f32_16x16x32_bf16 v[228:231], v[84:87], v[20:23], v[228:231]
    s_waitcnt lgkmcnt(10)
    v_mfma_f32_16x16x32_bf16 v[216:219], v[88:91], v[16:19], v[216:219]
    v_mfma_f32_16x16x32_bf16 v[232:235], v[88:91], v[20:23], v[232:235]
    s_waitcnt lgkmcnt(8)
    v_mfma_f32_16x16x32_bf16 v[220:223], v[92:95], v[16:19], v[220:223]
    v_mfma_f32_16x16x32_bf16 v[236:239], v[92:95], v[20:23], v[236:239]
    s_add_u32 s6, s3, s61
    s_add_u32 s56, s6, 0
    buffer_load_dwordx4 v[16:19], v100, s[20:23], s56 offen sc1
    s_add_u32 s56, s6, 49152
    buffer_load_dwordx4 v[20:23], v100, s[20:23], s56 offen sc1
    s_add_u32 s61, s61, 1024
    s_cmp_ge_u32 s61, 12288
    s_cselect_b32 s56, 12288, 0
    s_sub_u32 s61, s61, s56
    s_barrier
    s_add_u32 m0, s60, 10240
    s_add_u32 s56, s59, 102400
    buffer_load_dwordx4 v78, s[32:35], s56 offen lds
    s_add_u32 m0, s60, 11264
    s_add_u32 s56, s59, 112640
    buffer_load_dwordx4 v78, s[32:35], s56 offen lds
    s_add_u32 m0, s60, 12288
    s_add_u32 s56, s59, 122880
    buffer_load_dwordx4 v78, s[32:35], s56 offen lds
    s_add_u32 m0, s60, 13312
    s_add_u32 s56, s59, 133120
    buffer_load_dwordx4 v78, s[32:35], s56 offen lds
    s_add_u32 m0, s60, 14336
    s_add_u32 s56, s59, 143360
    buffer_load_dwordx4 v78, s[32:35], s56 offen lds
    s_add_u32 m0, s60, 15360
    s_add_u32 s56, s59, 153600
    buffer_load_dwordx4 v78, s[32:35], s56 offen lds
    s_add_u32 m0, s60, 16384
    s_add_u32 s56, s59, 163840
    buffer_load_dwordx4 v78, s[32:35], s56 offen lds
    s_add_u32 m0, s60, 17408
    s_add_u32 s56, s59, 174080
    buffer_load_dwordx4 v78, s[32:35], s56 offen lds
    s_add_u32 m0, s60, 18432
    s_add_u32 s56, s59, 184320
    buffer_load_dwordx4 v78, s[32:35], s56 offen lds
    s_add_u32 m0, s60, 19456
    s_add_u32 s56, s59, 194560
    buffer_load_dwordx4 v78, s[32:35], s56 offen lds
    ds_read_b64_tr_b16 v[80:81], v96 offset:16384
    ds_read_b64_tr_b16 v[82:83], v96 offset:18432
    ds_read_b64_tr_b16 v[84:85], v97 offset:16384
    ds_read_b64_tr_b16 v[86:87], v97 offset:18432
    ds_read_b64_tr_b16 v[88:89], v98 offset:16384
    ds_read_b64_tr_b16 v[90:91], v98 offset:18432
    ds_read_b64_tr_b16 v[92:93], v99 offset:16384
    ds_read_b64_tr_b16 v[94:95], v99 offset:18432
    s_waitcnt vmcnt(28)
    s_waitcnt lgkmcnt(14)
    v_mfma_f32_16x16x32_bf16 v[208:211], v[52:55], v[28:31], v[208:211]
    v_mfma_f32_16x16x32_bf16 v[224:227], v[52:55], v[32:35], v[224:227]
    s_waitcnt lgkmcnt(12)
    v_mfma_f32_16x16x32_bf16 v[212:215], v[56:59], v[28:31], v[212:215]
    v_mfma_f32_16x16x32_bf16 v[228:231], v[56:59], v[32:35], v[228:231]
    s_waitcnt lgkmcnt(10)
    v_mfma_f32_16x16x32_bf16 v[216:219], v[60:63], v[28:31], v[216:219]
    v_mfma_f32_16x16x32_bf16 v[232:235], v[60:63], v[32:35], v[232:235]
    s_waitcnt lgkmcnt(8)
    v_mfma_f32_16x16x32_bf16 v[220:223], v[64:67], v[28:31], v[220:223]
    v_mfma_f32_16x16x32_bf16 v[236:239], v[64:67], v[32:35], v[236:239]
    s_waitcnt vmcnt(20)
    s_barrier
    s_add_u32 m0, s58, 2048
    s_add_u32 s56, s57, 20480
    buffer_load_dwordx4 v78, s[28:31], s56 offen lds
    s_add_u32 m0, s58, 3072
    s_add_u32 s56, s57, 30720
    buffer_load_dwordx4 v78, s[28:31], s56 offen lds
    s_add_u32 s57, s57, 40960
    s_cmp_ge_u32 s57, s63
    s_cselect_b32 s56, 491520, 0
    s_sub_u32 s57, s57, s56
    ds_read_b64_tr_b16 v[52:53], v4 offset:61440
    ds_read_b64_tr_b16 v[54:55], v4 offset:63488
    ds_read_b64_tr_b16 v[56:57], v5 offset:61440
    ds_read_b64_tr_b16 v[58:59], v5 offset:63488
    ds_read_b64_tr_b16 v[60:61], v6 offset:61440
    ds_read_b64_tr_b16 v[62:63], v6 offset:63488
    ds_read_b64_tr_b16 v[64:65], v7 offset:61440
    ds_read_b64_tr_b16 v[66:67], v7 offset:63488
    s_waitcnt lgkmcnt(14)
    v_mfma_f32_16x16x32_bf16 v[208:211], v[80:83], v[40:43], v[208:211]
    v_mfma_f32_16x16x32_bf16 v[224:227], v[80:83], v[44:47], v[224:227]
    s_waitcnt lgkmcnt(12)
    v_mfma_f32_16x16x32_bf16 v[212:215], v[84:87], v[40:43], v[212:215]
    v_mfma_f32_16x16x32_bf16 v[228:231], v[84:87], v[44:47], v[228:231]
    s_waitcnt lgkmcnt(10)
    v_mfma_f32_16x16x32_bf16 v[216:219], v[88:91], v[40:43], v[216:219]
    v_mfma_f32_16x16x32_bf16 v[232:235], v[88:91], v[44:47], v[232:235]
    s_waitcnt lgkmcnt(8)
    v_mfma_f32_16x16x32_bf16 v[220:223], v[92:95], v[40:43], v[220:223]
    v_mfma_f32_16x16x32_bf16 v[236:239], v[92:95], v[44:47], v[236:239]
    s_barrier
    s_add_u32 m0, s58, 18432
    s_add_u32 s56, s57, 20480
    buffer_load_dwordx4 v78, s[28:31], s56 offen lds
    s_add_u32 m0, s58, 19456
    s_add_u32 s56, s57, 30720
    buffer_load_dwordx4 v78, s[28:31], s56 offen lds
    s_add_u32 s57, s57, 40960
    s_cmp_ge_u32 s57, s63
    s_cselect_b32 s56, 491520, 0
    s_sub_u32 s57, s57, s56
    ds_read_b64_tr_b16 v[80:81], v200 offset:12288
    ds_read_b64_tr_b16 v[82:83], v200 offset:14336
    ds_read_b64_tr_b16 v[84:85], v201 offset:12288
    ds_read_b64_tr_b16 v[86:87], v201 offset:14336
    ds_read_b64_tr_b16 v[88:89], v202 offset:12288
    ds_read_b64_tr_b16 v[90:91], v202 offset:14336
    ds_read_b64_tr_b16 v[92:93], v203 offset:12288
    ds_read_b64_tr_b16 v[94:95], v203 offset:14336
    s_waitcnt vmcnt(22)
    s_waitcnt lgkmcnt(14)
    v_mfma_f32_16x16x32_bf16 v[208:211], v[52:55], v[104:107], v[208:211]
    v_mfma_f32_16x16x32_bf16 v[224:227], v[52:55], v[108:111], v[224:227]
    s_waitcnt lgkmcnt(12)
    v_mfma_f32_16x16x32_bf16 v[212:215], v[56:59], v[104:107], v[212:215]
    v_mfma_f32_16x16x32_bf16 v[228:231], v[56:59], v[108:111], v[228:231]
    s_waitcnt lgkmcnt(10)
    v_mfma_f32_16x16x32_bf16 v[216:219], v[60:63], v[104:107], v[216:219]
    v_mfma_f32_16x16x32_bf16 v[232:235], v[60:63], v[108:111], v[232:235]
    s_waitcnt lgkmcnt(8)
    v_mfma_f32_16x16x32_bf16 v[220:223], v[64:67], v[104:107], v[220:223]
    v_mfma_f32_16x16x32_bf16 v[236:239], v[64:67], v[108:111], v[236:239]
    s_waitcnt vmcnt(2)
    s_barrier
    s_add_u32 m0, s58, 129024
    s_add_u32 s56, s57, 20480
    buffer_load_dwordx4 v78, s[28:31], s56 offen lds
    s_add_u32 m0, s58, 130048
    s_add_u32 s56, s57, 30720
    buffer_load_dwordx4 v78, s[28:31], s56 offen lds
    s_add_u32 s57, s57, 40960
    s_cmp_ge_u32 s57, s63
    s_cselect_b32 s56, 491520, 0
    s_sub_u32 s57, s57, s56
    ds_read_b64_tr_b16 v[52:53], v96 offset:0
    ds_read_b64_tr_b16 v[54:55], v96 offset:2048
    ds_read_b64_tr_b16 v[56:57], v97 offset:0
    ds_read_b64_tr_b16 v[58:59], v97 offset:2048
    ds_read_b64_tr_b16 v[60:61], v98 offset:0
    ds_read_b64_tr_b16 v[62:63], v98 offset:2048
    ds_read_b64_tr_b16 v[64:65], v99 offset:0
    ds_read_b64_tr_b16 v[66:67], v99 offset:2048
    s_waitcnt lgkmcnt(14)
    v_mfma_f32_16x16x32_bf16 v[208:211], v[80:83], v[116:119], v[208:211]
    v_mfma_f32_16x16x32_bf16 v[224:227], v[80:83], v[120:123], v[224:227]
    s_waitcnt lgkmcnt(12)
    v_mfma_f32_16x16x32_bf16 v[212:215], v[84:87], v[116:119], v[212:215]
    v_mfma_f32_16x16x32_bf16 v[228:231], v[84:87], v[120:123], v[228:231]
    s_waitcnt lgkmcnt(10)
    v_mfma_f32_16x16x32_bf16 v[216:219], v[88:91], v[116:119], v[216:219]
    v_mfma_f32_16x16x32_bf16 v[232:235], v[88:91], v[120:123], v[232:235]
    s_waitcnt lgkmcnt(8)
    v_mfma_f32_16x16x32_bf16 v[220:223], v[92:95], v[116:119], v[220:223]
    v_mfma_f32_16x16x32_bf16 v[236:239], v[92:95], v[120:123], v[236:239]
    s_waitcnt vmcnt(0)
    s_barrier
    ds_read_b64_tr_b16 v[80:81], v96 offset:16384
    ds_read_b64_tr_b16 v[82:83], v96 offset:18432
    ds_read_b64_tr_b16 v[84:85], v97 offset:16384
    ds_read_b64_tr_b16 v[86:87], v97 offset:18432
    ds_read_b64_tr_b16 v[88:89], v98 offset:16384
    ds_read_b64_tr_b16 v[90:91], v98 offset:18432
    ds_read_b64_tr_b16 v[92:93], v99 offset:16384
    ds_read_b64_tr_b16 v[94:95], v99 offset:18432
    s_waitcnt lgkmcnt(14)
    v_mfma_f32_16x16x32_bf16 v[208:211], v[52:55], v[128:131], v[208:211]
    v_mfma_f32_16x16x32_bf16 v[224:227], v[52:55], v[132:135], v[224:227]
    s_waitcnt lgkmcnt(12)
    v_mfma_f32_16x16x32_bf16 v[212:215], v[56:59], v[128:131], v[212:215]
    v_mfma_f32_16x16x32_bf16 v[228:231], v[56:59], v[132:135], v[228:231]
    s_waitcnt lgkmcnt(10)
    v_mfma_f32_16x16x32_bf16 v[216:219], v[60:63], v[128:131], v[216:219]
    v_mfma_f32_16x16x32_bf16 v[232:235], v[60:63], v[132:135], v[232:235]
    s_waitcnt lgkmcnt(8)
    v_mfma_f32_16x16x32_bf16 v[220:223], v[64:67], v[128:131], v[220:223]
    v_mfma_f32_16x16x32_bf16 v[236:239], v[64:67], v[132:135], v[236:239]
    ds_read_b64_tr_b16 v[52:53], v4 offset:61440
    ds_read_b64_tr_b16 v[54:55], v4 offset:63488
    ds_read_b64_tr_b16 v[56:57], v5 offset:61440
    ds_read_b64_tr_b16 v[58:59], v5 offset:63488
    ds_read_b64_tr_b16 v[60:61], v6 offset:61440
    ds_read_b64_tr_b16 v[62:63], v6 offset:63488
    ds_read_b64_tr_b16 v[64:65], v7 offset:61440
    ds_read_b64_tr_b16 v[66:67], v7 offset:63488
    s_waitcnt lgkmcnt(14)
    v_mfma_f32_16x16x32_bf16 v[208:211], v[80:83], v[140:143], v[208:211]
    v_mfma_f32_16x16x32_bf16 v[224:227], v[80:83], v[144:147], v[224:227]
    s_waitcnt lgkmcnt(12)
    v_mfma_f32_16x16x32_bf16 v[212:215], v[84:87], v[140:143], v[212:215]
    v_mfma_f32_16x16x32_bf16 v[228:231], v[84:87], v[144:147], v[228:231]
    s_waitcnt lgkmcnt(10)
    v_mfma_f32_16x16x32_bf16 v[216:219], v[88:91], v[140:143], v[216:219]
    v_mfma_f32_16x16x32_bf16 v[232:235], v[88:91], v[144:147], v[232:235]
    s_waitcnt lgkmcnt(8)
    v_mfma_f32_16x16x32_bf16 v[220:223], v[92:95], v[140:143], v[220:223]
    v_mfma_f32_16x16x32_bf16 v[236:239], v[92:95], v[144:147], v[236:239]
    s_waitcnt lgkmcnt(6)
    v_mfma_f32_16x16x32_bf16 v[208:211], v[52:55], v[16:19], v[208:211]
    v_mfma_f32_16x16x32_bf16 v[224:227], v[52:55], v[20:23], v[224:227]
    s_waitcnt lgkmcnt(4)
    v_mfma_f32_16x16x32_bf16 v[212:215], v[56:59], v[16:19], v[212:215]
    v_mfma_f32_16x16x32_bf16 v[228:231], v[56:59], v[20:23], v[228:231]
    s_waitcnt lgkmcnt(2)
    v_mfma_f32_16x16x32_bf16 v[216:219], v[60:63], v[16:19], v[216:219]
    v_mfma_f32_16x16x32_bf16 v[232:235], v[60:63], v[20:23], v[232:235]
    s_waitcnt lgkmcnt(0)
    v_mfma_f32_16x16x32_bf16 v[220:223], v[64:67], v[16:19], v[220:223]
    v_mfma_f32_16x16x32_bf16 v[236:239], v[64:67], v[20:23], v[236:239]
    v_sub_f32 v12, 1.0, v101
    v_pk_mul_f32 v[208:209], v[208:209], v[12:13] op_sel_hi:[1,0]
    v_pk_mul_f32 v[210:211], v[210:211], v[12:13] op_sel_hi:[1,0]
    v_pk_mul_f32 v[212:213], v[212:213], v[12:13] op_sel_hi:[1,0]
    v_pk_mul_f32 v[214:215], v[214:215], v[12:13] op_sel_hi:[1,0]
    v_pk_mul_f32 v[216:217], v[216:217], v[12:13] op_sel_hi:[1,0]
    v_pk_mul_f32 v[218:219], v[218:219], v[12:13] op_sel_hi:[1,0]
    v_pk_mul_f32 v[220:221], v[220:221], v[12:13] op_sel_hi:[1,0]
    v_pk_mul_f32 v[222:223], v[222:223], v[12:13] op_sel_hi:[1,0]
    v_sub_f32 v12, 1.0, v102
    v_pk_mul_f32 v[224:225], v[224:225], v[12:13] op_sel_hi:[1,0]
    v_pk_mul_f32 v[226:227], v[226:227], v[12:13] op_sel_hi:[1,0]
    v_pk_mul_f32 v[228:229], v[228:229], v[12:13] op_sel_hi:[1,0]
    v_pk_mul_f32 v[230:231], v[230:231], v[12:13] op_sel_hi:[1,0]
    v_pk_mul_f32 v[232:233], v[232:233], v[12:13] op_sel_hi:[1,0]
    v_pk_mul_f32 v[234:235], v[234:235], v[12:13] op_sel_hi:[1,0]
    v_pk_mul_f32 v[236:237], v[236:237], v[12:13] op_sel_hi:[1,0]
    v_pk_mul_f32 v[238:239], v[238:239], v[12:13] op_sel_hi:[1,0]
    v_and_b32 v12, 1, v0
    v_lshlrev_b32 v12, 2, v12
    v_bfe_u32 v13, v0, 1, 1
    v_lshl_add_u32 v12, v13, 8, v12
    s_lshl_b32 s56, s45, 9
    s_lshl_b32 s6, s53, 3
    s_add_u32 s56, s56, s6
    v_add_u32 v12, s56, v12
    v_cmp_gt_u32 vcc, 4, v0
    v_mov_b32 v13, 1073741824
    s_nop 0
    v_cndmask_b32 v12, v13, v12, vcc
    s_mov_b32 s4, 0
    s_mov_b32 s5, 10575872
    s_mov_b32 s7, 0xf
Lpoll_60:
    buffer_load_dword v10, v12, s[20:23], s5 offen sc1
    s_waitcnt vmcnt(0)
    v_cmp_eq_u32 vcc, s49, v10
    s_nop 1
    s_and_b32 s6, vcc_lo, s7
    s_cmp_eq_u32 s6, s7
    s_cbranch_scc1 Lpd_61
    s_add_u32 s4, s4, 1
    s_cmp_lt_u32 s4, 40000
    s_sleep 1
    s_cbranch_scc1 Lpoll_60
Lpd_61:
    s_mul_i32 s6, s55, 24
    s_mul_i32 s56, s53, 6
    s_add_u32 s6, s6, s56
    s_lshl_b32 s6, s6, 10
    s_add_u32 s56, s6, 11534336
    buffer_load_dwordx4 v[104:107], v100, s[20:23], s56 offen sc1
    s_add_u32 s56, s6, 11558912
    buffer_load_dwordx4 v[108:111], v100, s[20:23], s56 offen sc1
    s_add_u32 s56, s6, 11535360
    buffer_load_dwordx4 v[116:119], v100, s[20:23], s56 offen sc1
    s_add_u32 s56, s6, 11559936
    buffer_load_dwordx4 v[120:123], v100, s[20:23], s56 offen sc1
    s_add_u32 s56, s6, 11536384
    buffer_load_dwordx4 v[128:131], v100, s[20:23], s56 offen sc1
    s_add_u32 s56, s6, 11560960
    buffer_load_dwordx4 v[132:135], v100, s[20:23], s56 offen sc1
    s_add_u32 s56, s6, 11537408
    buffer_load_dwordx4 v[140:143], v100, s[20:23], s56 offen sc1
    s_add_u32 s56, s6, 11561984
    buffer_load_dwordx4 v[144:147], v100, s[20:23], s56 offen sc1
    s_add_u32 s56, s6, 11538432
    buffer_load_dwordx4 v[28:31], v100, s[20:23], s56 offen sc1
    s_add_u32 s56, s6, 11563008
    buffer_load_dwordx4 v[32:35], v100, s[20:23], s56 offen sc1
    s_add_u32 s56, s6, 11539456
    buffer_load_dwordx4 v[40:43], v100, s[20:23], s56 offen sc1
    s_add_u32 s56, s6, 11564032
    buffer_load_dwordx4 v[44:47], v100, s[20:23], s56 offen sc1
    ds_read_b64_tr_b16 v[80:81], v68
    ds_read_b64_tr_b16 v[82:83], v69
    v_xor_b32 v14, 32, v68
    ds_read_b64_tr_b16 v[84:85], v14
    v_xor_b32 v15, 32, v69
    ds_read_b64_tr_b16 v[86:87], v15
    v_xor_b32 v14, 64, v68
    ds_read_b64_tr_b16 v[88:89], v14
    v_xor_b32 v15, 64, v69
    ds_read_b64_tr_b16 v[90:91], v15
    v_xor_b32 v14, 96, v68
    ds_read_b64_tr_b16 v[92:93], v14
    v_xor_b32 v15, 96, v69
    ds_read_b64_tr_b16 v[94:95], v15
    ds_read_b64_tr_b16 v[52:53], v70
    ds_read_b64_tr_b16 v[54:55], v71
    v_xor_b32 v14, 32, v70
    ds_read_b64_tr_b16 v[56:57], v14
    v_xor_b32 v15, 32, v71
    ds_read_b64_tr_b16 v[58:59], v15
    v_xor_b32 v14, 64, v70
    ds_read_b64_tr_b16 v[60:61], v14
    v_xor_b32 v15, 64, v71
    ds_read_b64_tr_b16 v[62:63], v15
    v_xor_b32 v14, 96, v70
    ds_read_b64_tr_b16 v[64:65], v14
    v_xor_b32 v15, 96, v71
    ds_read_b64_tr_b16 v[66:67], v15
    s_waitcnt vmcnt(10)
    s_waitcnt lgkmcnt(14)
    v_mfma_f32_16x16x32_bf16 v[208:211], v[80:83], v[104:107], v[208:211]
    v_mfma_f32_16x16x32_bf16 v[224:227], v[80:83], v[108:111], v[224:227]
    s_waitcnt lgkmcnt(12)
    v_mfma_f32_16x16x32_bf16 v[212:215], v[84:87], v[104:107], v[212:215]
    v_mfma_f32_16x16x32_bf16 v[228:231], v[84:87], v[108:111], v[228:231]
    s_waitcnt lgkmcnt(10)
    v_mfma_f32_16x16x32_bf16 v[216:219], v[88:91], v[104:107], v[216:219]
    v_mfma_f32_16x16x32_bf16 v[232:235], v[88:91], v[108:111], v[232:235]
    s_waitcnt lgkmcnt(8)
    v_mfma_f32_16x16x32_bf16 v[220:223], v[92:95], v[104:107], v[220:223]
    v_mfma_f32_16x16x32_bf16 v[236:239], v[92:95], v[108:111], v[236:239]
    ds_read_b64_tr_b16 v[80:81], v72
    ds_read_b64_tr_b16 v[82:83], v73
    v_xor_b32 v14, 32, v72
    ds_read_b64_tr_b16 v[84:85], v14
    v_xor_b32 v15, 32, v73
    ds_read_b64_tr_b16 v[86:87], v15
    v_xor_b32 v14, 64, v72
    ds_read_b64_tr_b16 v[88:89], v14
    v_xor_b32 v15, 64, v73
    ds_read_b64_tr_b16 v[90:91], v15
    v_xor_b32 v14, 96, v72
    ds_read_b64_tr_b16 v[92:93], v14
    v_xor_b32 v15, 96, v73
    ds_read_b64_tr_b16 v[94:95], v15
    s_waitcnt vmcnt(8)
    s_waitcnt lgkmcnt(14)
    v_mfma_f32_16x16x32_bf16 v[208:211], v[52:55], v[116:119], v[208:211]
    v_mfma_f32_16x16x32_bf16 v[224:227], v[52:55], v[120:123], v[224:227]
    s_waitcnt lgkmcnt(12)
    v_mfma_f32_16x16x32_bf16 v[212:215], v[56:59], v[116:119], v[212:215]
    v_mfma_f32_16x16x32_bf16 v[228:231], v[56:59], v[120:123], v[228:231]
    s_waitcnt lgkmcnt(10)
    v_mfma_f32_16x16x32_bf16 v[216:219], v[60:63], v[116:119], v[216:219]
    v_mfma_f32_16x16x32_bf16 v[232:235], v[60:63], v[120:123], v[232:235]
    s_waitcnt lgkmcnt(8)
    v_mfma_f32_16x16x32_bf16 v[220:223], v[64:67], v[116:119], v[220:223]
    v_mfma_f32_16x16x32_bf16 v[236:239], v[64:67], v[120:123], v[236:239]
    ds_read_b64_tr_b16 v[52:53], v74
    ds_read_b64_tr_b16 v[54:55], v75
    v_xor_b32 v14, 32, v74
    ds_read_b64_tr_b16 v[56:57], v14
    v_xor_b32 v15, 32, v75
    ds_read_b64_tr_b16 v[58:59], v15
    v_xor_b32 v14, 64, v74
    ds_read_b64_tr_b16 v[60:61], v14
    v_xor_b32 v15, 64, v75
    ds_read_b64_tr_b16 v[62:63], v15
    v_xor_b32 v14, 96, v74
    ds_read_b64_tr_b16 v[64:65], v14
    v_xor_b32 v15, 96, v75
    ds_read_b64_tr_b16 v[66:67], v15
    s_waitcnt vmcnt(6)
    s_waitcnt lgkmcnt(14)
    v_mfma_f32_16x16x32_bf16 v[208:211], v[80:83], v[128:131], v[208:211]
    v_mfma_f32_16x16x32_bf16 v[224:227], v[80:83], v[132:135], v[224:227]
    s_waitcnt lgkmcnt(12)
    v_mfma_f32_16x16x32_bf16 v[212:215], v[84:87], v[128:131], v[212:215]
    v_mfma_f32_16x16x32_bf16 v[228:231], v[84:87], v[132:135], v[228:231]
    s_waitcnt lgkmcnt(10)
    v_mfma_f32_16x16x32_bf16 v[216:219], v[88:91], v[128:131], v[216:219]
    v_mfma_f32_16x16x32_bf16 v[232:235], v[88:91], v[132:135], v[232:235]
    s_waitcnt lgkmcnt(8)
    v_mfma_f32_16x16x32_bf16 v[220:223], v[92:95], v[128:131], v[220:223]
    v_mfma_f32_16x16x32_bf16 v[236:239], v[92:95], v[132:135], v[236:239]
    ds_read_b64_tr_b16 v[80:81], v76
    ds_read_b64_tr_b16 v[82:83], v77
    v_xor_b32 v14, 32, v76
    ds_read_b64_tr_b16 v[84:85], v14
    v_xor_b32 v15, 32, v77
    ds_read_b64_tr_b16 v[86:87], v15
    v_xor_b32 v14, 64, v76
    ds_read_b64_tr_b16 v[88:89], v14
    v_xor_b32 v15, 64, v77
    ds_read_b64_tr_b16 v[90:91], v15
    v_xor_b32 v14, 96, v76
    ds_read_b64_tr_b16 v[92:93], v14
    v_xor_b32 v15, 96, v77
    ds_read_b64_tr_b16 v[94:95], v15
    s_waitcnt vmcnt(4)
    s_waitcnt lgkmcnt(14)
    v_mfma_f32_16x16x32_bf16 v[208:211], v[52:55], v[140:143], v[208:211]
    v_mfma_f32_16x16x32_bf16 v[224:227], v[52:55], v[144:147], v[224:227]
    s_waitcnt lgkmcnt(12)
    v_mfma_f32_16x16x32_bf16 v[212:215], v[56:59], v[140:143], v[212:215]
    v_mfma_f32_16x16x32_bf16 v[228:231], v[56:59], v[144:147], v[228:231]
    s_waitcnt lgkmcnt(10)
    v_mfma_f32_16x16x32_bf16 v[216:219], v[60:63], v[140:143], v[216:219]
    v_mfma_f32_16x16x32_bf16 v[232:235], v[60:63], v[144:147], v[232:235]
    s_waitcnt lgkmcnt(8)
    v_mfma_f32_16x16x32_bf16 v[220:223], v[64:67], v[140:143], v[220:223]
    v_mfma_f32_16x16x32_bf16 v[236:239], v[64:67], v[144:147], v[236:239]
    ds_read_b64_tr_b16 v[52:53], v198
    ds_read_b64_tr_b16 v[54:55], v199
    v_xor_b32 v14, 32, v198
    ds_read_b64_tr_b16 v[56:57], v14
    v_xor_b32 v15, 32, v199
    ds_read_b64_tr_b16 v[58:59], v15
    v_xor_b32 v14, 64, v198
    ds_read_b64_tr_b16 v[60:61], v14
    v_xor_b32 v15, 64, v199
    ds_read_b64_tr_b16 v[62:63], v15
    v_xor_b32 v14, 96, v198
    ds_read_b64_tr_b16 v[64:65], v14
    v_xor_b32 v15, 96, v199
    ds_read_b64_tr_b16 v[66:67], v15
    s_waitcnt vmcnt(2)
    s_waitcnt lgkmcnt(14)
    v_mfma_f32_16x16x32_bf16 v[208:211], v[80:83], v[28:31], v[208:211]
    v_mfma_f32_16x16x32_bf16 v[224:227], v[80:83], v[32:35], v[224:227]
    s_waitcnt lgkmcnt(12)
    v_mfma_f32_16x16x32_bf16 v[212:215], v[84:87], v[28:31], v[212:215]
    v_mfma_f32_16x16x32_bf16 v[228:231], v[84:87], v[32:35], v[228:231]
    s_waitcnt lgkmcnt(10)
    v_mfma_f32_16x16x32_bf16 v[216:219], v[88:91], v[28:31], v[216:219]
    v_mfma_f32_16x16x32_bf16 v[232:235], v[88:91], v[32:35], v[232:235]
    s_waitcnt lgkmcnt(8)
    v_mfma_f32_16x16x32_bf16 v[220:223], v[92:95], v[28:31], v[220:223]
    v_mfma_f32_16x16x32_bf16 v[236:239], v[92:95], v[32:35], v[236:239]
    s_waitcnt vmcnt(0)
    s_waitcnt lgkmcnt(6)
    v_mfma_f32_16x16x32_bf16 v[208:211], v[52:55], v[40:43], v[208:211]
    v_mfma_f32_16x16x32_bf16 v[224:227], v[52:55], v[44:47], v[224:227]
    s_waitcnt lgkmcnt(4)
    v_mfma_f32_16x16x32_bf16 v[212:215], v[56:59], v[40:43], v[212:215]
    v_mfma_f32_16x16x32_bf16 v[228:231], v[56:59], v[44:47], v[228:231]
    s_waitcnt lgkmcnt(2)
    v_mfma_f32_16x16x32_bf16 v[216:219], v[60:63], v[40:43], v[216:219]
    v_mfma_f32_16x16x32_bf16 v[232:235], v[60:63], v[44:47], v[232:235]
    s_waitcnt lgkmcnt(0)
    v_mfma_f32_16x16x32_bf16 v[220:223], v[64:67], v[40:43], v[220:223]
    v_mfma_f32_16x16x32_bf16 v[236:239], v[64:67], v[44:47], v[236:239]
    s_barrier
Lfin:
    v_lshlrev_b32 v1, 4, v0
    s_mul_i32 s57, s44, 9216
    s_cmp_ge_u32 s44, 4
    s_cselect_b32 s56, 90112, 0
    s_add_u32 s57, s57, s56
    v_add_u32 v2, s57, v1
    v_and_b32 v3, 15, v0
    v_mul_u32_u24 v3, 1280, v3
    v_lshrrev_b32 v4, 4, v0
    v_lshl_add_u32 v3, v4, 3, v3
    s_mul_i32 s58, s55, 20480
    s_lshl_b32 s59, s50, 7
    s_add_u32 s58, s58, s59
    s_lshl_b32 s59, s53, 5
    s_add_u32 s58, s58, s59
    s_cmp_lt_u32 s51, 2
    s_cselect_b32 s59, s54, 0
    s_cmp_eq_u32 s59, 1
    s_cselect_b32 s59, 1073741824, 0
    v_add_u32 v5, s59, v3
    s_cmp_eq_u32 s53, 1
    s_cbranch_scc1 Lfk_63
    s_cmp_eq_u32 s53, 2
    s_cbranch_scc1 Lfk_64
    s_cmp_eq_u32 s53, 3
    s_cbranch_scc1 Lfk_65
Lfk_62:
    ds_write_b128 v2, v[212:215] offset:0
    ds_write_b128 v2, v[216:219] offset:1024
    ds_write_b128 v2, v[220:223] offset:2048
    ds_write_b128 v2, v[228:231] offset:3072
    ds_write_b128 v2, v[232:235] offset:4096
    ds_write_b128 v2, v[236:239] offset:5120
    ds_write_b128 v2, v[244:247] offset:6144
    ds_write_b128 v2, v[248:251] offset:7168
    ds_write_b128 v2, v[252:255] offset:8192
    s_lshl_b32 s60, s54, 2
    s_add_u32 s60, s60, 1
    s_mul_i32 s61, s60, 9216
    s_cmp_ge_u32 s60, 4
    s_cselect_b32 s56, 90112, 0
    s_add_u32 s61, s61, s56
    s_add_u32 s61, s61, 0
    v_add_u32 v6, s61, v1
    s_lshl_b32 s60, s54, 2
    s_add_u32 s60, s60, 2
    s_mul_i32 s61, s60, 9216
    s_cmp_ge_u32 s60, 4
    s_cselect_b32 s56, 90112, 0
    s_add_u32 s61, s61, s56
    s_add_u32 s61, s61, 0
    v_add_u32 v7, s61, v1
    s_lshl_b32 s60, s54, 2
    s_add_u32 s60, s60, 3
    s_mul_i32 s61, s60, 9216
    s_cmp_ge_u32 s60, 4
    s_cselect_b32 s56, 90112, 0
    s_add_u32 s61, s61, s56
    s_add_u32 s61, s61, 0
    v_add_u32 v8, s61, v1
    s_waitcnt lgkmcnt(0)
    s_barrier
    ds_read_b128 v[16:19], v6 offset:0
    ds_read_b128 v[20:23], v7 offset:0
    ds_read_b128 v[24:27], v8 offset:0
    ds_read_b128 v[28:31], v6 offset:3072
    ds_read_b128 v[32:35], v7 offset:3072
    ds_read_b128 v[36:39], v8 offset:3072
    ds_read_b128 v[40:43], v6 offset:6144
    ds_read_b128 v[44:47], v7 offset:6144
    ds_read_b128 v[48:51], v8 offset:6144
    s_waitcnt lgkmcnt(6)
    v_add_f32 v16, v16, v20
    v_add_f32 v208, v208, v24
    v_add_f32 v17, v17, v21
    v_add_f32 v209, v209, v25
    v_add_f32 v18, v18, v22
    v_add_f32 v210, v210, v26
    v_add_f32 v19, v19, v23
    v_add_f32 v211, v211, v27
    v_add_f32 v208, v208, v16
    v_add_f32 v209, v209, v17
    v_add_f32 v210, v210, v18
    v_add_f32 v211, v211, v19
    v_cvt_pk_bf16_f32 v16, v208, v209
    v_cvt_pk_bf16_f32 v17, v210, v211
    s_add_u32 s56, s58, 0
    buffer_store_dwordx2 v[16:17], v3, s[36:39], s56 offen
    s_waitcnt lgkmcnt(3)
    v_add_f32 v28, v28, v32
    v_add_f32 v224, v224, v36
    v_add_f32 v29, v29, v33
    v_add_f32 v225, v225, v37
    v_add_f32 v30, v30, v34
    v_add_f32 v226, v226, v38
    v_add_f32 v31, v31, v35
    v_add_f32 v227, v227, v39
    v_add_f32 v224, v224, v28
    v_add_f32 v225, v225, v29
    v_add_f32 v226, v226, v30
    v_add_f32 v227, v227, v31
    v_cvt_pk_bf16_f32 v28, v224, v225
    v_cvt_pk_bf16_f32 v29, v226, v227
    s_add_u32 s56, s58, 20480
    buffer_store_dwordx2 v[28:29], v3, s[36:39], s56 offen
    s_waitcnt lgkmcnt(0)
    v_add_f32 v40, v40, v44
    v_add_f32 v240, v240, v48
    v_add_f32 v41, v41, v45
    v_add_f32 v241, v241, v49
    v_add_f32 v42, v42, v46
    v_add_f32 v242, v242, v50
    v_add_f32 v43, v43, v47
    v_add_f32 v243, v243, v51
    v_add_f32 v240, v240, v40
    v_add_f32 v241, v241, v41
    v_add_f32 v242, v242, v42
    v_add_f32 v243, v243, v43
    v_cvt_pk_bf16_f32 v40, v240, v241
    v_cvt_pk_bf16_f32 v41, v242, v243
    s_add_u32 s56, s58, 40960
    buffer_store_dwordx2 v[40:41], v5, s[36:39], s56 offen
    s_branch Lfd_66
Lfk_63:
    ds_write_b128 v2, v[208:211] offset:0
    ds_write_b128 v2, v[216:219] offset:1024
    ds_write_b128 v2, v[220:223] offset:2048
    ds_write_b128 v2, v[224:227] offset:3072
    ds_write_b128 v2, v[232:235] offset:4096
    ds_write_b128 v2, v[236:239] offset:5120
    ds_write_b128 v2, v[240:243] offset:6144
    ds_write_b128 v2, v[248:251] offset:7168
    ds_write_b128 v2, v[252:255] offset:8192
    s_lshl_b32 s60, s54, 2
    s_add_u32 s60, s60, 0
    s_mul_i32 s61, s60, 9216
    s_cmp_ge_u32 s60, 4
    s_cselect_b32 s56, 90112, 0
    s_add_u32 s61, s61, s56
    s_add_u32 s61, s61, 0
    v_add_u32 v6, s61, v1
    s_lshl_b32 s60, s54, 2
    s_add_u32 s60, s60, 2
    s_mul_i32 s61, s60, 9216
    s_cmp_ge_u32 s60, 4
    s_cselect_b32 s56, 90112, 0
    s_add_u32 s61, s61, s56
    s_add_u32 s61, s61, 1024
    v_add_u32 v7, s61, v1
    s_lshl_b32 s60, s54, 2
    s_add_u32 s60, s60, 3
    s_mul_i32 s61, s60, 9216
    s_cmp_ge_u32 s60, 4
    s_cselect_b32 s56, 90112, 0
    s_add_u32 s61, s61, s56
    s_add_u32 s61, s61, 1024
    v_add_u32 v8, s61, v1
    s_waitcnt lgkmcnt(0)
    s_barrier
    ds_read_b128 v[16:19], v6 offset:0
    ds_read_b128 v[20:23], v7 offset:0
    ds_read_b128 v[24:27], v8 offset:0
    ds_read_b128 v[28:31], v6 offset:3072
    ds_read_b128 v[32:35], v7 offset:3072
    ds_read_b128 v[36:39], v8 offset:3072
    ds_read_b128 v[40:43], v6 offset:6144
    ds_read_b128 v[44:47], v7 offset:6144
    ds_read_b128 v[48:51], v8 offset:6144
    s_waitcnt lgkmcnt(6)
    v_add_f32 v16, v16, v20
    v_add_f32 v212, v212, v24
    v_add_f32 v17, v17, v21
    v_add_f32 v213, v213, v25
    v_add_f32 v18, v18, v22
    v_add_f32 v214, v214, v26
    v_add_f32 v19, v19, v23
    v_add_f32 v215, v215, v27
    v_add_f32 v212, v212, v16
    v_add_f32 v213, v213, v17
    v_add_f32 v214, v214, v18
    v_add_f32 v215, v215, v19
    v_cvt_pk_bf16_f32 v16, v212, v213
    v_cvt_pk_bf16_f32 v17, v214, v215
    s_add_u32 s56, s58, 0
    buffer_store_dwordx2 v[16:17], v3, s[36:39], s56 offen
    s_waitcnt lgkmcnt(3)
    v_add_f32 v28, v28, v32
    v_add_f32 v228, v228, v36
    v_add_f32 v29, v29, v33
    v_add_f32 v229, v229, v37
    v_add_f32 v30, v30, v34
    v_add_f32 v230, v230, v38
    v_add_f32 v31, v31, v35
    v_add_f32 v231, v231, v39
    v_add_f32 v228, v228, v28
    v_add_f32 v229, v229, v29
    v_add_f32 v230, v230, v30
    v_add_f32 v231, v231, v31
    v_cvt_pk_bf16_f32 v28, v228, v229
    v_cvt_pk_bf16_f32 v29, v230, v231
    s_add_u32 s56, s58, 20480
    buffer_store_dwordx2 v[28:29], v3, s[36:39], s56 offen
    s_waitcnt lgkmcnt(0)
    v_add_f32 v40, v40, v44
    v_add_f32 v244, v244, v48
    v_add_f32 v41, v41, v45
    v_add_f32 v245, v245, v49
    v_add_f32 v42, v42, v46
    v_add_f32 v246, v246, v50
    v_add_f32 v43, v43, v47
    v_add_f32 v247, v247, v51
    v_add_f32 v244, v244, v40
    v_add_f32 v245, v245, v41
    v_add_f32 v246, v246, v42
    v_add_f32 v247, v247, v43
    v_cvt_pk_bf16_f32 v40, v244, v245
    v_cvt_pk_bf16_f32 v41, v246, v247
    s_add_u32 s56, s58, 40960
    buffer_store_dwordx2 v[40:41], v5, s[36:39], s56 offen
    s_branch Lfd_66
Lfk_64:
    ds_write_b128 v2, v[208:211] offset:0
    ds_write_b128 v2, v[212:215] offset:1024
    ds_write_b128 v2, v[220:223] offset:2048
    ds_write_b128 v2, v[224:227] offset:3072
    ds_write_b128 v2, v[228:231] offset:4096
    ds_write_b128 v2, v[236:239] offset:5120
    ds_write_b128 v2, v[240:243] offset:6144
    ds_write_b128 v2, v[244:247] offset:7168
    ds_write_b128 v2, v[252:255] offset:8192
    s_lshl_b32 s60, s54, 2
    s_add_u32 s60, s60, 0
    s_mul_i32 s61, s60, 9216
    s_cmp_ge_u32 s60, 4
    s_cselect_b32 s56, 90112, 0
    s_add_u32 s61, s61, s56
    s_add_u32 s61, s61, 1024
    v_add_u32 v6, s61, v1
    s_lshl_b32 s60, s54, 2
    s_add_u32 s60, s60, 1
    s_mul_i32 s61, s60, 9216
    s_cmp_ge_u32 s60, 4
    s_cselect_b32 s56, 90112, 0
    s_add_u32 s61, s61, s56
    s_add_u32 s61, s61, 1024
    v_add_u32 v7, s61, v1
    s_lshl_b32 s60, s54, 2
    s_add_u32 s60, s60, 3
    s_mul_i32 s61, s60, 9216
    s_cmp_ge_u32 s60, 4
    s_cselect_b32 s56, 90112, 0
    s_add_u32 s61, s61, s56
    s_add_u32 s61, s61, 2048
    v_add_u32 v8, s61, v1
    s_waitcnt lgkmcnt(0)
    s_barrier
    ds_read_b128 v[16:19], v6 offset:0
    ds_read_b128 v[20:23], v7 offset:0
    ds_read_b128 v[24:27], v8 offset:0
    ds_read_b128 v[28:31], v6 offset:3072
    ds_read_b128 v[32:35], v7 offset:3072
    ds_read_b128 v[36:39], v8 offset:3072
    ds_read_b128 v[40:43], v6 offset:6144
    ds_read_b128 v[44:47], v7 offset:6144
    ds_read_b128 v[48:51], v8 offset:6144
    s_waitcnt lgkmcnt(6)
    v_add_f32 v16, v16, v20
    v_add_f32 v216, v216, v24
    v_add_f32 v17, v17, v21
    v_add_f32 v217, v217, v25
    v_add_f32 v18, v18, v22
    v_add_f32 v218, v218, v26
    v_add_f32 v19, v19, v23
    v_add_f32 v219, v219, v27
    v_add_f32 v216, v216, v16
    v_add_f32 v217, v217, v17
    v_add_f32 v218, v218, v18
    v_add_f32 v219, v219, v19
    v_cvt_pk_bf16_f32 v16, v216, v217
    v_cvt_pk_bf16_f32 v17, v218, v219
    s_add_u32 s56, s58, 0
    buffer_store_dwordx2 v[16:17], v3, s[36:39], s56 offen
    s_waitcnt lgkmcnt(3)
    v_add_f32 v28, v28, v32
    v_add_f32 v232, v232, v36
    v_add_f32 v29, v29, v33
    v_add_f32 v233, v233, v37
    v_add_f32 v30, v30, v34
    v_add_f32 v234, v234, v38
    v_add_f32 v31, v31, v35
    v_add_f32 v235, v235, v39
    v_add_f32 v232, v232, v28
    v_add_f32 v233, v233, v29
    v_add_f32 v234, v234, v30
    v_add_f32 v235, v235, v31
    v_cvt_pk_bf16_f32 v28, v232, v233
    v_cvt_pk_bf16_f32 v29, v234, v235
    s_add_u32 s56, s58, 20480
    buffer_store_dwordx2 v[28:29], v3, s[36:39], s56 offen
    s_waitcnt lgkmcnt(0)
    v_add_f32 v40, v40, v44
    v_add_f32 v248, v248, v48
    v_add_f32 v41, v41, v45
    v_add_f32 v249, v249, v49
    v_add_f32 v42, v42, v46
    v_add_f32 v250, v250, v50
    v_add_f32 v43, v43, v47
    v_add_f32 v251, v251, v51
    v_add_f32 v248, v248, v40
    v_add_f32 v249, v249, v41
    v_add_f32 v250, v250, v42
    v_add_f32 v251, v251, v43
    v_cvt_pk_bf16_f32 v40, v248, v249
    v_cvt_pk_bf16_f32 v41, v250, v251
    s_add_u32 s56, s58, 40960
    buffer_store_dwordx2 v[40:41], v5, s[36:39], s56 offen
    s_branch Lfd_66
Lfk_65:
    ds_write_b128 v2, v[208:211] offset:0
    ds_write_b128 v2, v[212:215] offset:1024
    ds_write_b128 v2, v[216:219] offset:2048
    ds_write_b128 v2, v[224:227] offset:3072
    ds_write_b128 v2, v[228:231] offset:4096
    ds_write_b128 v2, v[232:235] offset:5120
    ds_write_b128 v2, v[240:243] offset:6144
    ds_write_b128 v2, v[244:247] offset:7168
    ds_write_b128 v2, v[248:251] offset:8192
    s_lshl_b32 s60, s54, 2
    s_add_u32 s60, s60, 0
    s_mul_i32 s61, s60, 9216
    s_cmp_ge_u32 s60, 4
    s_cselect_b32 s56, 90112, 0
    s_add_u32 s61, s61, s56
    s_add_u32 s61, s61, 2048
    v_add_u32 v6, s61, v1
    s_lshl_b32 s60, s54, 2
    s_add_u32 s60, s60, 1
    s_mul_i32 s61, s60, 9216
    s_cmp_ge_u32 s60, 4
    s_cselect_b32 s56, 90112, 0
    s_add_u32 s61, s61, s56
    s_add_u32 s61, s61, 2048
    v_add_u32 v7, s61, v1
    s_lshl_b32 s60, s54, 2
    s_add_u32 s60, s60, 2
    s_mul_i32 s61, s60, 9216
    s_cmp_ge_u32 s60, 4
    s_cselect_b32 s56, 90112, 0
    s_add_u32 s61, s61, s56
    s_add_u32 s61, s61, 2048
    v_add_u32 v8, s61, v1
    s_waitcnt lgkmcnt(0)
    s_barrier
    ds_read_b128 v[16:19], v6 offset:0
    ds_read_b128 v[20:23], v7 offset:0
    ds_read_b128 v[24:27], v8 offset:0
    ds_read_b128 v[28:31], v6 offset:3072
    ds_read_b128 v[32:35], v7 offset:3072
    ds_read_b128 v[36:39], v8 offset:3072
    ds_read_b128 v[40:43], v6 offset:6144
    ds_read_b128 v[44:47], v7 offset:6144
    ds_read_b128 v[48:51], v8 offset:6144
    s_waitcnt lgkmcnt(6)
    v_add_f32 v16, v16, v20
    v_add_f32 v220, v220, v24
    v_add_f32 v17, v17, v21
    v_add_f32 v221, v221, v25
    v_add_f32 v18, v18, v22
    v_add_f32 v222, v222, v26
    v_add_f32 v19, v19, v23
    v_add_f32 v223, v223, v27
    v_add_f32 v220, v220, v16
    v_add_f32 v221, v221, v17
    v_add_f32 v222, v222, v18
    v_add_f32 v223, v223, v19
    v_cvt_pk_bf16_f32 v16, v220, v221
    v_cvt_pk_bf16_f32 v17, v222, v223
    s_add_u32 s56, s58, 0
    buffer_store_dwordx2 v[16:17], v3, s[36:39], s56 offen
    s_waitcnt lgkmcnt(3)
    v_add_f32 v28, v28, v32
    v_add_f32 v236, v236, v36
    v_add_f32 v29, v29, v33
    v_add_f32 v237, v237, v37
    v_add_f32 v30, v30, v34
    v_add_f32 v238, v238, v38
    v_add_f32 v31, v31, v35
    v_add_f32 v239, v239, v39
    v_add_f32 v236, v236, v28
    v_add_f32 v237, v237, v29
    v_add_f32 v238, v238, v30
    v_add_f32 v239, v239, v31
    v_cvt_pk_bf16_f32 v28, v236, v237
    v_cvt_pk_bf16_f32 v29, v238, v239
    s_add_u32 s56, s58, 20480
    buffer_store_dwordx2 v[28:29], v3, s[36:39], s56 offen
    s_waitcnt lgkmcnt(0)
    v_add_f32 v40, v40, v44
    v_add_f32 v252, v252, v48
    v_add_f32 v41, v41, v45
    v_add_f32 v253, v253, v49
    v_add_f32 v42, v42, v46
    v_add_f32 v254, v254, v50
    v_add_f32 v43, v43, v47
    v_add_f32 v255, v255, v51
    v_add_f32 v252, v252, v40
    v_add_f32 v253, v253, v41
    v_add_f32 v254, v254, v42
    v_add_f32 v255, v255, v43
    v_cvt_pk_bf16_f32 v40, v252, v253
    v_cvt_pk_bf16_f32 v41, v254, v255
    s_add_u32 s56, s58, 40960
    buffer_store_dwordx2 v[40:41], v5, s[36:39], s56 offen
Lfd_66:
    s_branch Ldone
Lldred:
    s_waitcnt vmcnt(11)
    s_barrier
    s_waitcnt vmcnt(0)
    s_barrier
    s_barrier
    v_mov_b32 v5, 163344
    ds_read_b32 v5, v5
    s_waitcnt lgkmcnt(0)
    v_readfirstlane_b32 s49, v5
    s_barrier
Lred:
    s_lshl_b32 s50, s45, 1
    s_add_u32 s50, s50, s46
    s_sub_u32 s50, s50, 30
    s_lshl_b32 s51, s44, 6
    v_add_u32 v1, s51, v0
    v_cmp_le_u32 vcc, 192, v1
    s_nop 1
    v_cndmask_b32 v2, 0, 1, vcc
    v_mul_u32_u24 v3, 192, v2
    v_sub_u32 v3, v1, v3
    v_cmp_le_u32 vcc, 128, v3
    s_nop 1
    v_cndmask_b32 v4, 0, 1, vcc
    v_lshrrev_b32 v6, 5, v3
    v_subrev_u32 v5, 128, v3
    v_lshrrev_b32 v7, 4, v5
    v_cndmask_b32 v6, v6, v7, vcc
    v_bfe_u32 v7, v3, 1, 4
    v_lshrrev_b32 v10, 2, v7
    v_mul_u32_u24 v10, 5, v10
    v_and_b32 v11, 3, v7
    v_add_u32 v12, v10, v11
    v_bfe_u32 v7, v5, 1, 3
    v_lshrrev_b32 v10, 1, v7
    v_mul_u32_u24 v10, 5, v10
    v_add_u32 v13, 4, v10
    v_and_b32 v11, 1, v7
    v_cmp_eq_u32 s[4:5], 1, v11
    s_nop 1
    v_cndmask_b32 v13, v13, 20, s[4:5]
    v_cndmask_b32 v12, v12, v13, vcc
    v_and_b32 v8, 1, v3
    s_and_b32 s51, s50, 1
    s_lshl_b32 s51, s51, 1
    v_add_u32 v16, s51, v2
    v_mul_u32_u24 v15, 5, v16
    v_lshrrev_b32 v9, 2, v15
    v_add_u32 v9, v9, v8
    v_lshl_add_u32 v9, v9, 2, v6
    v_sub_u32 v9, v9, v15
    v_mul_u32_u24 v16, 105, v16
    v_mul_u32_u24 v15, 5, v12
    v_add3_u32 v16, v16, v15, v9
    v_lshlrev_b32 v16, 4, v16
    v_mov_b32 v18, 1073741824
    v_cmp_gt_u32 vcc, 5, v9
    s_nop 1
    v_cndmask_b32 v16, v18, v16, vcc
    v_cmp_gt_u32 vcc, 384, v1
    s_nop 1
    v_cndmask_b32 v16, v18, v16, vcc
    v_lshlrev_b32 v17, 3, v3
    v_mul_u32_u24 v21, 1536, v2
    v_add_u32 v17, v17, v21
    v_cndmask_b32 v17, v18, v17, vcc
    s_cmp_lg_u32 s44, 4
    s_cbranch_scc1 Lrp_67
    v_lshlrev_b32 v19, 2, v0
    s_lshr_b32 s51, s50, 1
    s_lshl_b32 s51, s51, 8
    v_add_u32 v19, s51, v19
    v_cmp_gt_u32 vcc, 16, v0
    s_nop 1
    v_cndmask_b32 v19, v18, v19, vcc
    s_mov_b32 s4, 0
    s_mov_b32 s5, 10559488
    s_mov_b32 s7, 0xffff
Lpoll_68:
    buffer_load_dword v14, v19, s[20:23], s5 offen sc1
    s_waitcnt vmcnt(0)
    v_cmp_eq_u32 vcc, s49, v14
    s_nop 1
    s_and_b32 s6, vcc_lo, s7
    s_cmp_eq_u32 s6, s7
    s_cbranch_scc1 Lpd_69
    s_add_u32 s4, s4, 1
    s_cmp_lt_u32 s4, 40000
    s_sleep 1
    s_cbranch_scc1 Lpoll_68
Lpd_69:
Lrp_67:
    s_barrier
    s_lshr_b32 s51, s50, 1
    s_mul_i32 s51, s51, 114688
    s_add_u32 s51, s51, 9502720
    s_add_u32 s52, s51, 0
    buffer_load_dwordx4 v[32:35], v16, s[20:23], s52 offen sc1
    s_add_u32 s52, s51, 7168
    buffer_load_dwordx4 v[36:39], v16, s[20:23], s52 offen sc1
    s_add_u32 s52, s51, 14336
    buffer_load_dwordx4 v[40:43], v16, s[20:23], s52 offen sc1
    s_add_u32 s52, s51, 21504
    buffer_load_dwordx4 v[44:47], v16, s[20:23], s52 offen sc1
    s_add_u32 s52, s51, 28672
    buffer_load_dwordx4 v[48:51], v16, s[20:23], s52 offen sc1
    s_add_u32 s52, s51, 35840
    buffer_load_dwordx4 v[52:55], v16, s[20:23], s52 offen sc1
    s_add_u32 s52, s51, 43008
    buffer_load_dwordx4 v[56:59], v16, s[20:23], s52 offen sc1
    s_add_u32 s52, s51, 50176
    buffer_load_dwordx4 v[60:63], v16, s[20:23], s52 offen sc1
    s_add_u32 s52, s51, 57344
    buffer_load_dwordx4 v[64:67], v16, s[20:23], s52 offen sc1
    s_add_u32 s52, s51, 64512
    buffer_load_dwordx4 v[68:71], v16, s[20:23], s52 offen sc1
    s_add_u32 s52, s51, 71680
    buffer_load_dwordx4 v[72:75], v16, s[20:23], s52 offen sc1
    s_add_u32 s52, s51, 78848
    buffer_load_dwordx4 v[76:79], v16, s[20:23], s52 offen sc1
    s_add_u32 s52, s51, 86016
    buffer_load_dwordx4 v[80:83], v16, s[20:23], s52 offen sc1
    s_add_u32 s52, s51, 93184
    buffer_load_dwordx4 v[84:87], v16, s[20:23], s52 offen sc1
    s_add_u32 s52, s51, 100352
    buffer_load_dwordx4 v[88:91], v16, s[20:23], s52 offen sc1
    s_add_u32 s52, s51, 107520
    buffer_load_dwordx4 v[92:95], v16, s[20:23], s52 offen sc1
    s_waitcnt vmcnt(14)
    v_add_f32 v32, v32, v36
    v_add_f32 v33, v33, v37
    v_add_f32 v34, v34, v38
    v_add_f32 v35, v35, v39
    s_waitcnt vmcnt(13)
    v_add_f32 v32, v32, v40
    v_add_f32 v33, v33, v41
    v_add_f32 v34, v34, v42
    v_add_f32 v35, v35, v43
    s_waitcnt vmcnt(12)
    v_add_f32 v32, v32, v44
    v_add_f32 v33, v33, v45
    v_add_f32 v34, v34, v46
    v_add_f32 v35, v35, v47
    s_waitcnt vmcnt(11)
    v_add_f32 v32, v32, v48
    v_add_f32 v33, v33, v49
    v_add_f32 v34, v34, v50
    v_add_f32 v35, v35, v51
    s_waitcnt vmcnt(10)
    v_add_f32 v32, v32, v52
    v_add_f32 v33, v33, v53
    v_add_f32 v34, v34, v54
    v_add_f32 v35, v35, v55
    s_waitcnt vmcnt(9)
    v_add_f32 v32, v32, v56
    v_add_f32 v33, v33, v57
    v_add_f32 v34, v34, v58
    v_add_f32 v35, v35, v59
    s_waitcnt vmcnt(8)
    v_add_f32 v32, v32, v60
    v_add_f32 v33, v33, v61
    v_add_f32 v34, v34, v62
    v_add_f32 v35, v35, v63
    s_waitcnt vmcnt(7)
    v_add_f32 v32, v32, v64
    v_add_f32 v33, v33, v65
    v_add_f32 v34, v34, v66
    v_add_f32 v35, v35, v67
    s_waitcnt vmcnt(6)
    v_add_f32 v32, v32, v68
    v_add_f32 v33, v33, v69
    v_add_f32 v34, v34, v70
    v_add_f32 v35, v35, v71
    s_waitcnt vmcnt(5)
    v_add_f32 v32, v32, v72
    v_add_f32 v33, v33, v73
    v_add_f32 v34, v34, v74
    v_add_f32 v35, v35, v75
    s_waitcnt vmcnt(4)
    v_add_f32 v32, v32, v76
    v_add_f32 v33, v33, v77
    v_add_f32 v34, v34, v78
    v_add_f32 v35, v35, v79
    s_waitcnt vmcnt(3)
    v_add_f32 v32, v32, v80
    v_add_f32 v33, v33, v81
    v_add_f32 v34, v34, v82
    v_add_f32 v35, v35, v83
    s_waitcnt vmcnt(2)
    v_add_f32 v32, v32, v84
    v_add_f32 v33, v33, v85
    v_add_f32 v34, v34, v86
    v_add_f32 v35, v35, v87
    s_waitcnt vmcnt(1)
    v_add_f32 v32, v32, v88
    v_add_f32 v33, v33, v89
    v_add_f32 v34, v34, v90
    v_add_f32 v35, v35, v91
    s_waitcnt vmcnt(0)
    v_add_f32 v32, v32, v92
    v_add_f32 v33, v33, v93
    v_add_f32 v34, v34, v94
    v_add_f32 v35, v35, v95
    v_cvt_pk_bf16_f32 v20, v32, v33
    v_cvt_pk_bf16_f32 v21, v34, v35
    s_mul_i32 s52, s50, 3072
    s_add_u32 s52, s52, 10485760
    buffer_store_dwordx2 v[20:21], v17, s[20:23], s52 offen sc1
    s_waitcnt vmcnt(0)
    s_barrier
    s_cmp_lg_u32 s44, 0
    s_cbranch_scc1 Lrf_70
    v_mov_b32 v5, s49
    v_mov_b32 v6, 0
    v_cmp_eq_u32 vcc, 0, v0
    s_nop 1
    v_cndmask_b32 v6, v18, v6, vcc
    s_lshl_b32 s52, s50, 2
    s_add_u32 s52, s52, 10567680
    buffer_store_dword v5, v6, s[20:23], s52 offen sc1
Lrf_70:
    s_cmp_ge_u32 s44, 4
    s_cbranch_scc1 Lro_71
    v_lshlrev_b32 v12, 2, v0
    s_lshl_b32 s56, s48, 3
    v_add_u32 v12, s56, v12
    v_cmp_gt_u32 vcc, 2, v0
    v_mov_b32 v13, 1073741824
    s_nop 0
    v_cndmask_b32 v12, v13, v12, vcc
    s_mov_b32 s4, 0
    s_mov_b32 s5, 10567680
    s_mov_b32 s7, 0x3
Lpoll_72:
    buffer_load_dword v14, v12, s[20:23], s5 offen sc1
    s_waitcnt vmcnt(0)
    v_cmp_eq_u32 vcc, s49, v14
    s_nop 1
    s_and_b32 s6, vcc_lo, s7
    s_cmp_eq_u32 s6, s7
    s_cbranch_scc1 Lpd_73
    s_add_u32 s4, s4, 1
    s_cmp_lt_u32 s4, 40000
    s_sleep 1
    s_cbranch_scc1 Lpoll_72
Lpd_73:
    v_lshlrev_b32 v12, 4, v0
    v_and_b32 v13, 15, v0
    v_lshrrev_b32 v14, 2, v13
    v_lshlrev_b32 v14, 1, v14
    v_and_b32 v8, 1, v13
    v_add_u32 v14, v14, v8
    v_lshlrev_b32 v14, 4, v14
    v_lshrrev_b32 v8, 4, v0
    v_lshl_add_u32 v14, v8, 7, v14
    v_add_u32 v14, 1024, v14
    v_and_b32 v8, 2, v13
    v_cmp_eq_u32 vcc, 0, v8
    v_mov_b32 v8, 1073741824
    s_nop 0
    v_cndmask_b32 v14, v8, v14, vcc
    s_mul_i32 s6, s48, 6144
    s_add_u32 s56, s6, 10485760
    buffer_load_dwordx4 v[152:155], v12, s[20:23], s56 offen sc1
    buffer_load_dwordx4 v[156:159], v14, s[20:23], s56 offen sc1
    s_add_u32 s56, s6, 10487296
    buffer_load_dwordx4 v[160:163], v12, s[20:23], s56 offen sc1
    buffer_load_dwordx4 v[164:167], v14, s[20:23], s56 offen sc1
    s_add_u32 s56, s6, 10488832
    buffer_load_dwordx4 v[168:171], v12, s[20:23], s56 offen sc1
    buffer_load_dwordx4 v[172:175], v14, s[20:23], s56 offen sc1
    s_add_u32 s56, s6, 10490368
    buffer_load_dwordx4 v[28:31], v12, s[20:23], s56 offen sc1
    buffer_load_dwordx4 v[32:35], v14, s[20:23], s56 offen sc1
    s_waitcnt vmcnt(0)
    s_mov_b32 s4, 897988541
    s_lshl_b32 s5, s47, 3
    s_lshl_b32 s6, s44, 1
    s_add_u32 s5, s5, s6
    s_mul_i32 s5, s5, 24
    s_mul_i32 s6, s48, 3
    s_add_u32 s5, s5, s6
    s_lshl_b32 s5, s5, 10
    s_add_u32 s5, s5, 11534336
    v_lshlrev_b32 v14, 4, v0
    v_mfma_f32_16x16x32_bf16 v[36:39], v[152:155], v[176:179], 0
    v_mfma_f32_16x16x32_bf16 v[40:43], v[156:159], v[176:179], 0
    s_nop 7
    v_add_f32 v12, s4, v41
    v_rcp_f32 v12, v12
    s_nop 0
    v_mul_f32 v12, v12, v196
    v_mul_f32 v44, v12, v36
    v_mul_f32 v45, v12, v37
    v_mul_f32 v46, v12, v38
    v_mul_f32 v47, v12, v39
    v_cvt_pk_bf16_f32 v8, v44, v45
    v_cvt_pk_bf16_f32 v9, v46, v47
    v_mul_f32 v48, v12, v40
    v_mfma_f32_16x16x32_bf16 v[36:39], v[160:163], v[178:181], 0
    v_mfma_f32_16x16x32_bf16 v[40:43], v[164:167], v[178:181], 0
    s_nop 7
    v_add_f32 v12, s4, v41
    v_rcp_f32 v12, v12
    s_nop 0
    v_mul_f32 v12, v12, v196
    v_mul_f32 v49, v12, v36
    v_mul_f32 v50, v12, v37
    v_mul_f32 v51, v12, v38
    v_cvt_pk_bf16_f32 v10, v48, v49
    v_cvt_pk_bf16_f32 v11, v50, v51
    s_add_u32 s56, s5, 0
    buffer_store_dwordx4 v[8:11], v14, s[20:23], s56 offen sc1
    v_mul_f32 v44, v12, v39
    v_mul_f32 v45, v12, v40
    v_mfma_f32_16x16x32_bf16 v[36:39], v[168:171], v[180:183], 0
    v_mfma_f32_16x16x32_bf16 v[40:43], v[172:175], v[180:183], 0
    s_nop 7
    v_add_f32 v12, s4, v41
    v_rcp_f32 v12, v12
    s_nop 0
    v_mul_f32 v12, v12, v196
    v_mul_f32 v46, v12, v36
    v_mul_f32 v47, v12, v37
    v_cvt_pk_bf16_f32 v8, v44, v45
    v_cvt_pk_bf16_f32 v9, v46, v47
    v_mul_f32 v48, v12, v38
    v_mul_f32 v49, v12, v39
    v_mul_f32 v50, v12, v40
    v_mfma_f32_16x16x32_bf16 v[36:39], v[28:31], v[182:185], 0
    v_mfma_f32_16x16x32_bf16 v[40:43], v[32:35], v[182:185], 0
    s_nop 7
    v_add_f32 v12, s4, v41
    v_rcp_f32 v12, v12
    s_nop 0
    v_mul_f32 v12, v12, v196
    v_mul_f32 v51, v12, v36
    v_cvt_pk_bf16_f32 v10, v48, v49
    v_cvt_pk_bf16_f32 v11, v50, v51
    s_add_u32 s56, s5, 1024
    buffer_store_dwordx4 v[8:11], v14, s[20:23], s56 offen sc1
    v_mul_f32 v44, v12, v37
    v_mul_f32 v45, v12, v38
    v_mul_f32 v46, v12, v39
    v_mul_f32 v47, v12, v40
    v_cvt_pk_bf16_f32 v8, v44, v45
    v_cvt_pk_bf16_f32 v9, v46, v47
    v_mov_b32 v10, 0
    v_mov_b32 v11, 0
    s_add_u32 s56, s5, 2048
    buffer_store_dwordx4 v[8:11], v14, s[20:23], s56 offen sc1
    v_mfma_f32_16x16x32_bf16 v[36:39], v[152:155], v[186:189], 0
    v_mfma_f32_16x16x32_bf16 v[40:43], v[156:159], v[186:189], 0
    s_nop 7
    v_add_f32 v12, s4, v41
    v_rcp_f32 v12, v12
    s_nop 0
    v_mul_f32 v12, v12, v197
    v_mul_f32 v44, v12, v36
    v_mul_f32 v45, v12, v37
    v_mul_f32 v46, v12, v38
    v_mul_f32 v47, v12, v39
    v_cvt_pk_bf16_f32 v8, v44, v45
    v_cvt_pk_bf16_f32 v9, v46, v47
    v_mul_f32 v48, v12, v40
    v_mfma_f32_16x16x32_bf16 v[36:39], v[160:163], v[188:191], 0
    v_mfma_f32_16x16x32_bf16 v[40:43], v[164:167], v[188:191], 0
    s_nop 7
    v_add_f32 v12, s4, v41
    v_rcp_f32 v12, v12
    s_nop 0
    v_mul_f32 v12, v12, v197
    v_mul_f32 v49, v12, v36
    v_mul_f32 v50, v12, v37
    v_mul_f32 v51, v12, v38
    v_cvt_pk_bf16_f32 v10, v48, v49
    v_cvt_pk_bf16_f32 v11, v50, v51
    s_add_u32 s56, s5, 24576
    buffer_store_dwordx4 v[8:11], v14, s[20:23], s56 offen sc1
    v_mul_f32 v44, v12, v39
    v_mul_f32 v45, v12, v40
    v_mfma_f32_16x16x32_bf16 v[36:39], v[168:171], v[190:193], 0
    v_mfma_f32_16x16x32_bf16 v[40:43], v[172:175], v[190:193], 0
    s_nop 7
    v_add_f32 v12, s4, v41
    v_rcp_f32 v12, v12
    s_nop 0
    v_mul_f32 v12, v12, v197
    v_mul_f32 v46, v12, v36
    v_mul_f32 v47, v12, v37
    v_cvt_pk_bf16_f32 v8, v44, v45
    v_cvt_pk_bf16_f32 v9, v46, v47
    v_mul_f32 v48, v12, v38
    v_mul_f32 v49, v12, v39
    v_mul_f32 v50, v12, v40
    v_mfma_f32_16x16x32_bf16 v[36:39], v[28:31], v[192:195], 0
    v_mfma_f32_16x16x32_bf16 v[40:43], v[32:35], v[192:195], 0
    s_nop 7
    v_add_f32 v12, s4, v41
    v_rcp_f32 v12, v12
    s_nop 0
    v_mul_f32 v12, v12, v197
    v_mul_f32 v51, v12, v36
    v_cvt_pk_bf16_f32 v10, v48, v49
    v_cvt_pk_bf16_f32 v11, v50, v51
    s_add_u32 s56, s5, 25600
    buffer_store_dwordx4 v[8:11], v14, s[20:23], s56 offen sc1
    v_mul_f32 v44, v12, v37
    v_mul_f32 v45, v12, v38
    v_mul_f32 v46, v12, v39
    v_mul_f32 v47, v12, v40
    v_cvt_pk_bf16_f32 v8, v44, v45
    v_cvt_pk_bf16_f32 v9, v46, v47
    v_mov_b32 v10, 0
    v_mov_b32 v11, 0
    s_add_u32 s56, s5, 26624
    buffer_store_dwordx4 v[8:11], v14, s[20:23], s56 offen sc1
    s_waitcnt vmcnt(0)
    v_mov_b32 v12, 163348
    v_mov_b32 v13, 1
    v_cmp_eq_u32 vcc, 0, v0
    s_nop 1
    s_and_saveexec_b64 s[4:5], vcc
    ds_add_rtn_u32 v13, v12, v13
    s_waitcnt lgkmcnt(0)
    s_mov_b64 exec, s[4:5]
    v_readfirstlane_b32 s6, v13
    s_nop 1
    s_cmp_lg_u32 s6, 3
    s_cbranch_scc1 Lop_74
    v_mov_b32 v12, s49
    v_mov_b32 v13, 0
    v_cmp_eq_u32 vcc, 0, v0
    v_mov_b32 v14, 1073741824
    s_nop 0
    v_cndmask_b32 v13, v14, v13, vcc
    s_lshl_b32 s4, s47, 8
    s_lshl_b32 s5, s48, 2
    s_add_u32 s4, s4, s5
    s_add_u32 s4, s4, 10575872
    buffer_store_dword v12, v13, s[20:23], s4 offen sc1
Lfl_75:
Lop_74:
Lro_71:
Ldone:
Lend:
    s_endpgm
Lcode_end:
.section .rodata,"a"
.p2align 6
.amdhsa_kernel gated_mix__linear_attn_block__dense_activation_relu__prompt_kernel
  .amdhsa_next_free_vgpr 256
  .amdhsa_next_free_sgpr 102
  .amdhsa_accum_offset 256
  .amdhsa_group_segment_fixed_size 0
  .amdhsa_kernarg_size 80
  .amdhsa_user_sgpr_count 2
  .amdhsa_user_sgpr_kernarg_segment_ptr 1
  .amdhsa_system_sgpr_workgroup_id_x 1
.end_amdhsa_kernel
```
